```python
import torch

def _softmax(x, axis=-1):
    return torch.softmax(x, dim=axis)
def _gelu(x):
    return torch.nn.functional.gelu(x, approximate="tanh")
def _silu(x):
    return torch.nn.functional.silu(x)
def _sigmoid(x):
    return torch.sigmoid(x)
def _layernorm(x, axis=-1, eps=1e-5):
    m = x.mean(dim=axis, keepdim=True)
    v = x.var(dim=axis, keepdim=True, unbiased=False)
    return (x - m) / torch.sqrt(v + eps)
def _scatter_add(tgt, idx, src, axis=0):
    return tgt.clone().index_add_(axis, idx, src)
def _segment_sum(src, seg, n):
    out = torch.zeros((n,) + src.shape[1:], dtype=src.dtype)
    return out.index_add_(0, seg, src)
def _pad(x, pw):
    flat = tuple(v for pair in reversed(pw) for v in pair)
    return torch.nn.functional.pad(x, flat)

kernel_name = 'gated_mix__linear_kernel_hedgehog__grouped_kv_mqa__prompt'

def setup_inputs():

    _w = (lambda a: (lambda t: t.to(torch.bfloat16) if t.is_floating_point() else t)(torch.as_tensor(a)))
    def _A_setup():
        B, S, D, H = 1, 2048, 576, 32
        Dh = D // H
        return {
            "x": _w((lambda *s: torch.randn(*s, dtype=torch.bfloat16) * 0.05)(B, S, D)),
            "wqkv": _w((lambda *s: torch.randn(*s, dtype=torch.bfloat16) * 1.6)(D, 3 * D)),
            "w_phi": _w((lambda *s: torch.randn(*s, dtype=torch.bfloat16) * 1.6)(H, Dh, Dh) * (Dh ** -0.5)),
            "wo": _w((lambda *s: torch.randn(*s, dtype=torch.bfloat16) * 0.05)(D, D)),
        }
    _A_in = _A_setup()

    def _B_setup():
        B, S, D, H = 1, 2048, 576, 32
        Dh = D // H
        return {
            "x": _w((lambda *s: torch.randn(*s, dtype=torch.bfloat16) * 0.05)(B, S, D)),
            "wq": _w((lambda *s: torch.randn(*s, dtype=torch.bfloat16) * 1.6)(D, H * Dh)),
            "wk": _w((lambda *s: torch.randn(*s, dtype=torch.bfloat16) * 1.6)(D, Dh)),
            "wv": _w((lambda *s: torch.randn(*s, dtype=torch.bfloat16) * 0.05)(D, Dh)),
            "wo": _w((lambda *s: torch.randn(*s, dtype=torch.bfloat16) * 0.05)(H * Dh, D)),
        }
    _B_in = _B_setup()

    return {
        "A_x": _A_in["x"],
        "A_wqkv": _A_in["wqkv"],
        "A_w_phi": _A_in["w_phi"],
        "A_wo": _A_in["wo"],
        "B_x": _B_in["x"],
        "B_wq": _B_in["wq"],
        "B_wk": _B_in["wk"],
        "B_wv": _B_in["wv"],
        "B_wo": _B_in["wo"],
        "gate_w": _w((lambda *s: torch.randn(*s, dtype=torch.bfloat16) * 0.05)(576) * 16.0),
    }

def reference(A_x, A_wqkv, A_w_phi, A_wo, B_x, B_wq, B_wk, B_wv, B_wo, gate_w):
    def _A_ref(x, wqkv, w_phi, wo):
        B, S, D = x.shape
        H = 32; Dh = D // H
        qkv = (lambda x, *d: x.permute(*d))((x @ wqkv).reshape(B, S, 3, H, Dh), 2, 0, 3, 1, 4)
        q, k, v = qkv[0], qkv[1], qkv[2]
        pq = torch.einsum("bhsd,hdf->bhsf", q, w_phi)
        pk = torch.einsum("bhsd,hdf->bhsf", k, w_phi)
        phi_q = torch.concatenate([_softmax(pq, axis=-1), _softmax(-pq, axis=-1)], axis=-1)
        phi_k = torch.concatenate([_softmax(pk, axis=-1), _softmax(-pk, axis=-1)], axis=-1)
        kv = torch.einsum("bhsf,bhsd->bhfd", phi_k, v)
        z  = torch.einsum("bhsf->bhf", phi_k)
        num = torch.einsum("bhqf,bhfd->bhqd", phi_q, kv)
        den = torch.einsum("bhqf,bhf->bhq", phi_q, z)[..., None] + 1e-6
        o = num / den
        return (lambda x, *d: x.permute(*d))(o, 0, 2, 1, 3).reshape(B, S, D) @ wo

    def _B_ref(x, wq, wk, wv, wo):
        B, S, D = x.shape
        H = 32
        Dh = D // H
        q = (lambda x, *d: x.permute(*d))((x @ wq).reshape(B, S, H, Dh), 0, 2, 1, 3)
        k = x @ wk
        v = x @ wv
        scores = torch.einsum("bhqd,bkd->bhqk", q, k) * (Dh ** -0.5)
        p = _softmax(scores, axis=-1)
        o = torch.einsum("bhqk,bkd->bhqd", p, v)
        return (lambda x, *d: x.permute(*d))(o, 0, 2, 1, 3).reshape(B, S, H * Dh) @ wo

    x = A_x
    g = _sigmoid((x * gate_w).sum(-1, keepdims=True))
    a = _A_ref(x, A_wqkv, A_w_phi, A_wo)
    b = _B_ref(x, B_wq, B_wk, B_wv, B_wo)
    return g * a + (1 - g) * b
```

```asm
; @launch grid=(256,1,1) block=(512,1,1) lds=163840
.amdgcn_target "amdgcn-amd-amdhsa--gfx950"
.text
.globl gated_mix__linear_kernel_hedgehog__grouped_kv_mqa__prompt_kernel
.p2align 8
.type gated_mix__linear_kernel_hedgehog__grouped_kv_mqa__prompt_kernel,@function
gated_mix__linear_kernel_hedgehog__grouped_kv_mqa__prompt_kernel:
    s_cmp_ge_u32 s2, 256
    s_cbranch_scc1 L_exit0
    s_load_dwordx8 s[4:11], s[0:1], 0
    s_load_dwordx2 s[14:15], s[0:1], 40
    s_load_dwordx4 s[16:19], s[0:1], 48
    s_load_dwordx8 s[20:27], s[0:1], 64
    s_load_dwordx2 s[28:29], s[0:1], 96
    v_lshrrev_b32 v2, 6, v0
    v_and_b32 v1, 63, v0
    v_readfirstlane_b32 s48, v2
    s_nop 0
    s_cmp_lg_u32 s48, 2
    s_cbranch_scc1 L_g_1
    s_getpc_b64 s[78:79]
L_pcref:
    s_bfe_u32 s57, s2, 0x30003
    s_lshl_b32 s57, s57, 13
    v_lshl_add_u32 v12, v1, 7, s57
    v_cmp_gt_u32 vcc, L_codeend-L_pcref-4, v12
    s_nop 0
    s_and_saveexec_b64 s[92:93], vcc
    s_cbranch_execz L_cp_2
    global_load_dword v51, v12, s[78:79]
L_cp_2:
    s_mov_b64 exec, s[92:93]
L_g_1:
    s_and_b32 s53, s2, 1
    s_bfe_u32 s57, s2, 0x20001
    s_bfe_u32 s58, s2, 0x20003
    s_lshl_b32 s51, s57, 2
    s_or_b32 s51, s51, s58
    s_lshr_b32 s52, s2, 5
    s_lshl_b32 s58, s58, 1
    s_add_u32 s54, s52, s58
    s_add_u32 s54, s54, s57
    s_cmp_ge_u32 s54, 9
    s_cselect_b32 s58, 9, 0
    s_sub_u32 s54, s54, s58
    v_lshrrev_b32 v12, 3, v1
    v_mul_u32_u24 v12, 1152, v12
    v_lshrrev_b32 v11, 4, v1
    v_and_b32 v13, 7, v1
    v_xor_b32 v11, v11, v13
    v_lshl_add_u32 v70, v11, 4, v12
    v_xor_b32 v11, 4, v11
    v_lshl_add_u32 v71, v11, 4, v12
    v_add_u32 v71, 9216, v71
    s_and_b32 s49, s48, 3
    s_lshr_b32 s50, s48, 2
    s_cbranch_scc0 L_lower
    s_setprio 3
    s_lshl_b32 s56, s51, 2
    s_add_u32 s56, s56, s49
    s_mul_i32 s56, s56, 36864
    s_lshl_b32 s74, s49, 12
    s_lshr_b32 s60, s49, 1
    s_or_b32 s85, s60, s53
    s_movk_i32 s62, 1152
    s_cselect_b32 s62, 3456, s62
    s_sub_u32 s86, 2, s60
    s_mul_i32 s86, s86, s53
    s_mul_i32 s86, s86, 1152
    s_mul_i32 s59, s52, 144
    s_add_u32 s86, s86, s59
    s_and_b32 s59, s49, 1
    s_mul_i32 s96, s60, 10368
    s_mul_i32 s60, s59, 5120
    s_add_u32 s96, s96, s60
    s_lshl_b32 s63, s62, 5
    s_mul_i32 s60, s59, s63
    s_add_u32 s86, s86, s60
    s_lshl_b32 s63, s62, 6
    s_mul_i32 s38, s62, 576
    s_sub_u32 s38, s38, s86
    s_mov_b32 s39, 0x00020000
    v_mul_u32_u24 v12, 6554, v1
    v_lshrrev_b32 v12, 16, v12
    v_mad_i32_i24 v13, v12, -10, v1
    v_min_u32 v13, 8, v13
    v_mul_u32_u24 v12, s62, v12
    v_lshl_add_u32 v34, v13, 4, v12
    v_add_u32 v11, 64, v1
    v_mul_u32_u24 v12, 6554, v11
    v_lshrrev_b32 v12, 16, v12
    v_mad_i32_i24 v13, v12, -10, v11
    v_min_u32 v13, 8, v13
    v_mul_u32_u24 v12, s62, v12
    v_lshl_add_u32 v35, v13, 4, v12
    v_add_u32 v11, 128, v1
    v_mul_u32_u24 v12, 6554, v11
    v_lshrrev_b32 v12, 16, v12
    v_mad_i32_i24 v13, v12, -10, v11
    v_min_u32 v13, 8, v13
    v_mul_u32_u24 v12, s62, v12
    v_lshl_add_u32 v36, v13, 4, v12
    v_add_u32 v11, 192, v1
    v_mul_u32_u24 v12, 6554, v11
    v_lshrrev_b32 v12, 16, v12
    v_mad_i32_i24 v13, v12, -10, v11
    v_min_u32 v13, 8, v13
    v_mul_u32_u24 v12, s62, v12
    v_lshl_add_u32 v37, v13, 4, v12
    v_add_u32 v11, 256, v1
    v_mul_u32_u24 v12, 6554, v11
    v_lshrrev_b32 v12, 16, v12
    v_mad_i32_i24 v13, v12, -10, v11
    v_min_u32 v13, 8, v13
    v_mul_u32_u24 v12, s62, v12
    v_lshl_add_u32 v38, v13, 4, v12
    s_waitcnt lgkmcnt(0)
    s_mov_b32 s32, s4
    s_and_b32 s33, s5, 0xffff
    s_mov_b32 s34, 2359296
    s_mov_b32 s35, 0x00020000
    s_setprio 0
    s_lshl_b32 s66, s54, 7
    s_add_u32 s66, s66, s56
    s_add_u32 m0, s74, 110976
    s_nop 0
    buffer_load_dwordx4 v70, s[32:35], s66 offen lds
    s_add_u32 m0, s74, 112000
    s_nop 0
    buffer_load_dwordx4 v71, s[32:35], s66 offen lds
    s_add_u32 m0, s74, 113024
    s_add_u32 s66, s66, 18432
    buffer_load_dwordx4 v70, s[32:35], s66 offen lds
    s_add_u32 m0, s74, 114048
    s_nop 0
    buffer_load_dwordx4 v71, s[32:35], s66 offen lds
    s_cmp_eq_u32 s85, 0
    s_cselect_b32 s36, s14, s6
    s_cselect_b32 s37, s15, s7
    s_add_u32 s36, s36, s86
    s_addc_u32 s37, s37, 0
    s_and_b32 s37, s37, 0xffff
    s_mul_i32 s67, s54, s63
    s_add_u32 m0, s96, 127360
    s_nop 0
    buffer_load_dwordx4 v34, s[36:39], s67 offen lds
    s_add_u32 m0, s96, 128384
    s_nop 0
    buffer_load_dwordx4 v35, s[36:39], s67 offen lds
    s_add_u32 m0, s96, 129408
    s_nop 0
    buffer_load_dwordx4 v36, s[36:39], s67 offen lds
    s_add_u32 m0, s96, 130432
    s_nop 0
    buffer_load_dwordx4 v37, s[36:39], s67 offen lds
    s_add_u32 m0, s96, 131456
    s_add_u32 s54, s54, 1
    buffer_load_dwordx4 v38, s[36:39], s67 offen lds
    s_cmp_eq_u32 s54, 9
    s_cselect_b32 s54, 0, s54
    s_setprio 0
    s_branch L_upper
L_lower:
    s_lshl_b32 s75, s48, 10
    s_mov_b32 s84, 65536
    v_lshlrev_b32 v18, 4, v1
    v_lshrrev_b32 v6, 5, v1
    v_and_b32 v7, 31, v1
    v_add_u32 v57, 0, v1
    v_mul_u32_u24 v58, 21846, v57
    v_lshrrev_b32 v58, 16, v58
    v_mul_u32_u24 v60, 3, v58
    v_sub_u32 v60, v57, v60
    v_lshlrev_b32 v60, 4, v60
    v_min_u32 v60, 20, v60
    v_mad_u32_u24 v34, v58, 36, v60
    v_add_u32 v57, 64, v1
    v_mul_u32_u24 v58, 21846, v57
    v_lshrrev_b32 v58, 16, v58
    v_mul_u32_u24 v60, 3, v58
    v_sub_u32 v60, v57, v60
    v_lshlrev_b32 v60, 4, v60
    v_min_u32 v60, 20, v60
    v_mad_u32_u24 v35, v58, 36, v60
    v_add_u32 v57, 128, v1
    v_mul_u32_u24 v58, 21846, v57
    v_lshrrev_b32 v58, 16, v58
    v_mul_u32_u24 v60, 3, v58
    v_sub_u32 v60, v57, v60
    v_lshlrev_b32 v60, 4, v60
    v_min_u32 v60, 20, v60
    v_mad_u32_u24 v36, v58, 36, v60
    s_lshl_b32 s57, s51, 3
    s_add_u32 s57, s57, s52
    s_mul_i32 s57, s57, 18432
    s_lshl_b32 s58, s48, 8
    s_add_u32 s57, s57, s58
    s_mul_i32 s58, s48, 4608
    s_mul_i32 s59, s48, 6144
    s_lshl_b32 s60, s48, 12
    s_mov_b32 s70, 20736
    s_mov_b32 s71, 0x00020000
    s_cmp_eq_u32 s53, 0
    s_waitcnt lgkmcnt(0)
    s_cselect_b32 s68, s16, s18
    s_cselect_b32 s69, s17, s19
    s_and_b32 s69, s69, 0xffff
    s_mov_b32 s32, s4
    s_and_b32 s33, s5, 0xffff
    s_mov_b32 s34, 2359296
    s_mov_b32 s35, 0x00020000
    s_load_dword s83, s[28:29], 163840
    s_add_u32 m0, s60, 64640
    s_nop 0
    buffer_load_dwordx4 v70, s[32:35], s57 offen lds
    s_add_u32 m0, s60, 65664
    s_nop 0
    buffer_load_dwordx4 v71, s[32:35], s57 offen lds
    s_add_u32 m0, s59, 36992
    s_nop 0
    buffer_load_dwordx4 v34, s[68:71], s58 offen lds
    s_add_u32 m0, s59, 38016
    s_nop 0
    buffer_load_dwordx4 v35, s[68:71], s58 offen lds
    s_add_u32 m0, s59, 39040
    s_nop 0
    buffer_load_dwordx4 v36, s[68:71], s58 offen lds
    s_add_u32 s57, s57, 128
    s_add_u32 s58, s58, 2304
    s_add_u32 m0, s60, 66688
    s_nop 0
    buffer_load_dwordx4 v70, s[32:35], s57 offen lds
    s_add_u32 m0, s60, 67712
    s_nop 0
    buffer_load_dwordx4 v71, s[32:35], s57 offen lds
    s_add_u32 m0, s59, 40064
    s_nop 0
    buffer_load_dwordx4 v34, s[68:71], s58 offen lds
    s_add_u32 m0, s59, 41088
    s_nop 0
    buffer_load_dwordx4 v35, s[68:71], s58 offen lds
    s_add_u32 m0, s59, 42112
    s_nop 0
    buffer_load_dwordx4 v36, s[68:71], s58 offen lds
    s_add_u32 s57, s57, 128
    s_add_u32 s58, s58, 2304
    s_cmp_lg_u32 s48, 3
    s_cbranch_scc1 L_g_3
    s_add_u32 m0, s60, 68736
    s_nop 0
    buffer_load_dwordx4 v70, s[32:35], s57 offen lds
    s_add_u32 m0, s60, 69760
    s_nop 0
    buffer_load_dwordx4 v71, s[32:35], s57 offen lds
    s_add_u32 m0, s59, 43136
    s_nop 0
    buffer_load_dwordx4 v34, s[68:71], s58 offen lds
    s_add_u32 m0, s59, 44160
    s_nop 0
    buffer_load_dwordx4 v35, s[68:71], s58 offen lds
    s_add_u32 m0, s59, 45184
    s_nop 0
    buffer_load_dwordx4 v36, s[68:71], s58 offen lds
    s_add_u32 s57, s57, 128
    s_add_u32 s58, s58, 2304
L_g_3:
    s_cmp_lg_u32 s48, 0
    s_cbranch_scc1 L_g_4
    s_mov_b32 s68, s8
    s_and_b32 s69, s9, 0xffff
    s_mov_b32 s70, 20736
    s_mov_b32 s71, 0x00020000
    s_mul_i32 s57, s52, 2592
    s_mov_b32 m0, 159744
    s_nop 0
    buffer_load_dwordx4 v34, s[68:71], s57 offen lds
    s_mov_b32 m0, 160768
    s_nop 0
    buffer_load_dwordx4 v35, s[68:71], s57 offen lds
    s_mov_b32 m0, 161792
    s_nop 0
    buffer_load_dwordx4 v36, s[68:71], s57 offen lds
    s_add_u32 s57, s57, 2304
    s_mov_b32 m0, 162816
    s_nop 0
    buffer_load_dwordx4 v34, s[68:71], s57 offen lds
L_g_4:
    s_cmp_lg_u32 s48, 1
    s_cbranch_scc1 L_g_5
    s_mov_b32 s68, s22
    s_and_b32 s69, s23, 0xffff
    s_mov_b32 s70, 1152
    s_mov_b32 s71, 0x00020000
    s_mov_b32 m0, 157696
    s_nop 0
    buffer_load_dwordx4 v18, s[68:71], 0 offen lds
    buffer_load_dwordx4 v18, s[68:71], 0 offen offset:1024 lds
L_g_5:
    s_mov_b32 s44, s28
    s_and_b32 s45, s29, 0xffff
    s_mov_b32 s46, 11894784
    s_mov_b32 s47, 0x00020000
    s_movk_i32 s59, 1152
    v_add_u32 v56, 0, v0
    v_mul_u32_u24 v57, 7282, v56
    v_lshrrev_b32 v57, 16, v57
    v_mul_u32_u24 v60, 9, v57
    v_sub_u32 v60, v56, v60
    v_lshlrev_b32 v58, 4, v60
    v_and_b32 v60, 48, v57
    v_and_b32 v61, 3, v57
    v_lshl_or_b32 v60, v61, 2, v60
    v_bfe_u32 v61, v57, 2, 2
    v_or_b32 v57, v60, v61
    v_lshrrev_b32 v60, 4, v57
    v_and_b32 v61, 3, v57
    v_and_b32 v62, 4, v57
    v_lshl_add_u32 v61, v62, 1, v61
    v_bfe_u32 v62, v57, 3, 1
    v_lshl_add_u32 v61, v62, 2, v61
    v_mad_u32_u24 v61, v60, 18, v61
    v_mad_u32_u24 v246, v61, s59, v58
    v_and_b32 v63, 1, v60
    v_lshl_add_u32 v61, v63, 1, v61
    v_mad_u32_u24 v240, v61, s59, v58
    v_bfe_u32 v61, v57, 1, 1
    v_lshl_add_u32 v61, v60, 1, v61
    v_and_b32 v63, 4, v57
    v_lshl_add_u32 v61, v63, 1, v61
    v_and_b32 v63, 1, v57
    v_mad_u32_u24 v61, v61, 36, v63
    v_add_u32 v61, 16, v61
    v_lshl_add_u32 v63, v62, 1, v61
    v_mad_u32_u24 v243, v63, s59, v58
    v_mad_u32_u24 v63, v62, 18, v61
    v_mad_u32_u24 v249, v63, s59, v58
    v_add_u32 v56, 192, v0
    v_mul_u32_u24 v57, 7282, v56
    v_lshrrev_b32 v57, 16, v57
    v_mul_u32_u24 v60, 9, v57
    v_sub_u32 v60, v56, v60
    v_lshlrev_b32 v58, 4, v60
    v_and_b32 v60, 48, v57
    v_and_b32 v61, 3, v57
    v_lshl_or_b32 v60, v61, 2, v60
    v_bfe_u32 v61, v57, 2, 2
    v_or_b32 v57, v60, v61
    v_lshrrev_b32 v60, 4, v57
    v_and_b32 v61, 3, v57
    v_and_b32 v62, 4, v57
    v_lshl_add_u32 v61, v62, 1, v61
    v_bfe_u32 v62, v57, 3, 1
    v_lshl_add_u32 v61, v62, 2, v61
    v_mad_u32_u24 v61, v60, 18, v61
    v_mad_u32_u24 v247, v61, s59, v58
    v_and_b32 v63, 1, v60
    v_lshl_add_u32 v61, v63, 1, v61
    v_mad_u32_u24 v241, v61, s59, v58
    v_bfe_u32 v61, v57, 1, 1
    v_lshl_add_u32 v61, v60, 1, v61
    v_and_b32 v63, 4, v57
    v_lshl_add_u32 v61, v63, 1, v61
    v_and_b32 v63, 1, v57
    v_mad_u32_u24 v61, v61, 36, v63
    v_add_u32 v61, 16, v61
    v_lshl_add_u32 v63, v62, 1, v61
    v_mad_u32_u24 v244, v63, s59, v58
    v_mad_u32_u24 v63, v62, 18, v61
    v_mad_u32_u24 v250, v63, s59, v58
    v_add_u32 v56, 384, v0
    v_mul_u32_u24 v57, 7282, v56
    v_lshrrev_b32 v57, 16, v57
    v_mul_u32_u24 v60, 9, v57
    v_sub_u32 v60, v56, v60
    v_lshlrev_b32 v58, 4, v60
    v_and_b32 v60, 48, v57
    v_and_b32 v61, 3, v57
    v_lshl_or_b32 v60, v61, 2, v60
    v_bfe_u32 v61, v57, 2, 2
    v_or_b32 v57, v60, v61
    v_lshrrev_b32 v60, 4, v57
    v_and_b32 v61, 3, v57
    v_and_b32 v62, 4, v57
    v_lshl_add_u32 v61, v62, 1, v61
    v_bfe_u32 v62, v57, 3, 1
    v_lshl_add_u32 v61, v62, 2, v61
    v_mad_u32_u24 v61, v60, 18, v61
    v_mad_u32_u24 v248, v61, s59, v58
    v_and_b32 v63, 1, v60
    v_lshl_add_u32 v61, v63, 1, v61
    v_mad_u32_u24 v242, v61, s59, v58
    v_bfe_u32 v61, v57, 1, 1
    v_lshl_add_u32 v61, v60, 1, v61
    v_and_b32 v63, 4, v57
    v_lshl_add_u32 v61, v63, 1, v61
    v_and_b32 v63, 1, v57
    v_mad_u32_u24 v61, v61, 36, v63
    v_add_u32 v61, 16, v61
    v_lshl_add_u32 v63, v62, 1, v61
    v_mad_u32_u24 v245, v63, s59, v58
    v_mad_u32_u24 v63, v62, 18, v61
    v_mad_u32_u24 v251, v63, s59, v58
    v_bfe_u32 v32, v1, 2, 2
    v_bfe_u32 v61, v1, 4, 1
    v_and_b32 v62, 3, v1
    v_lshl_add_u32 v33, v61, 2, v62
    v_mov_b32 v59, 163840
    v_cmp_eq_u32 s[78:79], 1, v61
    v_cmp_eq_u32 s[76:77], 1, v6
    s_and_b32 s87, s49, 1
    v_lshlrev_b32 v63, 3, v62
    v_cndmask_b32 v63, v63, 40, s[78:79]
    v_mad_u32_u24 v63, v32, 48, v63
    s_mul_i32 s57, s49, 6144
    s_add_u32 s57, s57, 36992
    v_mul_u32_u24 v60, 384, v6
    v_cmp_lt_u32 vcc, 4, v33
    v_add3_u32 v38, v63, v60, s57
    s_nop 0
    v_cndmask_b32 v38, v38, v59, vcc
    v_bfe_u32 v63, v7, 1, 3
    v_xor_b32 v63, v63, v6
    v_lshlrev_b32 v60, 7, v7
    s_lshl_b32 s57, s49, 12
    s_add_u32 s58, s57, 64640
    v_xor_b32 v58, 0, v63
    v_lshl_add_u32 v58, v58, 4, v60
    v_add_u32 v8, s57, v58
    v_add_u32 v12, 73984, v8
    v_add_u32 v58, s58, v58
    v_cndmask_b32 v34, v58, v59, s[78:79]
    v_xor_b32 v58, 2, v63
    v_lshl_add_u32 v58, v58, 4, v60
    v_add_u32 v9, s57, v58
    v_add_u32 v13, 73984, v9
    v_add_u32 v58, s58, v58
    v_cndmask_b32 v35, v58, v59, s[78:79]
    v_xor_b32 v58, 4, v63
    v_lshl_add_u32 v58, v58, 4, v60
    v_add_u32 v10, s57, v58
    v_add_u32 v14, 73984, v10
    v_add_u32 v58, s58, v58
    v_cndmask_b32 v36, v58, v59, s[78:79]
    v_xor_b32 v58, 6, v63
    v_lshl_add_u32 v58, v58, 4, v60
    v_add_u32 v11, s57, v58
    v_add_u32 v15, 73984, v11
    v_add_u32 v58, s58, v58
    v_cndmask_b32 v37, v58, v59, s[78:79]
    v_lshl_add_u32 v60, v6, 3, v32
    v_mul_u32_u24 v60, 160, v60
    s_mul_i32 s57, s87, 72
    s_add_u32 s57, s57, 16384
    v_add_u32 v60, s57, v60
    s_movk_i32 s58, 10368
    v_mad_u32_u24 v63, v61, s58, v60
    v_lshl_add_u32 v20, v62, 3, v63
    v_add_u32 v21, 73984, v20
    v_lshrrev_b32 v63, 1, v62
    v_and_b32 v58, 1, v62
    v_cndmask_b32 v63, v63, v58, s[78:79]
    v_mad_u32_u24 v63, v63, s58, v60
    s_mul_i32 s57, s87, -144
    s_add_u32 s57, s57, 72
    v_add_u32 v58, s57, v63
    v_cmp_gt_u32 vcc, 6, v33
    v_cndmask_b32 v63, v63, v58, s[78:79]
    v_add_u32 v58, 73984, v63
    v_cndmask_b32 v22, v59, v63, vcc
    v_cndmask_b32 v23, v59, v58, vcc
    v_lshlrev_b32 v26, 4, v6
    v_add_u32 v26, 157696, v26
    s_mov_b32 s72, 0x11000000
    s_mov_b32 s73, 0x11000000
    s_cmp_eq_u32 s53, 0
    s_cselect_b32 s58, 16, 24
    v_mad_u32_u24 v56, v6, s58, v7
    s_bfm_b32 s92, s58, 0
    s_mov_b32 s93, s92
    s_lshl_b32 s58, s58, 5
    s_mul_i32 s57, s49, 1536
    s_add_u32 s57, s57, 147968
    v_lshl_add_u32 v56, v56, 4, s57
    v_add_u32 v57, s58, v56
    s_mov_b32 s32, s10
    s_and_b32 s33, s11, 0xffff
    s_mov_b32 s34, 663552
    s_mov_b32 s35, 0x00020000
    s_mov_b32 s36, s20
    s_and_b32 s37, s21, 0xffff
    s_mov_b32 s38, 663552
    s_mov_b32 s39, 0x00020000
    s_mov_b32 s40, s24
    s_and_b32 s41, s25, 0xffff
    s_mov_b32 s42, 2359296
    s_mov_b32 s43, 0x00020000
    s_xor_b32 s58, s49, 0
    s_lshl_b32 s80, s51, 2
    s_add_u32 s80, s80, s58
    s_and_b32 s58, s2, 7
    s_lshl_b32 s82, s58, 2
    s_bfe_u32 s59, s2, 0x20003
    s_or_b32 s82, s82, s59
    s_lshl_b32 s13, s58, 1
    s_and_b32 s59, s59, 1
    s_or_b32 s13, s13, s59
    s_lshl_b32 s12, s13, 2
    s_add_u32 s12, s12, s49
    s_lshr_b32 s81, s2, 4
    s_and_b32 s58, s49, 1
    s_lshl_b32 s86, s52, 1
    s_add_u32 s86, s86, s58
    s_lshl_b32 s85, s12, 4
    s_add_u32 s85, s85, s81
    s_mul_i32 s85, s85, 3328
    s_add_u32 s85, s85, 196608
    s_mul_i32 s89, s52, 144
    s_add_u32 s58, s52, s48
    s_and_b32 s30, s58, 3
    s_bfe_u32 s31, s58, 0x10002
    s_lshl_b32 s90, s82, 1
    s_add_u32 s90, s90, s31
    s_lshl_b32 s90, s90, 3
    s_add_u32 s90, s90, s30
    s_mul_i32 s90, s90, 12288
    s_add_u32 s90, s90, 5603328
    v_mov_b32 v2, 0xdddd
    v_add_u32 v3, 0, v18
    v_lshlrev_b32 v4, 2, v7
    v_add_u32 v4, 1024, v4
    v_mul_u32_u24 v58, 304, v6
    v_lshl_add_u32 v5, v7, 4, v58
    v_add_u32 v5, 1152, v5
    v_cmp_gt_u32 vcc, 19, v7
    v_mov_b32 v29, 0x3f803f80
    v_mov_b32 v31, 0x3f803f80
    v_cndmask_b32 v5, v59, v5, vcc
    v_cndmask_b32 v253, 0, 1, vcc
    v_lshl_add_u32 v0, v32, 1, v6
    v_mul_u32_u24 v0, 288, v0
    v_lshl_add_u32 v0, v33, 3, v0
    s_lshl_b32 s101, s80, 4
    s_add_u32 s101, s101, s86
    s_mul_i32 s101, s101, 3328
    s_add_u32 s101, s101, 196608
    v_lshlrev_b32 v25, 3, v7
    s_and_b32 s60, s49, 1
    s_xor_b32 s58, s49, 0
    s_lshl_b32 s58, s58, 5
    v_add_u32 v58, s58, v7
    s_mul_i32 s58, s60, 10240
    s_add_u32 s58, s58, 143360
    v_mad_u32_u24 v60, v58, 40, s58
    v_lshl_add_u32 v228, v6, 3, v60
    s_movk_i32 s59, 5120
    v_mad_u32_u24 v229, v6, s59, v60
    v_lshl_add_u32 v58, v58, 1, v6
    s_mul_i32 s58, s60, 20480
    s_add_u32 s58, s58, 102400
    v_mad_u32_u24 v230, v58, 40, s58
    v_lshl_add_u32 v58, v6, 3, v32
    v_and_b32 v60, 1, v33
    v_lshl_add_u32 v60, v58, 1, v60
    s_mul_i32 s58, s49, 10240
    s_add_u32 s58, s58, 102400
    v_mad_u32_u24 v232, v60, 40, s58
    v_lshrrev_b32 v60, 1, v33
    v_cmp_gt_u32 vcc, 6, v33
    v_lshl_add_u32 v232, v60, 3, v232
    s_mul_i32 s58, s49, 5120
    s_add_u32 s58, s58, 143360
    v_cndmask_b32 v232, v59, v232, vcc
    v_mad_u32_u24 v233, v58, 40, s58
    v_min_u32 v60, 4, v33
    v_lshl_add_u32 v233, v60, 3, v233
    s_lshl_b32 s55, s52, 2
    s_add_u32 s55, s55, s49
    s_lshl_b32 s55, s55, 4
    s_add_u32 s55, s55, s51
    s_mul_i32 s55, s55, 3712
    s_add_u32 s55, s55, 3604480
    v_mad_u32_u24 v239, v6, 19, v7
    v_lshlrev_b32 v239, 4, v239
    v_lshlrev_b32 v58, 3, v62
    v_cndmask_b32 v58, v58, 40, s[78:79]
    v_mad_u32_u24 v58, v32, 48, v58
    s_mul_i32 s59, s60, 1728
    s_add_u32 s59, s59, 159744
    v_add_u32 v27, s59, v58
    v_mul_u32_u24 v60, 192, v6
    v_add_u32 v30, v27, v60
    s_lshl_b32 s58, s49, 12
    s_add_u32 s58, s58, 53248
    v_add_u32 v224, s58, v18
    s_xor_b32 s58, s49, 0
    s_lshl_b32 s58, s58, 10
    s_add_u32 s58, s58, 69632
    v_add_u32 v225, s58, v18
    s_add_u32 s58, s58, 77312
    v_lshl_add_u32 v226, v7, 2, s58
    v_mov_b32 v62, 0x3fb8aa3b
    v_mov_b32 v63, 0xbfb8aa3b
    v_mov_b32 v61, 156160
    s_cmp_eq_u32 s53, 0
    s_cselect_b32 s94, 0x3eae1a93, 1.0
    s_mov_b32 s95, s94
    s_bfe_u32 s59, s2, 0x20003
    s_mul_i32 s97, s59, 37888
    s_lshl_b32 s88, s49, 10
    s_add_u32 s88, s88, 53248
    s_add_u32 s97, s97, s88
    s_sub_u32 s60, s97, 151552
    s_min_u32 s97, s97, s60
    s_waitcnt vmcnt(0) lgkmcnt(0)
    ds_read_b128 v[64:67], v34 offset:0
    ds_read_b64_tr_b16 v[68:69], v38 offset:0
    ds_read_b64_tr_b16 v[70:71], v38 offset:192
    ds_read_b128 v[72:75], v35 offset:0
    ds_read_b64_tr_b16 v[76:77], v38 offset:768
    ds_read_b64_tr_b16 v[78:79], v38 offset:960
    ds_read_b128 v[80:83], v36 offset:0
    ds_read_b64_tr_b16 v[84:85], v38 offset:1536
    ds_read_b64_tr_b16 v[86:87], v38 offset:1728
    ds_read_b128 v[88:91], v37 offset:0
    ds_read_b64_tr_b16 v[92:93], v38 offset:2304
    ds_read_b64_tr_b16 v[94:95], v38 offset:2496
    ds_read_b128 v[96:99], v34 offset:2048
    ds_read_b64_tr_b16 v[100:101], v38 offset:3072
    ds_read_b64_tr_b16 v[102:103], v38 offset:3264
    ds_read_b128 v[104:107], v35 offset:2048
    ds_read_b64_tr_b16 v[108:109], v38 offset:3840
    ds_read_b64_tr_b16 v[110:111], v38 offset:4032
    ds_read_b128 v[112:115], v36 offset:2048
    ds_read_b64_tr_b16 v[116:117], v38 offset:4608
    ds_read_b64_tr_b16 v[118:119], v38 offset:4800
    ds_read_b128 v[120:123], v37 offset:2048
    ds_read_b64_tr_b16 v[124:125], v38 offset:5376
    ds_read_b64_tr_b16 v[126:127], v38 offset:5568
    s_cmp_lg_u32 s48, 3
    s_cbranch_scc1 L_g_6
    ds_read_b128 v[128:131], v34 offset:4096
    ds_read_b64_tr_b16 v[132:133], v38 offset:6144
    ds_read_b64_tr_b16 v[134:135], v38 offset:6336
    ds_read_b128 v[136:139], v35 offset:4096
    ds_read_b64_tr_b16 v[140:141], v38 offset:6912
    ds_read_b64_tr_b16 v[142:143], v38 offset:7104
    ds_read_b128 v[144:147], v36 offset:4096
    ds_read_b64_tr_b16 v[148:149], v38 offset:7680
    ds_read_b64_tr_b16 v[150:151], v38 offset:7872
    ds_read_b128 v[152:155], v37 offset:4096
    ds_read_b64_tr_b16 v[156:157], v38 offset:8448
    ds_read_b64_tr_b16 v[158:159], v38 offset:8640
L_g_6:
    s_mul_i32 s83, s83, 0x9e3779b1
    s_add_u32 s83, s83, 0x7f4a7c15
    s_and_b32 s61, s83, 0xbfffbfff
    v_mov_b32 v252, s61
    s_cmp_lg_u32 s53, 0
    s_cbranch_scc1 L_mv_7
    s_waitcnt lgkmcnt(15)
    v_mfma_f32_32x32x16_bf16 v[40:55], v[68:71], v[64:67], 0
    s_waitcnt lgkmcnt(15)
    v_mfma_f32_32x32x16_bf16 v[40:55], v[76:79], v[72:75], v[40:55]
    s_waitcnt lgkmcnt(15)
    v_mfma_f32_32x32x16_bf16 v[40:55], v[84:87], v[80:83], v[40:55]
    s_waitcnt lgkmcnt(12)
    v_mfma_f32_32x32x16_bf16 v[40:55], v[92:95], v[88:91], v[40:55]
    s_waitcnt lgkmcnt(9)
    v_mfma_f32_32x32x16_bf16 v[40:55], v[100:103], v[96:99], v[40:55]
    s_waitcnt lgkmcnt(6)
    v_mfma_f32_32x32x16_bf16 v[40:55], v[108:111], v[104:107], v[40:55]
    s_waitcnt lgkmcnt(3)
    v_mfma_f32_32x32x16_bf16 v[40:55], v[116:119], v[112:115], v[40:55]
    s_waitcnt lgkmcnt(0)
    v_mfma_f32_32x32x16_bf16 v[40:55], v[124:127], v[120:123], v[40:55]
    s_cmp_lg_u32 s48, 3
    s_cbranch_scc1 L_mc_8
    v_mfma_f32_32x32x16_bf16 v[40:55], v[132:135], v[128:131], v[40:55]
    v_mfma_f32_32x32x16_bf16 v[40:55], v[140:143], v[136:139], v[40:55]
    v_mfma_f32_32x32x16_bf16 v[40:55], v[148:151], v[144:147], v[40:55]
    v_mfma_f32_32x32x16_bf16 v[40:55], v[156:159], v[152:155], v[40:55]
    s_branch L_mc_8
L_mv_7:
    s_waitcnt lgkmcnt(15)
    v_mfma_f32_32x32x16_bf16 v[40:55], v[64:67], v[68:71], 0
    s_waitcnt lgkmcnt(15)
    v_mfma_f32_32x32x16_bf16 v[40:55], v[72:75], v[76:79], v[40:55]
    s_waitcnt lgkmcnt(15)
    v_mfma_f32_32x32x16_bf16 v[40:55], v[80:83], v[84:87], v[40:55]
    s_waitcnt lgkmcnt(12)
    v_mfma_f32_32x32x16_bf16 v[40:55], v[88:91], v[92:95], v[40:55]
    s_waitcnt lgkmcnt(9)
    v_mfma_f32_32x32x16_bf16 v[40:55], v[96:99], v[100:103], v[40:55]
    s_waitcnt lgkmcnt(6)
    v_mfma_f32_32x32x16_bf16 v[40:55], v[104:107], v[108:111], v[40:55]
    s_waitcnt lgkmcnt(3)
    v_mfma_f32_32x32x16_bf16 v[40:55], v[112:115], v[116:119], v[40:55]
    s_waitcnt lgkmcnt(0)
    v_mfma_f32_32x32x16_bf16 v[40:55], v[120:123], v[124:127], v[40:55]
    s_cmp_lg_u32 s48, 3
    s_cbranch_scc1 L_mc_8
    v_mfma_f32_32x32x16_bf16 v[40:55], v[128:131], v[132:135], v[40:55]
    v_mfma_f32_32x32x16_bf16 v[40:55], v[136:139], v[140:143], v[40:55]
    v_mfma_f32_32x32x16_bf16 v[40:55], v[144:147], v[148:151], v[40:55]
    v_mfma_f32_32x32x16_bf16 v[40:55], v[152:155], v[156:159], v[40:55]
L_mc_8:
    s_nop 10
    s_mov_b64 exec, s[92:93]
    ds_write_b128 v56, v[40:43]
    ds_write_b128 v57, v[44:47]
    s_cmp_lg_u32 s53, 0
    s_cbranch_scc1 L_g_9
    ds_write_b128 v56, v[48:51] offset:1024
L_g_9:
    s_mov_b64 exec, -1
    s_lshl_b32 s57, s87, 13
    s_sub_u32 s57, 4096, s57
    v_add_u32 v144, s57, v8
    v_add_u32 v145, s57, v9
    v_add_u32 v146, s57, v10
    v_add_u32 v147, s57, v11
    v_add_u32 v148, s57, v12
    v_add_u32 v149, s57, v13
    v_add_u32 v150, s57, v14
    v_add_u32 v151, s57, v15
    s_lshl_b32 s57, s54, 7
    v_add_u32 v28, s57, v26
    s_add_u32 s54, s54, 1
    s_cmp_eq_u32 s54, 9
    s_cselect_b32 s54, 0, s54
    s_waitcnt lgkmcnt(0)
    s_barrier
    ds_read_b128 v[160:163], v12 offset:36992
    ds_read_b128 v[164:167], v148 offset:36992
    ds_read_b64_tr_b16 v[168:169], v21 offset:36992
    ds_read_b64_tr_b16 v[170:171], v21 offset:37632
    ds_read_b64_tr_b16 v[172:173], v21 offset:37032
    ds_read_b64_tr_b16 v[174:175], v21 offset:37672
    ds_read_b64_tr_b16 v[176:177], v23 offset:37024
    ds_read_b64_tr_b16 v[178:179], v23 offset:37664
    s_mov_b64 exec, s[72:73]
    ds_read_b128 v[176:179], v28 offset:0
    s_mov_b64 exec, -1
    ds_read_b128 v[180:183], v13 offset:36992
    ds_read_b128 v[184:187], v149 offset:36992
    ds_read_b64_tr_b16 v[188:189], v21 offset:39552
    ds_read_b64_tr_b16 v[190:191], v21 offset:40192
    ds_read_b64_tr_b16 v[192:193], v21 offset:39592
    ds_read_b64_tr_b16 v[194:195], v21 offset:40232
    ds_read_b64_tr_b16 v[196:197], v23 offset:39584
    ds_read_b64_tr_b16 v[198:199], v23 offset:40224
    s_mov_b64 exec, s[72:73]
    ds_read_b128 v[196:199], v28 offset:32
    s_mov_b64 exec, -1
    s_waitcnt lgkmcnt(9)
    v_mfma_f32_32x32x16_bf16 v[128:143], v[176:179], v[160:163], 0
    ds_read_b128 v[200:203], v14 offset:36992
    ds_read_b128 v[204:207], v150 offset:36992
    v_mfma_f32_32x32x16_bf16 v[96:111], v[168:171], v[164:167], 0
    ds_read_b64_tr_b16 v[208:209], v21 offset:42112
    ds_read_b64_tr_b16 v[210:211], v21 offset:42752
    v_mfma_f32_32x32x16_bf16 v[112:127], v[172:175], v[164:167], 0
    ds_read_b64_tr_b16 v[212:213], v21 offset:42152
    ds_read_b64_tr_b16 v[214:215], v21 offset:42792
    v_mfma_f32_32x32x16_bf16 v[64:79], v[168:171], v[160:163], 0
    ds_read_b64_tr_b16 v[216:217], v23 offset:42144
    ds_read_b64_tr_b16 v[218:219], v23 offset:42784
    v_mfma_f32_32x32x16_bf16 v[80:95], v[172:175], v[160:163], 0
    s_mov_b64 exec, s[72:73]
    ds_read_b128 v[216:219], v28 offset:64
    s_mov_b64 exec, -1
    s_waitcnt lgkmcnt(9)
    v_mfma_f32_32x32x16_bf16 v[128:143], v[196:199], v[180:183], v[128:143]
    ds_read_b128 v[160:163], v15 offset:36992
    ds_read_b128 v[164:167], v151 offset:36992
    v_mfma_f32_32x32x16_bf16 v[96:111], v[188:191], v[184:187], v[96:111]
    ds_read_b64_tr_b16 v[168:169], v21 offset:44672
    ds_read_b64_tr_b16 v[170:171], v21 offset:45312
    v_mfma_f32_32x32x16_bf16 v[112:127], v[192:195], v[184:187], v[112:127]
    ds_read_b64_tr_b16 v[172:173], v21 offset:44712
    ds_read_b64_tr_b16 v[174:175], v21 offset:45352
    v_mfma_f32_32x32x16_bf16 v[64:79], v[188:191], v[180:183], v[64:79]
    ds_read_b64_tr_b16 v[176:177], v23 offset:44704
    ds_read_b64_tr_b16 v[178:179], v23 offset:45344
    v_mfma_f32_32x32x16_bf16 v[80:95], v[192:195], v[180:183], v[80:95]
    s_mov_b64 exec, s[72:73]
    ds_read_b128 v[176:179], v28 offset:96
    s_mov_b64 exec, -1
    s_waitcnt lgkmcnt(9)
    v_mfma_f32_32x32x16_bf16 v[128:143], v[216:219], v[200:203], v[128:143]
    s_lshl_b32 s57, s54, 7
    v_add_u32 v28, s57, v26
    s_add_u32 s54, s54, 1
    s_cmp_eq_u32 s54, 9
    s_cselect_b32 s54, 0, s54
    s_barrier
    ds_read_b128 v[180:183], v8 offset:0
    ds_read_b128 v[184:187], v144 offset:0
    v_mfma_f32_32x32x16_bf16 v[96:111], v[208:211], v[204:207], v[96:111]
    ds_read_b64_tr_b16 v[188:189], v20 offset:0
    ds_read_b64_tr_b16 v[190:191], v20 offset:640
    v_mfma_f32_32x32x16_bf16 v[112:127], v[212:215], v[204:207], v[112:127]
    ds_read_b64_tr_b16 v[192:193], v20 offset:40
    ds_read_b64_tr_b16 v[194:195], v20 offset:680
    v_mfma_f32_32x32x16_bf16 v[64:79], v[208:211], v[200:203], v[64:79]
    ds_read_b64_tr_b16 v[196:197], v22 offset:32
    ds_read_b64_tr_b16 v[198:199], v22 offset:672
    v_mfma_f32_32x32x16_bf16 v[80:95], v[212:215], v[200:203], v[80:95]
    s_mov_b64 exec, s[72:73]
    ds_read_b128 v[196:199], v28 offset:0
    s_mov_b64 exec, -1
    s_waitcnt lgkmcnt(9)
    v_mfma_f32_32x32x16_bf16 v[128:143], v[176:179], v[160:163], v[128:143]
    ds_read_b128 v[200:203], v9 offset:0
    ds_read_b128 v[204:207], v145 offset:0
    v_mfma_f32_32x32x16_bf16 v[96:111], v[168:171], v[164:167], v[96:111]
    ds_read_b64_tr_b16 v[208:209], v20 offset:2560
    ds_read_b64_tr_b16 v[210:211], v20 offset:3200
    v_mfma_f32_32x32x16_bf16 v[112:127], v[172:175], v[164:167], v[112:127]
    ds_read_b64_tr_b16 v[212:213], v20 offset:2600
    ds_read_b64_tr_b16 v[214:215], v20 offset:3240
    v_mfma_f32_32x32x16_bf16 v[64:79], v[168:171], v[160:163], v[64:79]
    ds_read_b64_tr_b16 v[216:217], v22 offset:2592
    ds_read_b64_tr_b16 v[218:219], v22 offset:3232
    v_mfma_f32_32x32x16_bf16 v[80:95], v[172:175], v[160:163], v[80:95]
    s_mov_b64 exec, s[72:73]
    ds_read_b128 v[216:219], v28 offset:32
    s_mov_b64 exec, -1
    s_waitcnt lgkmcnt(9)
    v_mfma_f32_32x32x16_bf16 v[128:143], v[196:199], v[180:183], v[128:143]
    ds_read_b128 v[160:163], v10 offset:0
    ds_read_b128 v[164:167], v146 offset:0
    v_mfma_f32_32x32x16_bf16 v[96:111], v[188:191], v[184:187], v[96:111]
    ds_read_b64_tr_b16 v[168:169], v20 offset:5120
    ds_read_b64_tr_b16 v[170:171], v20 offset:5760
    v_mfma_f32_32x32x16_bf16 v[112:127], v[192:195], v[184:187], v[112:127]
    ds_read_b64_tr_b16 v[172:173], v20 offset:5160
    ds_read_b64_tr_b16 v[174:175], v20 offset:5800
    v_mfma_f32_32x32x16_bf16 v[64:79], v[188:191], v[180:183], v[64:79]
    ds_read_b64_tr_b16 v[176:177], v22 offset:5152
    ds_read_b64_tr_b16 v[178:179], v22 offset:5792
    v_mfma_f32_32x32x16_bf16 v[80:95], v[192:195], v[180:183], v[80:95]
    s_mov_b64 exec, s[72:73]
    ds_read_b128 v[176:179], v28 offset:64
    s_mov_b64 exec, -1
    s_waitcnt lgkmcnt(9)
    v_mfma_f32_32x32x16_bf16 v[128:143], v[216:219], v[200:203], v[128:143]
    ds_read_b128 v[180:183], v11 offset:0
    ds_read_b128 v[184:187], v147 offset:0
    v_mfma_f32_32x32x16_bf16 v[96:111], v[208:211], v[204:207], v[96:111]
    ds_read_b64_tr_b16 v[188:189], v20 offset:7680
    ds_read_b64_tr_b16 v[190:191], v20 offset:8320
    v_mfma_f32_32x32x16_bf16 v[112:127], v[212:215], v[204:207], v[112:127]
    ds_read_b64_tr_b16 v[192:193], v20 offset:7720
    ds_read_b64_tr_b16 v[194:195], v20 offset:8360
    v_mfma_f32_32x32x16_bf16 v[64:79], v[208:211], v[200:203], v[64:79]
    ds_read_b64_tr_b16 v[196:197], v22 offset:7712
    ds_read_b64_tr_b16 v[198:199], v22 offset:8352
    v_mfma_f32_32x32x16_bf16 v[80:95], v[212:215], v[200:203], v[80:95]
    s_mov_b64 exec, s[72:73]
    ds_read_b128 v[196:199], v28 offset:96
    s_mov_b64 exec, -1
    s_waitcnt lgkmcnt(9)
    v_mfma_f32_32x32x16_bf16 v[128:143], v[176:179], v[160:163], v[128:143]
    s_lshl_b32 s57, s54, 7
    v_add_u32 v28, s57, v26
    s_add_u32 s54, s54, 1
    s_cmp_eq_u32 s54, 9
    s_cselect_b32 s54, 0, s54
    s_barrier
    ds_read_b128 v[200:203], v8 offset:36992
    ds_read_b128 v[204:207], v144 offset:36992
    v_mfma_f32_32x32x16_bf16 v[96:111], v[168:171], v[164:167], v[96:111]
    ds_read_b64_tr_b16 v[208:209], v20 offset:36992
    ds_read_b64_tr_b16 v[210:211], v20 offset:37632
    v_mfma_f32_32x32x16_bf16 v[112:127], v[172:175], v[164:167], v[112:127]
    ds_read_b64_tr_b16 v[212:213], v20 offset:37032
    ds_read_b64_tr_b16 v[214:215], v20 offset:37672
    v_mfma_f32_32x32x16_bf16 v[64:79], v[168:171], v[160:163], v[64:79]
    ds_read_b64_tr_b16 v[216:217], v22 offset:37024
    ds_read_b64_tr_b16 v[218:219], v22 offset:37664
    v_mfma_f32_32x32x16_bf16 v[80:95], v[172:175], v[160:163], v[80:95]
    s_mov_b64 exec, s[72:73]
    ds_read_b128 v[216:219], v28 offset:0
    s_mov_b64 exec, -1
    s_waitcnt lgkmcnt(9)
    v_mfma_f32_32x32x16_bf16 v[128:143], v[196:199], v[180:183], v[128:143]
    ds_read_b128 v[160:163], v9 offset:36992
    ds_read_b128 v[164:167], v145 offset:36992
    v_mfma_f32_32x32x16_bf16 v[96:111], v[188:191], v[184:187], v[96:111]
    ds_read_b64_tr_b16 v[168:169], v20 offset:39552
    ds_read_b64_tr_b16 v[170:171], v20 offset:40192
    v_mfma_f32_32x32x16_bf16 v[112:127], v[192:195], v[184:187], v[112:127]
    ds_read_b64_tr_b16 v[172:173], v20 offset:39592
    ds_read_b64_tr_b16 v[174:175], v20 offset:40232
    v_mfma_f32_32x32x16_bf16 v[64:79], v[188:191], v[180:183], v[64:79]
    ds_read_b64_tr_b16 v[176:177], v22 offset:39584
    ds_read_b64_tr_b16 v[178:179], v22 offset:40224
    v_mfma_f32_32x32x16_bf16 v[80:95], v[192:195], v[180:183], v[80:95]
    s_mov_b64 exec, s[72:73]
    ds_read_b128 v[176:179], v28 offset:32
    s_mov_b64 exec, -1
    s_waitcnt lgkmcnt(9)
    v_mfma_f32_32x32x16_bf16 v[128:143], v[216:219], v[200:203], v[128:143]
    ds_read_b128 v[180:183], v10 offset:36992
    ds_read_b128 v[184:187], v146 offset:36992
    v_mfma_f32_32x32x16_bf16 v[96:111], v[208:211], v[204:207], v[96:111]
    ds_read_b64_tr_b16 v[188:189], v20 offset:42112
    ds_read_b64_tr_b16 v[190:191], v20 offset:42752
    v_mfma_f32_32x32x16_bf16 v[112:127], v[212:215], v[204:207], v[112:127]
    ds_read_b64_tr_b16 v[192:193], v20 offset:42152
    ds_read_b64_tr_b16 v[194:195], v20 offset:42792
    v_mfma_f32_32x32x16_bf16 v[64:79], v[208:211], v[200:203], v[64:79]
    ds_read_b64_tr_b16 v[196:197], v22 offset:42144
    ds_read_b64_tr_b16 v[198:199], v22 offset:42784
    v_mfma_f32_32x32x16_bf16 v[80:95], v[212:215], v[200:203], v[80:95]
    s_mov_b64 exec, s[72:73]
    ds_read_b128 v[196:199], v28 offset:64
    s_mov_b64 exec, -1
    s_waitcnt lgkmcnt(9)
    v_mfma_f32_32x32x16_bf16 v[128:143], v[176:179], v[160:163], v[128:143]
    ds_read_b128 v[200:203], v11 offset:36992
    ds_read_b128 v[204:207], v147 offset:36992
    v_mfma_f32_32x32x16_bf16 v[96:111], v[168:171], v[164:167], v[96:111]
    ds_read_b64_tr_b16 v[208:209], v20 offset:44672
    ds_read_b64_tr_b16 v[210:211], v20 offset:45312
    v_mfma_f32_32x32x16_bf16 v[112:127], v[172:175], v[164:167], v[112:127]
    ds_read_b64_tr_b16 v[212:213], v20 offset:44712
    ds_read_b64_tr_b16 v[214:215], v20 offset:45352
    v_mfma_f32_32x32x16_bf16 v[64:79], v[168:171], v[160:163], v[64:79]
    ds_read_b64_tr_b16 v[216:217], v22 offset:44704
    ds_read_b64_tr_b16 v[218:219], v22 offset:45344
    v_mfma_f32_32x32x16_bf16 v[80:95], v[172:175], v[160:163], v[80:95]
    s_mov_b64 exec, s[72:73]
    ds_read_b128 v[216:219], v28 offset:96
    s_mov_b64 exec, -1
    s_waitcnt lgkmcnt(9)
    v_mfma_f32_32x32x16_bf16 v[128:143], v[196:199], v[180:183], v[128:143]
    s_lshl_b32 s57, s54, 7
    v_add_u32 v28, s57, v26
    s_add_u32 s54, s54, 1
    s_cmp_eq_u32 s54, 9
    s_cselect_b32 s54, 0, s54
    s_barrier
    ds_read_b128 v[160:163], v12 offset:0
    ds_read_b128 v[164:167], v148 offset:0
    v_mfma_f32_32x32x16_bf16 v[96:111], v[188:191], v[184:187], v[96:111]
    ds_read_b64_tr_b16 v[168:169], v21 offset:0
    ds_read_b64_tr_b16 v[170:171], v21 offset:640
    v_mfma_f32_32x32x16_bf16 v[112:127], v[192:195], v[184:187], v[112:127]
    ds_read_b64_tr_b16 v[172:173], v21 offset:40
    ds_read_b64_tr_b16 v[174:175], v21 offset:680
    v_mfma_f32_32x32x16_bf16 v[64:79], v[188:191], v[180:183], v[64:79]
    ds_read_b64_tr_b16 v[176:177], v23 offset:32
    ds_read_b64_tr_b16 v[178:179], v23 offset:672
    v_mfma_f32_32x32x16_bf16 v[80:95], v[192:195], v[180:183], v[80:95]
    s_mov_b64 exec, s[72:73]
    ds_read_b128 v[176:179], v28 offset:0
    s_mov_b64 exec, -1
    s_waitcnt lgkmcnt(9)
    v_mfma_f32_32x32x16_bf16 v[128:143], v[216:219], v[200:203], v[128:143]
    ds_read_b128 v[180:183], v13 offset:0
    ds_read_b128 v[184:187], v149 offset:0
    v_mfma_f32_32x32x16_bf16 v[96:111], v[208:211], v[204:207], v[96:111]
    ds_read_b64_tr_b16 v[188:189], v21 offset:2560
    ds_read_b64_tr_b16 v[190:191], v21 offset:3200
    v_mfma_f32_32x32x16_bf16 v[112:127], v[212:215], v[204:207], v[112:127]
    ds_read_b64_tr_b16 v[192:193], v21 offset:2600
    ds_read_b64_tr_b16 v[194:195], v21 offset:3240
    v_mfma_f32_32x32x16_bf16 v[64:79], v[208:211], v[200:203], v[64:79]
    ds_read_b64_tr_b16 v[196:197], v23 offset:2592
    ds_read_b64_tr_b16 v[198:199], v23 offset:3232
    v_mfma_f32_32x32x16_bf16 v[80:95], v[212:215], v[200:203], v[80:95]
    s_mov_b64 exec, s[72:73]
    ds_read_b128 v[196:199], v28 offset:32
    s_mov_b64 exec, -1
    s_waitcnt lgkmcnt(9)
    v_mfma_f32_32x32x16_bf16 v[128:143], v[176:179], v[160:163], v[128:143]
    ds_read_b128 v[200:203], v14 offset:0
    ds_read_b128 v[204:207], v150 offset:0
    v_mfma_f32_32x32x16_bf16 v[96:111], v[168:171], v[164:167], v[96:111]
    ds_read_b64_tr_b16 v[208:209], v21 offset:5120
    ds_read_b64_tr_b16 v[210:211], v21 offset:5760
    v_mfma_f32_32x32x16_bf16 v[112:127], v[172:175], v[164:167], v[112:127]
    ds_read_b64_tr_b16 v[212:213], v21 offset:5160
    ds_read_b64_tr_b16 v[214:215], v21 offset:5800
    v_mfma_f32_32x32x16_bf16 v[64:79], v[168:171], v[160:163], v[64:79]
    ds_read_b64_tr_b16 v[216:217], v23 offset:5152
    ds_read_b64_tr_b16 v[218:219], v23 offset:5792
    v_mfma_f32_32x32x16_bf16 v[80:95], v[172:175], v[160:163], v[80:95]
    s_mov_b64 exec, s[72:73]
    ds_read_b128 v[216:219], v28 offset:64
    s_mov_b64 exec, -1
    s_waitcnt lgkmcnt(9)
    v_mfma_f32_32x32x16_bf16 v[128:143], v[196:199], v[180:183], v[128:143]
    ds_read_b128 v[160:163], v15 offset:0
    ds_read_b128 v[164:167], v151 offset:0
    v_mfma_f32_32x32x16_bf16 v[96:111], v[188:191], v[184:187], v[96:111]
    ds_read_b64_tr_b16 v[168:169], v21 offset:7680
    ds_read_b64_tr_b16 v[170:171], v21 offset:8320
    v_mfma_f32_32x32x16_bf16 v[112:127], v[192:195], v[184:187], v[112:127]
    ds_read_b64_tr_b16 v[172:173], v21 offset:7720
    ds_read_b64_tr_b16 v[174:175], v21 offset:8360
    v_mfma_f32_32x32x16_bf16 v[64:79], v[188:191], v[180:183], v[64:79]
    ds_read_b64_tr_b16 v[176:177], v23 offset:7712
    ds_read_b64_tr_b16 v[178:179], v23 offset:8352
    v_mfma_f32_32x32x16_bf16 v[80:95], v[192:195], v[180:183], v[80:95]
    s_mov_b64 exec, s[72:73]
    ds_read_b128 v[176:179], v28 offset:96
    s_mov_b64 exec, -1
    s_waitcnt lgkmcnt(9)
    v_mfma_f32_32x32x16_bf16 v[128:143], v[216:219], v[200:203], v[128:143]
    s_lshl_b32 s57, s54, 7
    v_add_u32 v28, s57, v26
    s_add_u32 s54, s54, 1
    s_cmp_eq_u32 s54, 9
    s_cselect_b32 s54, 0, s54
    s_barrier
    ds_read_b128 v[180:183], v12 offset:36992
    ds_read_b128 v[184:187], v148 offset:36992
    v_mfma_f32_32x32x16_bf16 v[96:111], v[208:211], v[204:207], v[96:111]
    ds_read_b64_tr_b16 v[188:189], v21 offset:36992
    ds_read_b64_tr_b16 v[190:191], v21 offset:37632
    v_mfma_f32_32x32x16_bf16 v[112:127], v[212:215], v[204:207], v[112:127]
    ds_read_b64_tr_b16 v[192:193], v21 offset:37032
    ds_read_b64_tr_b16 v[194:195], v21 offset:37672
    v_mfma_f32_32x32x16_bf16 v[64:79], v[208:211], v[200:203], v[64:79]
    ds_read_b64_tr_b16 v[196:197], v23 offset:37024
    ds_read_b64_tr_b16 v[198:199], v23 offset:37664
    v_mfma_f32_32x32x16_bf16 v[80:95], v[212:215], v[200:203], v[80:95]
    s_mov_b64 exec, s[72:73]
    ds_read_b128 v[196:199], v28 offset:0
    s_mov_b64 exec, -1
    s_waitcnt lgkmcnt(9)
    v_mfma_f32_32x32x16_bf16 v[128:143], v[176:179], v[160:163], v[128:143]
    ds_read_b128 v[200:203], v13 offset:36992
    ds_read_b128 v[204:207], v149 offset:36992
    v_mfma_f32_32x32x16_bf16 v[96:111], v[168:171], v[164:167], v[96:111]
    ds_read_b64_tr_b16 v[208:209], v21 offset:39552
    ds_read_b64_tr_b16 v[210:211], v21 offset:40192
    v_mfma_f32_32x32x16_bf16 v[112:127], v[172:175], v[164:167], v[112:127]
    ds_read_b64_tr_b16 v[212:213], v21 offset:39592
    ds_read_b64_tr_b16 v[214:215], v21 offset:40232
    v_mfma_f32_32x32x16_bf16 v[64:79], v[168:171], v[160:163], v[64:79]
    ds_read_b64_tr_b16 v[216:217], v23 offset:39584
    ds_read_b64_tr_b16 v[218:219], v23 offset:40224
    v_mfma_f32_32x32x16_bf16 v[80:95], v[172:175], v[160:163], v[80:95]
    s_mov_b64 exec, s[72:73]
    ds_read_b128 v[216:219], v28 offset:32
    s_mov_b64 exec, -1
    s_waitcnt lgkmcnt(9)
    v_mfma_f32_32x32x16_bf16 v[128:143], v[196:199], v[180:183], v[128:143]
    ds_read_b128 v[160:163], v14 offset:36992
    ds_read_b128 v[164:167], v150 offset:36992
    v_mfma_f32_32x32x16_bf16 v[96:111], v[188:191], v[184:187], v[96:111]
    ds_read_b64_tr_b16 v[168:169], v21 offset:42112
    ds_read_b64_tr_b16 v[170:171], v21 offset:42752
    v_mfma_f32_32x32x16_bf16 v[112:127], v[192:195], v[184:187], v[112:127]
    ds_read_b64_tr_b16 v[172:173], v21 offset:42152
    ds_read_b64_tr_b16 v[174:175], v21 offset:42792
    v_mfma_f32_32x32x16_bf16 v[64:79], v[188:191], v[180:183], v[64:79]
    ds_read_b64_tr_b16 v[176:177], v23 offset:42144
    ds_read_b64_tr_b16 v[178:179], v23 offset:42784
    v_mfma_f32_32x32x16_bf16 v[80:95], v[192:195], v[180:183], v[80:95]
    s_mov_b64 exec, s[72:73]
    ds_read_b128 v[176:179], v28 offset:64
    s_mov_b64 exec, -1
    s_waitcnt lgkmcnt(9)
    v_mfma_f32_32x32x16_bf16 v[128:143], v[216:219], v[200:203], v[128:143]
    ds_read_b128 v[180:183], v15 offset:36992
    ds_read_b128 v[184:187], v151 offset:36992
    v_mfma_f32_32x32x16_bf16 v[96:111], v[208:211], v[204:207], v[96:111]
    ds_read_b64_tr_b16 v[188:189], v21 offset:44672
    ds_read_b64_tr_b16 v[190:191], v21 offset:45312
    v_mfma_f32_32x32x16_bf16 v[112:127], v[212:215], v[204:207], v[112:127]
    ds_read_b64_tr_b16 v[192:193], v21 offset:44712
    ds_read_b64_tr_b16 v[194:195], v21 offset:45352
    v_mfma_f32_32x32x16_bf16 v[64:79], v[208:211], v[200:203], v[64:79]
    ds_read_b64_tr_b16 v[196:197], v23 offset:44704
    ds_read_b64_tr_b16 v[198:199], v23 offset:45344
    v_mfma_f32_32x32x16_bf16 v[80:95], v[212:215], v[200:203], v[80:95]
    s_mov_b64 exec, s[72:73]
    ds_read_b128 v[196:199], v28 offset:96
    s_mov_b64 exec, -1
    s_waitcnt lgkmcnt(9)
    v_mfma_f32_32x32x16_bf16 v[128:143], v[176:179], v[160:163], v[128:143]
    s_lshl_b32 s57, s54, 7
    v_add_u32 v28, s57, v26
    s_add_u32 s54, s54, 1
    s_cmp_eq_u32 s54, 9
    s_cselect_b32 s54, 0, s54
    s_barrier
    ds_read_b128 v[200:203], v8 offset:0
    ds_read_b128 v[204:207], v144 offset:0
    v_mfma_f32_32x32x16_bf16 v[96:111], v[168:171], v[164:167], v[96:111]
    ds_read_b64_tr_b16 v[208:209], v20 offset:0
    ds_read_b64_tr_b16 v[210:211], v20 offset:640
    v_mfma_f32_32x32x16_bf16 v[112:127], v[172:175], v[164:167], v[112:127]
    ds_read_b64_tr_b16 v[212:213], v20 offset:40
    ds_read_b64_tr_b16 v[214:215], v20 offset:680
    v_mfma_f32_32x32x16_bf16 v[64:79], v[168:171], v[160:163], v[64:79]
    ds_read_b64_tr_b16 v[216:217], v22 offset:32
    ds_read_b64_tr_b16 v[218:219], v22 offset:672
    v_mfma_f32_32x32x16_bf16 v[80:95], v[172:175], v[160:163], v[80:95]
    s_mov_b64 exec, s[72:73]
    ds_read_b128 v[216:219], v28 offset:0
    s_mov_b64 exec, -1
    s_waitcnt lgkmcnt(9)
    v_mfma_f32_32x32x16_bf16 v[128:143], v[196:199], v[180:183], v[128:143]
    ds_read_b128 v[160:163], v9 offset:0
    ds_read_b128 v[164:167], v145 offset:0
    v_mfma_f32_32x32x16_bf16 v[96:111], v[188:191], v[184:187], v[96:111]
    ds_read_b64_tr_b16 v[168:169], v20 offset:2560
    ds_read_b64_tr_b16 v[170:171], v20 offset:3200
    v_mfma_f32_32x32x16_bf16 v[112:127], v[192:195], v[184:187], v[112:127]
    ds_read_b64_tr_b16 v[172:173], v20 offset:2600
    ds_read_b64_tr_b16 v[174:175], v20 offset:3240
    v_mfma_f32_32x32x16_bf16 v[64:79], v[188:191], v[180:183], v[64:79]
    ds_read_b64_tr_b16 v[176:177], v22 offset:2592
    ds_read_b64_tr_b16 v[178:179], v22 offset:3232
    v_mfma_f32_32x32x16_bf16 v[80:95], v[192:195], v[180:183], v[80:95]
    s_mov_b64 exec, s[72:73]
    ds_read_b128 v[176:179], v28 offset:32
    s_mov_b64 exec, -1
    s_waitcnt lgkmcnt(9)
    v_mfma_f32_32x32x16_bf16 v[128:143], v[216:219], v[200:203], v[128:143]
    ds_read_b128 v[180:183], v10 offset:0
    ds_read_b128 v[184:187], v146 offset:0
    v_mfma_f32_32x32x16_bf16 v[96:111], v[208:211], v[204:207], v[96:111]
    ds_read_b64_tr_b16 v[188:189], v20 offset:5120
    ds_read_b64_tr_b16 v[190:191], v20 offset:5760
    v_mfma_f32_32x32x16_bf16 v[112:127], v[212:215], v[204:207], v[112:127]
    ds_read_b64_tr_b16 v[192:193], v20 offset:5160
    ds_read_b64_tr_b16 v[194:195], v20 offset:5800
    v_mfma_f32_32x32x16_bf16 v[64:79], v[208:211], v[200:203], v[64:79]
    ds_read_b64_tr_b16 v[196:197], v22 offset:5152
    ds_read_b64_tr_b16 v[198:199], v22 offset:5792
    v_mfma_f32_32x32x16_bf16 v[80:95], v[212:215], v[200:203], v[80:95]
    s_mov_b64 exec, s[72:73]
    ds_read_b128 v[196:199], v28 offset:64
    s_mov_b64 exec, -1
    s_waitcnt lgkmcnt(9)
    v_mfma_f32_32x32x16_bf16 v[128:143], v[176:179], v[160:163], v[128:143]
    ds_read_b128 v[200:203], v11 offset:0
    ds_read_b128 v[204:207], v147 offset:0
    v_mfma_f32_32x32x16_bf16 v[96:111], v[168:171], v[164:167], v[96:111]
    ds_read_b64_tr_b16 v[208:209], v20 offset:7680
    ds_read_b64_tr_b16 v[210:211], v20 offset:8320
    v_mfma_f32_32x32x16_bf16 v[112:127], v[172:175], v[164:167], v[112:127]
    ds_read_b64_tr_b16 v[212:213], v20 offset:7720
    ds_read_b64_tr_b16 v[214:215], v20 offset:8360
    v_mfma_f32_32x32x16_bf16 v[64:79], v[168:171], v[160:163], v[64:79]
    ds_read_b64_tr_b16 v[216:217], v22 offset:7712
    ds_read_b64_tr_b16 v[218:219], v22 offset:8352
    v_mfma_f32_32x32x16_bf16 v[80:95], v[172:175], v[160:163], v[80:95]
    s_mov_b64 exec, s[72:73]
    ds_read_b128 v[216:219], v28 offset:96
    s_mov_b64 exec, -1
    s_waitcnt lgkmcnt(9)
    v_mfma_f32_32x32x16_bf16 v[128:143], v[196:199], v[180:183], v[128:143]
    s_lshl_b32 s57, s54, 7
    v_add_u32 v28, s57, v26
    s_add_u32 s54, s54, 1
    s_cmp_eq_u32 s54, 9
    s_cselect_b32 s54, 0, s54
    s_barrier
    ds_read_b128 v[160:163], v8 offset:36992
    ds_read_b128 v[164:167], v144 offset:36992
    v_mfma_f32_32x32x16_bf16 v[96:111], v[188:191], v[184:187], v[96:111]
    ds_read_b64_tr_b16 v[168:169], v20 offset:36992
    ds_read_b64_tr_b16 v[170:171], v20 offset:37632
    v_mfma_f32_32x32x16_bf16 v[112:127], v[192:195], v[184:187], v[112:127]
    ds_read_b64_tr_b16 v[172:173], v20 offset:37032
    ds_read_b64_tr_b16 v[174:175], v20 offset:37672
    v_mfma_f32_32x32x16_bf16 v[64:79], v[188:191], v[180:183], v[64:79]
    ds_read_b64_tr_b16 v[176:177], v22 offset:37024
    ds_read_b64_tr_b16 v[178:179], v22 offset:37664
    v_mfma_f32_32x32x16_bf16 v[80:95], v[192:195], v[180:183], v[80:95]
    s_mov_b64 exec, s[72:73]
    ds_read_b128 v[176:179], v28 offset:0
    s_mov_b64 exec, -1
    s_waitcnt lgkmcnt(9)
    v_mfma_f32_32x32x16_bf16 v[128:143], v[216:219], v[200:203], v[128:143]
    ds_read_b128 v[180:183], v9 offset:36992
    ds_read_b128 v[184:187], v145 offset:36992
    v_mfma_f32_32x32x16_bf16 v[96:111], v[208:211], v[204:207], v[96:111]
    ds_read_b64_tr_b16 v[188:189], v20 offset:39552
    ds_read_b64_tr_b16 v[190:191], v20 offset:40192
    v_mfma_f32_32x32x16_bf16 v[112:127], v[212:215], v[204:207], v[112:127]
    ds_read_b64_tr_b16 v[192:193], v20 offset:39592
    ds_read_b64_tr_b16 v[194:195], v20 offset:40232
    v_mfma_f32_32x32x16_bf16 v[64:79], v[208:211], v[200:203], v[64:79]
    ds_read_b64_tr_b16 v[196:197], v22 offset:39584
    ds_read_b64_tr_b16 v[198:199], v22 offset:40224
    v_mfma_f32_32x32x16_bf16 v[80:95], v[212:215], v[200:203], v[80:95]
    s_mov_b64 exec, s[72:73]
    ds_read_b128 v[196:199], v28 offset:32
    s_mov_b64 exec, -1
    s_waitcnt lgkmcnt(9)
    v_mfma_f32_32x32x16_bf16 v[128:143], v[176:179], v[160:163], v[128:143]
    ds_read_b128 v[200:203], v10 offset:36992
    ds_read_b128 v[204:207], v146 offset:36992
    v_mfma_f32_32x32x16_bf16 v[96:111], v[168:171], v[164:167], v[96:111]
    ds_read_b64_tr_b16 v[208:209], v20 offset:42112
    ds_read_b64_tr_b16 v[210:211], v20 offset:42752
    v_mfma_f32_32x32x16_bf16 v[112:127], v[172:175], v[164:167], v[112:127]
    ds_read_b64_tr_b16 v[212:213], v20 offset:42152
    ds_read_b64_tr_b16 v[214:215], v20 offset:42792
    v_mfma_f32_32x32x16_bf16 v[64:79], v[168:171], v[160:163], v[64:79]
    ds_read_b64_tr_b16 v[216:217], v22 offset:42144
    ds_read_b64_tr_b16 v[218:219], v22 offset:42784
    v_mfma_f32_32x32x16_bf16 v[80:95], v[172:175], v[160:163], v[80:95]
    s_mov_b64 exec, s[72:73]
    ds_read_b128 v[216:219], v28 offset:64
    s_mov_b64 exec, -1
    s_waitcnt lgkmcnt(9)
    v_mfma_f32_32x32x16_bf16 v[128:143], v[196:199], v[180:183], v[128:143]
    ds_read_b128 v[160:163], v11 offset:36992
    ds_read_b128 v[164:167], v147 offset:36992
    v_mfma_f32_32x32x16_bf16 v[96:111], v[188:191], v[184:187], v[96:111]
    ds_read_b64_tr_b16 v[168:169], v20 offset:44672
    ds_read_b64_tr_b16 v[170:171], v20 offset:45312
    v_mfma_f32_32x32x16_bf16 v[112:127], v[192:195], v[184:187], v[112:127]
    ds_read_b64_tr_b16 v[172:173], v20 offset:44712
    ds_read_b64_tr_b16 v[174:175], v20 offset:45352
    v_mfma_f32_32x32x16_bf16 v[64:79], v[188:191], v[180:183], v[64:79]
    ds_read_b64_tr_b16 v[176:177], v22 offset:44704
    ds_read_b64_tr_b16 v[178:179], v22 offset:45344
    v_mfma_f32_32x32x16_bf16 v[80:95], v[192:195], v[180:183], v[80:95]
    s_mov_b64 exec, s[72:73]
    ds_read_b128 v[176:179], v28 offset:96
    s_mov_b64 exec, -1
    s_waitcnt lgkmcnt(9)
    v_mfma_f32_32x32x16_bf16 v[128:143], v[216:219], v[200:203], v[128:143]
    s_lshl_b32 s57, s54, 7
    v_add_u32 v28, s57, v26
    s_add_u32 s54, s54, 1
    s_cmp_eq_u32 s54, 9
    s_cselect_b32 s54, 0, s54
    s_barrier
    ds_read_b128 v[180:183], v12 offset:0
    ds_read_b128 v[184:187], v148 offset:0
    v_mfma_f32_32x32x16_bf16 v[96:111], v[208:211], v[204:207], v[96:111]
    ds_read_b64_tr_b16 v[188:189], v21 offset:0
    ds_read_b64_tr_b16 v[190:191], v21 offset:640
    v_mfma_f32_32x32x16_bf16 v[112:127], v[212:215], v[204:207], v[112:127]
    ds_read_b64_tr_b16 v[192:193], v21 offset:40
    ds_read_b64_tr_b16 v[194:195], v21 offset:680
    v_mfma_f32_32x32x16_bf16 v[64:79], v[208:211], v[200:203], v[64:79]
    ds_read_b64_tr_b16 v[196:197], v23 offset:32
    ds_read_b64_tr_b16 v[198:199], v23 offset:672
    v_mfma_f32_32x32x16_bf16 v[80:95], v[212:215], v[200:203], v[80:95]
    s_mov_b64 exec, s[72:73]
    ds_read_b128 v[196:199], v28 offset:0
    s_mov_b64 exec, -1
    s_waitcnt lgkmcnt(9)
    v_mfma_f32_32x32x16_bf16 v[128:143], v[176:179], v[160:163], v[128:143]
    ds_read_b128 v[200:203], v13 offset:0
    ds_read_b128 v[204:207], v149 offset:0
    v_mfma_f32_32x32x16_bf16 v[96:111], v[168:171], v[164:167], v[96:111]
    ds_read_b64_tr_b16 v[208:209], v21 offset:2560
    ds_read_b64_tr_b16 v[210:211], v21 offset:3200
    v_mfma_f32_32x32x16_bf16 v[112:127], v[172:175], v[164:167], v[112:127]
    ds_read_b64_tr_b16 v[212:213], v21 offset:2600
    ds_read_b64_tr_b16 v[214:215], v21 offset:3240
    v_mfma_f32_32x32x16_bf16 v[64:79], v[168:171], v[160:163], v[64:79]
    ds_read_b64_tr_b16 v[216:217], v23 offset:2592
    ds_read_b64_tr_b16 v[218:219], v23 offset:3232
    v_mfma_f32_32x32x16_bf16 v[80:95], v[172:175], v[160:163], v[80:95]
    s_mov_b64 exec, s[72:73]
    ds_read_b128 v[216:219], v28 offset:32
    s_mov_b64 exec, -1
    s_waitcnt lgkmcnt(9)
    v_mfma_f32_32x32x16_bf16 v[128:143], v[196:199], v[180:183], v[128:143]
    ds_read_b128 v[160:163], v14 offset:0
    ds_read_b128 v[164:167], v150 offset:0
    v_mfma_f32_32x32x16_bf16 v[96:111], v[188:191], v[184:187], v[96:111]
    ds_read_b64_tr_b16 v[168:169], v21 offset:5120
    ds_read_b64_tr_b16 v[170:171], v21 offset:5760
    v_mfma_f32_32x32x16_bf16 v[112:127], v[192:195], v[184:187], v[112:127]
    ds_read_b64_tr_b16 v[172:173], v21 offset:5160
    ds_read_b64_tr_b16 v[174:175], v21 offset:5800
    v_mfma_f32_32x32x16_bf16 v[64:79], v[188:191], v[180:183], v[64:79]
    ds_read_b64_tr_b16 v[176:177], v23 offset:5152
    ds_read_b64_tr_b16 v[178:179], v23 offset:5792
    v_mfma_f32_32x32x16_bf16 v[80:95], v[192:195], v[180:183], v[80:95]
    s_mov_b64 exec, s[72:73]
    ds_read_b128 v[176:179], v28 offset:64
    s_mov_b64 exec, -1
    s_waitcnt lgkmcnt(9)
    v_mfma_f32_32x32x16_bf16 v[128:143], v[216:219], v[200:203], v[128:143]
    ds_read_b128 v[180:183], v15 offset:0
    ds_read_b128 v[184:187], v151 offset:0
    v_mfma_f32_32x32x16_bf16 v[96:111], v[208:211], v[204:207], v[96:111]
    ds_read_b64_tr_b16 v[188:189], v21 offset:7680
    ds_read_b64_tr_b16 v[190:191], v21 offset:8320
    v_mfma_f32_32x32x16_bf16 v[112:127], v[212:215], v[204:207], v[112:127]
    ds_read_b64_tr_b16 v[192:193], v21 offset:7720
    ds_read_b64_tr_b16 v[194:195], v21 offset:8360
    v_mfma_f32_32x32x16_bf16 v[64:79], v[208:211], v[200:203], v[64:79]
    ds_read_b64_tr_b16 v[196:197], v23 offset:7712
    ds_read_b64_tr_b16 v[198:199], v23 offset:8352
    v_mfma_f32_32x32x16_bf16 v[80:95], v[212:215], v[200:203], v[80:95]
    s_mov_b64 exec, s[72:73]
    ds_read_b128 v[196:199], v28 offset:96
    s_mov_b64 exec, -1
    s_waitcnt lgkmcnt(9)
    v_mfma_f32_32x32x16_bf16 v[128:143], v[176:179], v[160:163], v[128:143]
    v_mfma_f32_32x32x16_bf16 v[96:111], v[168:171], v[164:167], v[96:111]
    v_mfma_f32_32x32x16_bf16 v[112:127], v[172:175], v[164:167], v[112:127]
    v_mfma_f32_32x32x16_bf16 v[64:79], v[168:171], v[160:163], v[64:79]
    v_mfma_f32_32x32x16_bf16 v[80:95], v[172:175], v[160:163], v[80:95]
    s_waitcnt lgkmcnt(0)
    v_mfma_f32_32x32x16_bf16 v[128:143], v[196:199], v[180:183], v[128:143]
    v_mfma_f32_32x32x16_bf16 v[96:111], v[188:191], v[184:187], v[96:111]
    s_lshl_b32 s57, s54, 7
    v_add_u32 v28, s57, v26
    s_add_u32 s54, s54, 1
    s_cmp_eq_u32 s54, 9
    s_cselect_b32 s54, 0, s54
    s_barrier
    ds_read_b128 v[200:203], v12 offset:36992
    ds_read_b128 v[204:207], v148 offset:36992
    ds_read_b64_tr_b16 v[208:209], v21 offset:36992
    ds_read_b64_tr_b16 v[210:211], v21 offset:37632
    ds_read_b64_tr_b16 v[212:213], v21 offset:37032
    ds_read_b64_tr_b16 v[214:215], v21 offset:37672
    ds_read_b64_tr_b16 v[216:217], v23 offset:37024
    ds_read_b64_tr_b16 v[218:219], v23 offset:37664
    s_mov_b64 exec, s[72:73]
    ds_read_b128 v[216:219], v28 offset:0
    s_mov_b64 exec, -1
    v_mfma_f32_32x32x16_bf16 v[112:127], v[192:195], v[184:187], v[112:127]
    ds_read_b128 v[160:163], v13 offset:36992
    ds_read_b128 v[164:167], v149 offset:36992
    ds_read_b64_tr_b16 v[168:169], v21 offset:39552
    v_mfma_f32_32x32x16_bf16 v[64:79], v[188:191], v[180:183], v[64:79]
    ds_read_b64_tr_b16 v[170:171], v21 offset:40192
    ds_read_b64_tr_b16 v[172:173], v21 offset:39592
    ds_read_b64_tr_b16 v[174:175], v21 offset:40232
    v_mfma_f32_32x32x16_bf16 v[80:95], v[192:195], v[180:183], v[80:95]
    ds_read_b64_tr_b16 v[176:177], v23 offset:39584
    ds_read_b64_tr_b16 v[178:179], v23 offset:40224
    s_mov_b64 exec, s[72:73]
    ds_read_b128 v[176:179], v28 offset:32
    s_mov_b64 exec, -1
    s_waitcnt lgkmcnt(9)
    v_mfma_f32_32x32x16_bf16 v[128:143], v[216:219], v[200:203], v[128:143]
    ds_read_b128 v[180:183], v14 offset:36992
    ds_read_b128 v[184:187], v150 offset:36992
    v_mfma_f32_32x32x16_bf16 v[96:111], v[208:211], v[204:207], v[96:111]
    ds_read_b64_tr_b16 v[188:189], v21 offset:42112
    ds_read_b64_tr_b16 v[190:191], v21 offset:42752
    v_mfma_f32_32x32x16_bf16 v[112:127], v[212:215], v[204:207], v[112:127]
    ds_read_b64_tr_b16 v[192:193], v21 offset:42152
    ds_read_b64_tr_b16 v[194:195], v21 offset:42792
    v_mfma_f32_32x32x16_bf16 v[64:79], v[208:211], v[200:203], v[64:79]
    ds_read_b64_tr_b16 v[196:197], v23 offset:42144
    ds_read_b64_tr_b16 v[198:199], v23 offset:42784
    v_mfma_f32_32x32x16_bf16 v[80:95], v[212:215], v[200:203], v[80:95]
    s_mov_b64 exec, s[72:73]
    ds_read_b128 v[196:199], v28 offset:64
    s_mov_b64 exec, -1
    s_waitcnt lgkmcnt(9)
    v_mfma_f32_32x32x16_bf16 v[128:143], v[176:179], v[160:163], v[128:143]
    ds_read_b128 v[200:203], v15 offset:36992
    ds_read_b128 v[204:207], v151 offset:36992
    ds_read_b64_tr_b16 v[208:209], v21 offset:44672
    v_mfma_f32_32x32x16_bf16 v[96:111], v[168:171], v[164:167], v[96:111]
    ds_read_b64_tr_b16 v[210:211], v21 offset:45312
    ds_read_b64_tr_b16 v[212:213], v21 offset:44712
    ds_read_b64_tr_b16 v[214:215], v21 offset:45352
    v_mfma_f32_32x32x16_bf16 v[112:127], v[172:175], v[164:167], v[112:127]
    ds_read_b64_tr_b16 v[216:217], v23 offset:44704
    ds_read_b64_tr_b16 v[218:219], v23 offset:45344
    s_mov_b64 exec, s[72:73]
    ds_read_b128 v[216:219], v28 offset:96
    s_mov_b64 exec, -1
    s_waitcnt lgkmcnt(9)
    v_mfma_f32_32x32x16_bf16 v[128:143], v[196:199], v[180:183], v[128:143]
    ds_read_b64_tr_b16 v[40:41], v30
    ds_read_b64_tr_b16 v[42:43], v30 offset:384
    v_mfma_f32_32x32x16_bf16 v[96:111], v[188:191], v[184:187], v[96:111]
    ds_read_b64_tr_b16 v[44:45], v30 offset:960
    ds_read_b64_tr_b16 v[46:47], v30 offset:1344
    v_mfma_f32_32x32x16_bf16 v[112:127], v[192:195], v[184:187], v[112:127]
    ds_read_b64_tr_b16 v[48:49], v27 offset:768
    ds_read_b32 v60, v61
    v_mfma_f32_32x32x16_bf16 v[64:79], v[168:171], v[160:163], v[64:79]
    s_waitcnt lgkmcnt(6)
    v_mfma_f32_32x32x16_bf16 v[128:143], v[216:219], v[200:203], v[128:143]
    v_mfma_f32_32x32x16_bf16 v[96:111], v[208:211], v[204:207], v[96:111]
    v_mfma_f32_32x32x16_bf16 v[112:127], v[212:215], v[204:207], v[112:127]
    s_setprio 2
    v_mfma_f32_32x32x16_bf16 v[80:95], v[172:175], v[160:163], v[80:95]
    s_nop 6
    s_nop 0
    ds_write_b128 v225, v[136:139]
    s_mov_b32 exec_hi, 0
    ds_write_b32 v226, v140 offset:1024
    s_mov_b64 exec, -1
    v_mfma_f32_32x32x16_bf16 v[64:79], v[188:191], v[180:183], v[64:79]
    v_cvt_pk_bf16_f32 v104, v104, v105
    v_cvt_pk_bf16_f32 v105, v106, v107
    v_cvt_pk_bf16_f32 v106, v108, v109
    v_cvt_pk_bf16_f32 v107, v110, v111
    ds_write_b128 v224, v[104:107] offset:0
    v_mfma_f32_32x32x16_bf16 v[80:95], v[192:195], v[180:183], v[80:95]
    v_cvt_pk_bf16_f32 v120, v120, v121
    v_cvt_pk_bf16_f32 v121, v122, v123
    v_cvt_pk_bf16_f32 v122, v124, v125
    v_cvt_pk_bf16_f32 v123, v126, v127
    ds_write_b128 v224, v[120:123] offset:1024
    v_mfma_f32_32x32x16_bf16 v[64:79], v[208:211], v[200:203], v[64:79]
    v_mul_f32 v96, s94, v96
    v_mul_f32 v97, s94, v97
    v_mul_f32 v98, s94, v98
    v_mul_f32 v99, s94, v99
    v_mul_f32 v100, s94, v100
    v_mul_f32 v101, s94, v101
    v_mul_f32 v102, s94, v102
    v_mul_f32 v103, s94, v103
    v_cvt_pk_bf16_f32 v96, v96, v97
    v_cvt_pk_bf16_f32 v97, v98, v99
    v_cvt_pk_bf16_f32 v98, v100, v101
    v_cvt_pk_bf16_f32 v99, v102, v103
    ds_write_b128 v224, v[96:99] offset:2048
    v_mfma_f32_32x32x16_bf16 v[80:95], v[212:215], v[200:203], v[80:95]
    v_mul_f32 v112, s94, v112
    v_mul_f32 v113, s94, v113
    v_mul_f32 v114, s94, v114
    v_mul_f32 v115, s94, v115
    v_mul_f32 v116, s94, v116
    v_mul_f32 v117, s94, v117
    v_mul_f32 v118, s94, v118
    v_mul_f32 v119, s94, v119
    v_cvt_pk_bf16_f32 v112, v112, v113
    v_cvt_pk_bf16_f32 v113, v114, v115
    v_cvt_pk_bf16_f32 v114, v116, v117
    v_cvt_pk_bf16_f32 v115, v118, v119
    ds_write_b128 v224, v[112:115] offset:3072
    s_waitcnt lgkmcnt(0)
    s_barrier
    v_cvt_pk_bf16_f32 v132, v132, v133
    v_cvt_pk_bf16_f32 v133, v134, v135
    v_cndmask_b32 v48, v48, 0, s[76:77]
    v_cndmask_b32 v49, 0, v49, s[76:77]
    v_readfirstlane_b32 s100, v60
    s_and_b32 s57, s51, 2
    s_or_b32 s100, s100, s57
    v_mfma_f32_32x32x4_2b_bf16 v[144:175], v[48:49], v[132:133], 0
    v_cvt_pk_bf16_f32 v72, v72, v73
    v_cvt_pk_bf16_f32 v73, v74, v75
    v_cvt_pk_bf16_f32 v74, v76, v77
    v_cvt_pk_bf16_f32 v75, v78, v79
    v_cvt_pk_bf16_f32 v88, v88, v89
    v_cvt_pk_bf16_f32 v89, v90, v91
    v_cvt_pk_bf16_f32 v90, v92, v93
    v_cvt_pk_bf16_f32 v91, v94, v95
    s_cmp_lg_u32 s53, 0
    s_cbranch_scc1 L_g_10
    v_mul_f32 v64, s94, v64
    v_mul_f32 v65, s94, v65
    v_mul_f32 v66, s94, v66
    v_mul_f32 v67, s94, v67
    v_mul_f32 v68, s94, v68
    v_mul_f32 v69, s94, v69
    v_mul_f32 v70, s94, v70
    v_mul_f32 v71, s94, v71
L_g_10:
    s_nop 7
    v_mfma_f32_32x32x16_bf16 v[144:159], v[40:43], v[72:75], v[144:159]
    v_mfma_f32_32x32x16_bf16 v[160:175], v[44:47], v[88:91], v[160:175]
    v_cvt_pk_bf16_f32 v64, v64, v65
    v_cvt_pk_bf16_f32 v65, v66, v67
    v_cvt_pk_bf16_f32 v66, v68, v69
    v_cvt_pk_bf16_f32 v67, v70, v71
    s_cmp_lg_u32 s53, 0
    s_cbranch_scc1 L_g_11
    v_mul_f32 v80, s94, v80
    v_mul_f32 v81, s94, v81
    v_mul_f32 v82, s94, v82
    v_mul_f32 v83, s94, v83
    v_mul_f32 v84, s94, v84
    v_mul_f32 v85, s94, v85
    v_mul_f32 v86, s94, v86
    v_mul_f32 v87, s94, v87
L_g_11:
    v_cvt_pk_bf16_f32 v80, v80, v81
    v_cvt_pk_bf16_f32 v81, v82, v83
    v_cvt_pk_bf16_f32 v82, v84, v85
    v_cvt_pk_bf16_f32 v83, v86, v87
L_epi:
    s_cmp_lg_u32 s53, 0
    s_cbranch_scc1 L_kvrole
    v_mul_f32 v128, s94, v128
    v_mul_f32 v129, s94, v129
    v_mul_f32 v130, s94, v130
    v_mul_f32 v131, s94, v131
    v_mul_f32 v19, v63, v140
    v_exp_f32 v19, v19
    v_cvt_pk_bf16_f32 v128, v128, v129
    v_cvt_pk_bf16_f32 v129, v130, v131
    v_add_f32 v19, 1.0, v19
    v_rcp_f32 v19, v19
    v_mov_b32 v100, v129
    v_mov_b32 v101, v80
    s_nop 0
    v_permlane32_swap_b32 v100, v81
    v_mov_b32 v104, v67
    v_mov_b32 v105, v82
    v_permlane32_swap_b32 v81, v83
    v_mov_b32 v67, v252
    v_mov_b32 v103, v252
    v_mov_b32 v107, v252
    v_mov_b32 v109, v252
    v_mov_b32 v108, v19
    v_cndmask_b32 v102, v83, v81, s[76:77]
    v_cndmask_b32 v106, v128, v83, s[76:77]
    s_bitcmp1_b32 s100, 1
    s_cbranch_scc1 L_far_12
    buffer_store_dwordx4 v[64:67], v18, s[44:47], s101 offen offset:0 nt
    buffer_store_dwordx4 v[100:103], v18, s[44:47], s101 offen offset:1024 nt
    buffer_store_dwordx4 v[104:107], v18, s[44:47], s101 offen offset:2048 nt
    s_mov_b32 exec_hi, 0
    buffer_store_dwordx2 v[108:109], v25, s[44:47], s101 offen offset:3072 nt
    s_mov_b64 exec, -1
    s_branch L_nfd_13
L_far_12:
    buffer_store_dwordx4 v[64:67], v18, s[44:47], s101 offen offset:0 sc1
    buffer_store_dwordx4 v[100:103], v18, s[44:47], s101 offen offset:1024 sc1
    buffer_store_dwordx4 v[104:107], v18, s[44:47], s101 offen offset:2048 sc1
    s_mov_b32 exec_hi, 0
    buffer_store_dwordx2 v[108:109], v25, s[44:47], s101 offen offset:3072 sc1
    s_mov_b64 exec, -1
L_nfd_13:
    s_setprio 0
    v_cndmask_b32 v152, v154, v155, s[76:77]
    v_max3_f32 v40, v144, v145, v146
    v_min3_f32 v41, v144, v145, v146
    v_max3_f32 v40, v40, v147, v148
    v_min3_f32 v41, v41, v147, v148
    v_max3_f32 v40, v40, v149, v150
    v_min3_f32 v41, v41, v149, v150
    v_max3_f32 v40, v40, v151, v152
    v_min3_f32 v41, v41, v151, v152
    v_mov_b64 v[42:43], v[40:41]
    s_nop 1
    v_permlane32_swap_b32 v40, v42
    v_permlane32_swap_b32 v41, v43
    v_max_f32 v40, v40, v42
    v_min_f32 v41, v41, v43
    v_pk_mul_f32 v[40:41], v[40:41], v[62:63] op_sel:[0,1] op_sel_hi:[1,0]
    v_pk_fma_f32 v[176:177], v[144:145], v[62:63], v[40:41] op_sel:[0,0,0] op_sel_hi:[0,1,1]
    v_pk_fma_f32 v[178:179], v[144:145], v[62:63], v[40:41] op_sel:[1,0,0] op_sel_hi:[1,1,1]
    v_pk_fma_f32 v[180:181], v[146:147], v[62:63], v[40:41] op_sel:[0,0,0] op_sel_hi:[0,1,1]
    v_pk_fma_f32 v[182:183], v[146:147], v[62:63], v[40:41] op_sel:[1,0,0] op_sel_hi:[1,1,1]
    v_pk_fma_f32 v[184:185], v[148:149], v[62:63], v[40:41] op_sel:[0,0,0] op_sel_hi:[0,1,1]
    v_pk_fma_f32 v[186:187], v[148:149], v[62:63], v[40:41] op_sel:[1,0,0] op_sel_hi:[1,1,1]
    v_pk_fma_f32 v[188:189], v[150:151], v[62:63], v[40:41] op_sel:[0,0,0] op_sel_hi:[0,1,1]
    v_pk_fma_f32 v[190:191], v[150:151], v[62:63], v[40:41] op_sel:[1,0,0] op_sel_hi:[1,1,1]
    v_pk_fma_f32 v[192:193], v[152:153], v[62:63], v[40:41] op_sel:[0,0,0] op_sel_hi:[0,1,1]
    v_exp_f32 v176, v176
    v_exp_f32 v177, v177
    v_exp_f32 v178, v178
    v_exp_f32 v179, v179
    v_exp_f32 v180, v180
    v_exp_f32 v181, v181
    v_exp_f32 v182, v182
    v_exp_f32 v183, v183
    v_exp_f32 v184, v184
    v_exp_f32 v185, v185
    v_exp_f32 v186, v186
    v_exp_f32 v187, v187
    v_exp_f32 v188, v188
    v_exp_f32 v189, v189
    v_exp_f32 v190, v190
    v_exp_f32 v191, v191
    v_exp_f32 v192, v192
    v_exp_f32 v193, v193
    v_pk_add_f32 v[42:43], v[176:177], v[178:179]
    v_pk_add_f32 v[44:45], v[180:181], v[182:183]
    v_pk_add_f32 v[42:43], v[42:43], v[184:185]
    v_pk_add_f32 v[44:45], v[44:45], v[186:187]
    v_pk_add_f32 v[42:43], v[42:43], v[188:189]
    v_pk_add_f32 v[44:45], v[44:45], v[190:191]
    v_pk_add_f32 v[42:43], v[42:43], v[192:193]
    v_pk_add_f32 v[42:43], v[42:43], v[44:45]
    v_mov_b64 v[44:45], v[42:43]
    s_nop 1
    v_permlane32_swap_b32 v42, v44
    v_permlane32_swap_b32 v43, v45
    v_pk_add_f32 v[42:43], v[42:43], v[44:45]
    v_rcp_f32 v42, v42
    v_rcp_f32 v43, v43
    s_nop 0
    v_pk_mul_f32 v[176:177], v[176:177], v[42:43]
    v_pk_mul_f32 v[178:179], v[178:179], v[42:43]
    v_pk_mul_f32 v[180:181], v[180:181], v[42:43]
    v_pk_mul_f32 v[182:183], v[182:183], v[42:43]
    v_pk_mul_f32 v[184:185], v[184:185], v[42:43]
    v_pk_mul_f32 v[186:187], v[186:187], v[42:43]
    v_pk_mul_f32 v[188:189], v[188:189], v[42:43]
    v_pk_mul_f32 v[190:191], v[190:191], v[42:43]
    v_pk_mul_f32 v[192:193], v[192:193], v[42:43]
    v_cvt_pk_bf16_f32 v212, v176, v180
    v_cvt_pk_bf16_f32 v213, v177, v181
    v_cvt_pk_bf16_f32 v214, v178, v182
    v_cvt_pk_bf16_f32 v216, v184, v179
    v_cvt_pk_bf16_f32 v217, v185, v183
    v_cvt_pk_bf16_f32 v218, v186, v187
    v_cvt_pk_bf16_f32 v220, v188, v192
    v_cvt_pk_bf16_f32 v221, v189, v193
    v_cvt_pk_bf16_f32 v222, v190, v191
    v_mov_b32 v215, 0
    v_mov_b32 v219, 0
    v_mov_b32 v223, 0
    buffer_load_dwordx4 v[8:11], v18, s[44:47], s85 offen sc1
    buffer_load_dwordx4 v[12:15], v18, s[44:47], s85 offen offset:1024 sc1
    buffer_load_dwordx4 v[20:23], v18, s[44:47], s85 offen offset:2048 sc1
    buffer_load_dwordx2 v[26:27], v25, s[44:47], s85 offen offset:3072 sc1
    v_cndmask_b32 v168, v170, v171, s[76:77]
    v_max3_f32 v48, v160, v161, v162
    v_min3_f32 v49, v160, v161, v162
    v_max3_f32 v48, v48, v163, v164
    v_min3_f32 v49, v49, v163, v164
    v_max3_f32 v48, v48, v165, v166
    v_min3_f32 v49, v49, v165, v166
    v_max3_f32 v48, v48, v167, v168
    v_min3_f32 v49, v49, v167, v168
    v_mov_b64 v[50:51], v[48:49]
    s_nop 1
    v_permlane32_swap_b32 v48, v50
    v_permlane32_swap_b32 v49, v51
    v_max_f32 v48, v48, v50
    v_min_f32 v49, v49, v51
    v_pk_mul_f32 v[48:49], v[48:49], v[62:63] op_sel:[0,1] op_sel_hi:[1,0]
    v_pk_fma_f32 v[194:195], v[160:161], v[62:63], v[48:49] op_sel:[0,0,0] op_sel_hi:[0,1,1]
    v_pk_fma_f32 v[196:197], v[160:161], v[62:63], v[48:49] op_sel:[1,0,0] op_sel_hi:[1,1,1]
    v_pk_fma_f32 v[198:199], v[162:163], v[62:63], v[48:49] op_sel:[0,0,0] op_sel_hi:[0,1,1]
    v_pk_fma_f32 v[200:201], v[162:163], v[62:63], v[48:49] op_sel:[1,0,0] op_sel_hi:[1,1,1]
    v_pk_fma_f32 v[202:203], v[164:165], v[62:63], v[48:49] op_sel:[0,0,0] op_sel_hi:[0,1,1]
    v_pk_fma_f32 v[204:205], v[164:165], v[62:63], v[48:49] op_sel:[1,0,0] op_sel_hi:[1,1,1]
    v_pk_fma_f32 v[206:207], v[166:167], v[62:63], v[48:49] op_sel:[0,0,0] op_sel_hi:[0,1,1]
    v_pk_fma_f32 v[208:209], v[166:167], v[62:63], v[48:49] op_sel:[1,0,0] op_sel_hi:[1,1,1]
    v_pk_fma_f32 v[210:211], v[168:169], v[62:63], v[48:49] op_sel:[0,0,0] op_sel_hi:[0,1,1]
    v_exp_f32 v194, v194
    v_exp_f32 v195, v195
    v_exp_f32 v196, v196
    v_exp_f32 v197, v197
    v_exp_f32 v198, v198
    v_exp_f32 v199, v199
    v_exp_f32 v200, v200
    v_exp_f32 v201, v201
    v_exp_f32 v202, v202
    v_exp_f32 v203, v203
    v_exp_f32 v204, v204
    v_exp_f32 v205, v205
    v_exp_f32 v206, v206
    v_exp_f32 v207, v207
    v_exp_f32 v208, v208
    v_exp_f32 v209, v209
    v_exp_f32 v210, v210
    v_exp_f32 v211, v211
    v_pk_add_f32 v[50:51], v[194:195], v[196:197]
    v_pk_add_f32 v[52:53], v[198:199], v[200:201]
    v_pk_add_f32 v[50:51], v[50:51], v[202:203]
    v_pk_add_f32 v[52:53], v[52:53], v[204:205]
    v_pk_add_f32 v[50:51], v[50:51], v[206:207]
    v_pk_add_f32 v[52:53], v[52:53], v[208:209]
    v_pk_add_f32 v[50:51], v[50:51], v[210:211]
    v_pk_add_f32 v[50:51], v[50:51], v[52:53]
    v_mov_b64 v[52:53], v[50:51]
    s_nop 1
    v_permlane32_swap_b32 v50, v52
    v_permlane32_swap_b32 v51, v53
    v_pk_add_f32 v[50:51], v[50:51], v[52:53]
    v_rcp_f32 v50, v50
    v_rcp_f32 v51, v51
    s_nop 0
    v_pk_mul_f32 v[194:195], v[194:195], v[50:51]
    v_pk_mul_f32 v[196:197], v[196:197], v[50:51]
    v_pk_mul_f32 v[198:199], v[198:199], v[50:51]
    v_pk_mul_f32 v[200:201], v[200:201], v[50:51]
    v_pk_mul_f32 v[202:203], v[202:203], v[50:51]
    v_pk_mul_f32 v[204:205], v[204:205], v[50:51]
    v_pk_mul_f32 v[206:207], v[206:207], v[50:51]
    v_pk_mul_f32 v[208:209], v[208:209], v[50:51]
    v_pk_mul_f32 v[210:211], v[210:211], v[50:51]
    v_cvt_pk_bf16_f32 v224, v194, v198
    v_cvt_pk_bf16_f32 v225, v195, v199
    v_cvt_pk_bf16_f32 v226, v196, v200
    v_cvt_pk_bf16_f32 v228, v202, v197
    v_cvt_pk_bf16_f32 v229, v203, v201
    v_cvt_pk_bf16_f32 v230, v204, v205
    v_cvt_pk_bf16_f32 v232, v206, v210
    v_cvt_pk_bf16_f32 v233, v207, v211
    v_cvt_pk_bf16_f32 v234, v208, v209
    v_mov_b32 v227, 0
    v_mov_b32 v231, 0
    v_mov_b32 v235, 0
    s_waitcnt vmcnt(8)
    s_cmp_eq_u32 s50, 0
    s_cbranch_scc1 L_g_14
    s_barrier
L_g_14:
    s_waitcnt vmcnt(0)
    s_branch L_ck_16
L_rt_15:
    buffer_load_dwordx4 v[8:11], v18, s[44:47], s85 offen sc1
    buffer_load_dwordx4 v[12:15], v18, s[44:47], s85 offen offset:1024 sc1
    buffer_load_dwordx4 v[20:23], v18, s[44:47], s85 offen offset:2048 sc1
    buffer_load_dwordx2 v[26:27], v25, s[44:47], s85 offen offset:3072 sc1
    s_waitcnt vmcnt(0)
L_ck_16:
    v_xor_b32 v24, v11, v252
    v_bitop3_b32 v24, v24, v15, v252 bitop3:0xf6
    v_bitop3_b32 v24, v24, v23, v252 bitop3:0xf6
    v_bitop3_b32 v24, v24, v27, v252 bitop3:0xf6
    v_cmp_ne_u32 vcc, 0, v24
    s_cbranch_vccz L_ok_17
    s_sub_u32 s84, s84, 1
    s_cmp_gt_i32 s84, 0
    s_cbranch_scc1 L_rt_15
L_ok_17:
    v_mov_b32 v254, v26
    ds_read_b128 v[24:27], v18
    ds_read_b128 v[40:43], v3
    ds_read_b32 v28, v4
    ds_read_b128 v[32:35], v5
    ds_read_b128 v[36:39], v5 offset:608
    v_mov_b32 v46, 0
    v_mov_b32 v47, 0
    v_mov_b32 v11, v20
    v_mov_b32 v15, v21
    v_mov_b32 v16, v22
    v_mfma_f32_32x32x4_2b_bf16 v[48:79], v[46:47], v[46:47], 0
    s_waitcnt lgkmcnt(4)
    v_mfma_f32_32x32x16_bf16 v[112:127], v[24:27], v[8:11], 0
    v_mfma_f32_32x32x16_bf16 v[128:143], v[24:27], v[12:15], 0
    s_waitcnt lgkmcnt(2)
    v_mfma_f32_32x32x16_bf16 v[80:95], v[40:43], v[8:11], 0
    v_mfma_f32_32x32x16_bf16 v[96:111], v[40:43], v[12:15], 0
    ds_read_b128 v[24:27], v3 offset:4736
    ds_read_b32 v30, v4 offset:4736
    s_nop 5
    v_max3_f32 v44, v112, v113, v114
    v_max3_f32 v44, v44, v115, v116
    v_max3_f32 v44, v44, v117, v118
    v_max3_f32 v44, v44, v119, v120
    v_max3_f32 v44, v44, v121, v122
    v_max3_f32 v44, v44, v123, v124
    v_max3_f32 v44, v44, v125, v126
    v_max_f32 v44, v44, v127
    v_max3_f32 v45, v128, v129, v130
    v_max3_f32 v45, v45, v131, v132
    v_max3_f32 v45, v45, v133, v134
    v_max3_f32 v45, v45, v135, v136
    v_max3_f32 v45, v45, v137, v138
    v_max3_f32 v45, v45, v139, v140
    v_max3_f32 v45, v45, v141, v142
    v_max_f32 v45, v45, v143
    s_nop 1
    v_permlane32_swap_b32 v44, v45
    v_min_f32 v44, -v44, -v45
    v_and_b32 v45, 0xffff0000, v44
    v_sub_f32 v44, v44, v45
    v_cvt_pk_bf16_f32 v17, v45, v44
    s_nop 1
    v_mfma_f32_32x32x4_2b_bf16 v[80:111], v[28:29], v[16:17], v[80:111]
    s_cmp_lg_u32 s50, 0
    s_cbranch_scc1 L_g_18
    s_barrier
L_g_18:
    s_branch L_phase2
L_kvrole:
    v_cvt_pk_bf16_f32 v128, v128, v129
    v_cvt_pk_bf16_f32 v129, v130, v131
    ds_write_b64 v228, v[64:65] offset:0
    ds_write_b64 v228, v[66:67] offset:16
    ds_write_b64 v228, v[80:81] offset:5120
    ds_write_b64 v228, v[82:83] offset:5136
    v_cndmask_b32 v120, v128, v129, s[76:77]
    v_mov_b32 v121, 0x3f80
    ds_write_b64 v229, v[120:121] offset:32
    s_setprio 0
    v_cndmask_b32 v152, v154, v155, s[76:77]
    v_max3_f32 v40, v144, v145, v146
    v_min3_f32 v41, v144, v145, v146
    v_max3_f32 v40, v40, v147, v148
    v_min3_f32 v41, v41, v147, v148
    v_max3_f32 v40, v40, v149, v150
    v_min3_f32 v41, v41, v149, v150
    v_max3_f32 v40, v40, v151, v152
    v_min3_f32 v41, v41, v151, v152
    v_mov_b64 v[42:43], v[40:41]
    s_nop 1
    v_permlane32_swap_b32 v40, v42
    v_permlane32_swap_b32 v41, v43
    v_max_f32 v40, v40, v42
    v_min_f32 v41, v41, v43
    v_pk_mul_f32 v[40:41], v[40:41], v[62:63] op_sel:[0,1] op_sel_hi:[1,0]
    v_pk_fma_f32 v[176:177], v[144:145], v[62:63], v[40:41] op_sel:[0,0,0] op_sel_hi:[0,1,1]
    v_pk_fma_f32 v[178:179], v[144:145], v[62:63], v[40:41] op_sel:[1,0,0] op_sel_hi:[1,1,1]
    v_pk_fma_f32 v[180:181], v[146:147], v[62:63], v[40:41] op_sel:[0,0,0] op_sel_hi:[0,1,1]
    v_pk_fma_f32 v[182:183], v[146:147], v[62:63], v[40:41] op_sel:[1,0,0] op_sel_hi:[1,1,1]
    v_pk_fma_f32 v[184:185], v[148:149], v[62:63], v[40:41] op_sel:[0,0,0] op_sel_hi:[0,1,1]
    v_pk_fma_f32 v[186:187], v[148:149], v[62:63], v[40:41] op_sel:[1,0,0] op_sel_hi:[1,1,1]
    v_pk_fma_f32 v[188:189], v[150:151], v[62:63], v[40:41] op_sel:[0,0,0] op_sel_hi:[0,1,1]
    v_pk_fma_f32 v[190:191], v[150:151], v[62:63], v[40:41] op_sel:[1,0,0] op_sel_hi:[1,1,1]
    v_pk_fma_f32 v[192:193], v[152:153], v[62:63], v[40:41] op_sel:[0,0,0] op_sel_hi:[0,1,1]
    v_exp_f32 v176, v176
    v_exp_f32 v177, v177
    v_exp_f32 v178, v178
    v_exp_f32 v179, v179
    v_exp_f32 v180, v180
    v_exp_f32 v181, v181
    v_exp_f32 v182, v182
    v_exp_f32 v183, v183
    v_exp_f32 v184, v184
    v_exp_f32 v185, v185
    v_exp_f32 v186, v186
    v_exp_f32 v187, v187
    v_exp_f32 v188, v188
    v_exp_f32 v189, v189
    v_exp_f32 v190, v190
    v_exp_f32 v191, v191
    v_exp_f32 v192, v192
    v_exp_f32 v193, v193
    v_pk_add_f32 v[42:43], v[176:177], v[178:179]
    v_pk_add_f32 v[44:45], v[180:181], v[182:183]
    v_pk_add_f32 v[42:43], v[42:43], v[184:185]
    v_pk_add_f32 v[44:45], v[44:45], v[186:187]
    v_pk_add_f32 v[42:43], v[42:43], v[188:189]
    v_pk_add_f32 v[44:45], v[44:45], v[190:191]
    v_pk_add_f32 v[42:43], v[42:43], v[192:193]
    v_pk_add_f32 v[42:43], v[42:43], v[44:45]
    v_mov_b64 v[44:45], v[42:43]
    s_nop 1
    v_permlane32_swap_b32 v42, v44
    v_permlane32_swap_b32 v43, v45
    v_pk_add_f32 v[42:43], v[42:43], v[44:45]
    v_rcp_f32 v42, v42
    v_rcp_f32 v43, v43
    s_nop 0
    v_pk_mul_f32 v[176:177], v[176:177], v[42:43]
    v_pk_mul_f32 v[178:179], v[178:179], v[42:43]
    v_pk_mul_f32 v[180:181], v[180:181], v[42:43]
    v_pk_mul_f32 v[182:183], v[182:183], v[42:43]
    v_pk_mul_f32 v[184:185], v[184:185], v[42:43]
    v_pk_mul_f32 v[186:187], v[186:187], v[42:43]
    v_pk_mul_f32 v[188:189], v[188:189], v[42:43]
    v_pk_mul_f32 v[190:191], v[190:191], v[42:43]
    v_pk_mul_f32 v[192:193], v[192:193], v[42:43]
    v_cvt_pk_bf16_f32 v96, v176, v177
    v_cvt_pk_bf16_f32 v97, v178, v179
    v_cvt_pk_bf16_f32 v98, v180, v181
    v_cvt_pk_bf16_f32 v99, v182, v183
    v_cvt_pk_bf16_f32 v100, v184, v185
    v_cvt_pk_bf16_f32 v101, v186, v187
    v_cvt_pk_bf16_f32 v102, v188, v189
    v_cvt_pk_bf16_f32 v103, v190, v191
    v_cvt_pk_bf16_f32 v104, v192, v193
    ds_write_b64 v230, v[96:97] offset:0
    ds_write_b64 v230, v[98:99] offset:8
    ds_write_b64 v230, v[100:101] offset:16
    ds_write_b64 v230, v[102:103] offset:24
    ds_write_b32 v230, v104 offset:32
    v_cndmask_b32 v168, v170, v171, s[76:77]
    v_max3_f32 v48, v160, v161, v162
    v_min3_f32 v49, v160, v161, v162
    v_max3_f32 v48, v48, v163, v164
    v_min3_f32 v49, v49, v163, v164
    v_max3_f32 v48, v48, v165, v166
    v_min3_f32 v49, v49, v165, v166
    v_max3_f32 v48, v48, v167, v168
    v_min3_f32 v49, v49, v167, v168
    v_mov_b64 v[50:51], v[48:49]
    s_nop 1
    v_permlane32_swap_b32 v48, v50
    v_permlane32_swap_b32 v49, v51
    v_max_f32 v48, v48, v50
    v_min_f32 v49, v49, v51
    v_pk_mul_f32 v[48:49], v[48:49], v[62:63] op_sel:[0,1] op_sel_hi:[1,0]
    v_pk_fma_f32 v[194:195], v[160:161], v[62:63], v[48:49] op_sel:[0,0,0] op_sel_hi:[0,1,1]
    v_pk_fma_f32 v[196:197], v[160:161], v[62:63], v[48:49] op_sel:[1,0,0] op_sel_hi:[1,1,1]
    v_pk_fma_f32 v[198:199], v[162:163], v[62:63], v[48:49] op_sel:[0,0,0] op_sel_hi:[0,1,1]
    v_pk_fma_f32 v[200:201], v[162:163], v[62:63], v[48:49] op_sel:[1,0,0] op_sel_hi:[1,1,1]
    v_pk_fma_f32 v[202:203], v[164:165], v[62:63], v[48:49] op_sel:[0,0,0] op_sel_hi:[0,1,1]
    v_pk_fma_f32 v[204:205], v[164:165], v[62:63], v[48:49] op_sel:[1,0,0] op_sel_hi:[1,1,1]
    v_pk_fma_f32 v[206:207], v[166:167], v[62:63], v[48:49] op_sel:[0,0,0] op_sel_hi:[0,1,1]
    v_pk_fma_f32 v[208:209], v[166:167], v[62:63], v[48:49] op_sel:[1,0,0] op_sel_hi:[1,1,1]
    v_pk_fma_f32 v[210:211], v[168:169], v[62:63], v[48:49] op_sel:[0,0,0] op_sel_hi:[0,1,1]
    v_exp_f32 v194, v194
    v_exp_f32 v195, v195
    v_exp_f32 v196, v196
    v_exp_f32 v197, v197
    v_exp_f32 v198, v198
    v_exp_f32 v199, v199
    v_exp_f32 v200, v200
    v_exp_f32 v201, v201
    v_exp_f32 v202, v202
    v_exp_f32 v203, v203
    v_exp_f32 v204, v204
    v_exp_f32 v205, v205
    v_exp_f32 v206, v206
    v_exp_f32 v207, v207
    v_exp_f32 v208, v208
    v_exp_f32 v209, v209
    v_exp_f32 v210, v210
    v_exp_f32 v211, v211
    v_pk_add_f32 v[50:51], v[194:195], v[196:197]
    v_pk_add_f32 v[52:53], v[198:199], v[200:201]
    v_pk_add_f32 v[50:51], v[50:51], v[202:203]
    v_pk_add_f32 v[52:53], v[52:53], v[204:205]
    v_pk_add_f32 v[50:51], v[50:51], v[206:207]
    v_pk_add_f32 v[52:53], v[52:53], v[208:209]
    v_pk_add_f32 v[50:51], v[50:51], v[210:211]
    v_pk_add_f32 v[50:51], v[50:51], v[52:53]
    v_mov_b64 v[52:53], v[50:51]
    s_nop 1
    v_permlane32_swap_b32 v50, v52
    v_permlane32_swap_b32 v51, v53
    v_pk_add_f32 v[50:51], v[50:51], v[52:53]
    v_rcp_f32 v50, v50
    v_rcp_f32 v51, v51
    s_nop 0
    v_pk_mul_f32 v[194:195], v[194:195], v[50:51]
    v_pk_mul_f32 v[196:197], v[196:197], v[50:51]
    v_pk_mul_f32 v[198:199], v[198:199], v[50:51]
    v_pk_mul_f32 v[200:201], v[200:201], v[50:51]
    v_pk_mul_f32 v[202:203], v[202:203], v[50:51]
    v_pk_mul_f32 v[204:205], v[204:205], v[50:51]
    v_pk_mul_f32 v[206:207], v[206:207], v[50:51]
    v_pk_mul_f32 v[208:209], v[208:209], v[50:51]
    v_pk_mul_f32 v[210:211], v[210:211], v[50:51]
    v_cvt_pk_bf16_f32 v108, v194, v195
    v_cvt_pk_bf16_f32 v109, v196, v197
    v_cvt_pk_bf16_f32 v110, v198, v199
    v_cvt_pk_bf16_f32 v111, v200, v201
    v_cvt_pk_bf16_f32 v112, v202, v203
    v_cvt_pk_bf16_f32 v113, v204, v205
    v_cvt_pk_bf16_f32 v114, v206, v207
    v_cvt_pk_bf16_f32 v115, v208, v209
    v_cvt_pk_bf16_f32 v116, v210, v211
    buffer_load_dwordx4 v[8:11], v18, s[44:47], s85 offen sc1
    buffer_load_dwordx4 v[12:15], v18, s[44:47], s85 offen offset:1024 sc1
    buffer_load_dwordx4 v[20:23], v18, s[44:47], s85 offen offset:2048 sc1
    buffer_load_dwordx2 v[26:27], v25, s[44:47], s85 offen offset:3072 sc1
    ds_write_b64 v230, v[108:109] offset:10240
    ds_write_b64 v230, v[110:111] offset:10248
    ds_write_b64 v230, v[112:113] offset:10256
    ds_write_b64 v230, v[114:115] offset:10264
    ds_write_b32 v230, v116 offset:10272
    s_waitcnt vmcnt(4) lgkmcnt(0)
    s_barrier
    ds_read_b64_tr_b16 v[144:145], v233 offset:0
    ds_read_b64_tr_b16 v[146:147], v233 offset:160
    ds_read_b64_tr_b16 v[148:149], v232 offset:0
    ds_read_b64_tr_b16 v[150:151], v232 offset:320
    ds_read_b64_tr_b16 v[152:153], v233 offset:640
    ds_read_b64_tr_b16 v[154:155], v233 offset:800
    ds_read_b64_tr_b16 v[156:157], v232 offset:1280
    ds_read_b64_tr_b16 v[158:159], v232 offset:1600
    ds_read_b64_tr_b16 v[160:161], v233 offset:1280
    ds_read_b64_tr_b16 v[162:163], v233 offset:1440
    ds_read_b64_tr_b16 v[164:165], v232 offset:2560
    ds_read_b64_tr_b16 v[166:167], v232 offset:2880
    ds_read_b64_tr_b16 v[168:169], v233 offset:1920
    ds_read_b64_tr_b16 v[170:171], v233 offset:2080
    ds_read_b64_tr_b16 v[172:173], v232 offset:3840
    ds_read_b64_tr_b16 v[174:175], v232 offset:4160
    s_waitcnt lgkmcnt(12)
    v_mfma_f32_32x32x16_bf16 v[192:207], v[148:151], v[144:147], 0
    ds_read_b64_tr_b16 v[176:177], v233 offset:2560
    ds_read_b64_tr_b16 v[178:179], v233 offset:2720
    ds_read_b64_tr_b16 v[180:181], v232 offset:5120
    ds_read_b64_tr_b16 v[182:183], v232 offset:5440
    s_waitcnt lgkmcnt(12)
    v_mfma_f32_32x32x16_bf16 v[192:207], v[156:159], v[152:155], v[192:207]
    ds_read_b64_tr_b16 v[184:185], v233 offset:3200
    ds_read_b64_tr_b16 v[186:187], v233 offset:3360
    ds_read_b64_tr_b16 v[188:189], v232 offset:6400
    ds_read_b64_tr_b16 v[190:191], v232 offset:6720
    s_waitcnt lgkmcnt(12)
    v_mfma_f32_32x32x16_bf16 v[192:207], v[164:167], v[160:163], v[192:207]
    ds_read_b64_tr_b16 v[144:145], v233 offset:3840
    ds_read_b64_tr_b16 v[146:147], v233 offset:4000
    ds_read_b64_tr_b16 v[148:149], v232 offset:7680
    ds_read_b64_tr_b16 v[150:151], v232 offset:8000
    s_waitcnt lgkmcnt(12)
    v_mfma_f32_32x32x16_bf16 v[192:207], v[172:175], v[168:171], v[192:207]
    ds_read_b64_tr_b16 v[152:153], v233 offset:4480
    ds_read_b64_tr_b16 v[154:155], v233 offset:4640
    ds_read_b64_tr_b16 v[156:157], v232 offset:8960
    ds_read_b64_tr_b16 v[158:159], v232 offset:9280
    s_waitcnt lgkmcnt(12)
    v_mfma_f32_32x32x16_bf16 v[192:207], v[180:183], v[176:179], v[192:207]
    s_waitcnt lgkmcnt(8)
    v_mfma_f32_32x32x16_bf16 v[192:207], v[188:191], v[184:187], v[192:207]
    s_waitcnt lgkmcnt(4)
    v_mfma_f32_32x32x16_bf16 v[192:207], v[148:151], v[144:147], v[192:207]
    s_waitcnt lgkmcnt(0)
    v_mfma_f32_32x32x16_bf16 v[192:207], v[156:159], v[152:155], v[192:207]
    s_waitcnt vmcnt(0)
    s_branch L_ck_20
L_rt_19:
    buffer_load_dwordx4 v[8:11], v18, s[44:47], s85 offen sc1
    buffer_load_dwordx4 v[12:15], v18, s[44:47], s85 offen offset:1024 sc1
    buffer_load_dwordx4 v[20:23], v18, s[44:47], s85 offen offset:2048 sc1
    buffer_load_dwordx2 v[26:27], v25, s[44:47], s85 offen offset:3072 sc1
    s_waitcnt vmcnt(0)
L_ck_20:
    v_xor_b32 v24, v11, v252
    v_bitop3_b32 v24, v24, v15, v252 bitop3:0xf6
    v_bitop3_b32 v24, v24, v23, v252 bitop3:0xf6
    v_bitop3_b32 v24, v24, v27, v252 bitop3:0xf6
    v_cmp_ne_u32 vcc, 0, v24
    s_cbranch_vccz L_ok_21
    s_sub_u32 s84, s84, 1
    s_cmp_gt_i32 s84, 0
    s_cbranch_scc1 L_rt_19
L_ok_21:
    v_mov_b32 v254, v26
    ds_read_b128 v[24:27], v18
    ds_read_b128 v[40:43], v3
    ds_read_b32 v28, v4
    ds_read_b128 v[32:35], v5
    ds_read_b128 v[36:39], v5 offset:608
    v_mov_b32 v46, 0
    v_mov_b32 v47, 0
    v_mov_b32 v11, v20
    v_mov_b32 v15, v21
    v_mov_b32 v16, v22
    v_mfma_f32_32x32x4_2b_bf16 v[48:79], v[46:47], v[46:47], 0
    s_waitcnt lgkmcnt(4)
    v_mfma_f32_32x32x16_bf16 v[112:127], v[24:27], v[8:11], 0
    v_mfma_f32_32x32x16_bf16 v[128:143], v[24:27], v[12:15], 0
    s_waitcnt lgkmcnt(2)
    v_mfma_f32_32x32x16_bf16 v[80:95], v[40:43], v[8:11], 0
    v_mfma_f32_32x32x16_bf16 v[96:111], v[40:43], v[12:15], 0
    ds_read_b128 v[24:27], v3 offset:4736
    ds_read_b32 v30, v4 offset:4736
    v_mov_b32 v204, v195
    v_mov_b32 v205, v199
    v_mov_b32 v206, v203
    s_cmp_eq_u32 s50, 0
    s_cbranch_scc1 L_g_22
    v_mov_b32 v198, v195
L_g_22:
    v_mov_b32 v195, v252
    v_mov_b32 v199, v252
    v_mov_b32 v203, v252
    v_mov_b32 v207, v252
    v_max3_f32 v44, v112, v113, v114
    v_max3_f32 v44, v44, v115, v116
    v_max3_f32 v44, v44, v117, v118
    v_max3_f32 v44, v44, v119, v120
    v_max3_f32 v44, v44, v121, v122
    v_max3_f32 v44, v44, v123, v124
    v_max3_f32 v44, v44, v125, v126
    v_max_f32 v44, v44, v127
    v_max3_f32 v45, v128, v129, v130
    v_max3_f32 v45, v45, v131, v132
    v_max3_f32 v45, v45, v133, v134
    v_max3_f32 v45, v45, v135, v136
    v_max3_f32 v45, v45, v137, v138
    v_max3_f32 v45, v45, v139, v140
    v_max3_f32 v45, v45, v141, v142
    v_max_f32 v45, v45, v143
    s_nop 1
    v_permlane32_swap_b32 v44, v45
    v_min_f32 v44, -v44, -v45
    v_and_b32 v45, 0xffff0000, v44
    v_sub_f32 v44, v44, v45
    v_cvt_pk_bf16_f32 v17, v45, v44
    s_nop 1
    v_mfma_f32_32x32x4_2b_bf16 v[80:111], v[28:29], v[16:17], v[80:111]
    s_mov_b32 exec_lo, 0x7ffff
    s_mov_b32 exec_hi, 0x7ffff
    buffer_store_dwordx4 v[192:195], v239, s[44:47], s55 offen offset:0 sc1
    buffer_store_dwordx4 v[196:199], v239, s[44:47], s55 offen offset:608 sc1
    s_cmp_lg_u32 s50, 0
    s_cbranch_scc1 L_g_23
    buffer_store_dwordx4 v[200:203], v239, s[44:47], s55 offen offset:1216 sc1
    buffer_store_dwordx4 v[204:207], v239, s[44:47], s55 offen offset:1824 sc1
L_g_23:
    s_mov_b64 exec, -1
L_phase2:
    s_cmp_lg_u32 s50, 0
    s_nop 15
    s_nop 1
    s_cbranch_scc1 L_stream1
    s_setprio 1
    v_exp_f32 v80, v80
    v_exp_f32 v81, v81
    v_exp_f32 v82, v82
    v_exp_f32 v83, v83
    s_waitcnt lgkmcnt(0)
    s_mov_b32 m0, s88
    s_add_u32 s88, s88, 4096
    buffer_load_dwordx4 v18, s[44:47], s97 offen sc1 lds
    s_add_u32 s97, s97, 4096
    s_sub_u32 s60, s97, 151552
    s_min_u32 s97, s97, s60
    v_exp_f32 v84, v84
    v_exp_f32 v85, v85
    v_exp_f32 v86, v86
    v_exp_f32 v87, v87
    v_mfma_f32_32x32x4_2b_bf16 v[112:143], v[30:31], v[16:17], 0
    v_exp_f32 v88, v88
    v_exp_f32 v89, v89
    v_exp_f32 v90, v90
    v_exp_f32 v91, v91
    v_exp_f32 v92, v92
    v_exp_f32 v93, v93
    v_exp_f32 v94, v94
    v_exp_f32 v95, v95
    v_smfmac_f32_32x32x32_bf16 v[48:63], v[32:35], v[80:87], v2
    ds_read_b128 v[20:23], v3 offset:9472
    s_mov_b32 m0, s88
    s_add_u32 s88, s88, 4096
    buffer_load_dwordx4 v18, s[44:47], s97 offen sc1 lds
    s_add_u32 s97, s97, 4096
    s_sub_u32 s60, s97, 151552
    s_min_u32 s97, s97, s60
    v_exp_f32 v96, v96
    v_exp_f32 v97, v97
    v_exp_f32 v98, v98
    v_exp_f32 v99, v99
    v_smfmac_f32_32x32x32_bf16 v[48:63], v[36:39], v[88:95], v2
    ds_read_b32 v28, v4 offset:9472
    s_setprio 0
    v_exp_f32 v100, v100
    v_exp_f32 v101, v101
    v_exp_f32 v102, v102
    v_exp_f32 v103, v103
    v_mfma_f32_32x32x16_bf16 v[112:127], v[24:27], v[8:11], v[112:127]
    ds_read_b128 v[40:43], v5 offset:4736
    s_setprio 1
    s_mov_b32 m0, s88
    s_add_u32 s88, s88, 4096
    buffer_load_dwordx4 v18, s[44:47], s97 offen sc1 lds
    s_add_u32 s97, s97, 4096
    s_sub_u32 s60, s97, 151552
    s_min_u32 s97, s97, s60
    v_exp_f32 v104, v104
    v_exp_f32 v105, v105
    v_exp_f32 v106, v106
    v_exp_f32 v107, v107
    v_smfmac_f32_32x32x32_bf16 v[64:79], v[32:35], v[96:103], v2
    ds_read_b128 v[44:47], v5 offset:5344
    v_exp_f32 v108, v108
    v_exp_f32 v109, v109
    v_exp_f32 v110, v110
    v_exp_f32 v111, v111
    v_mfma_f32_32x32x16_bf16 v[128:143], v[24:27], v[12:15], v[128:143]
    v_exp_f32 v112, v112
    v_exp_f32 v113, v113
    v_exp_f32 v114, v114
    v_exp_f32 v115, v115
    v_smfmac_f32_32x32x32_bf16 v[64:79], v[36:39], v[104:111], v2
    s_waitcnt lgkmcnt(0)
    s_mov_b32 m0, s88
    s_add_u32 s88, s88, 4096
    buffer_load_dwordx4 v18, s[44:47], s97 offen sc1 lds
    s_add_u32 s97, s97, 4096
    s_sub_u32 s60, s97, 151552
    s_min_u32 s97, s97, s60
    v_exp_f32 v116, v116
    v_exp_f32 v117, v117
    v_exp_f32 v118, v118
    v_exp_f32 v119, v119
    v_mfma_f32_32x32x4_2b_bf16 v[80:111], v[28:29], v[16:17], 0
    v_exp_f32 v120, v120
    v_exp_f32 v121, v121
    v_exp_f32 v122, v122
    v_exp_f32 v123, v123
    v_exp_f32 v124, v124
    v_exp_f32 v125, v125
    v_exp_f32 v126, v126
    v_exp_f32 v127, v127
    v_smfmac_f32_32x32x32_bf16 v[48:63], v[40:43], v[112:119], v2
    ds_read_b128 v[24:27], v3 offset:14208
    s_mov_b32 m0, s88
    s_add_u32 s88, s88, 4096
    buffer_load_dwordx4 v18, s[44:47], s97 offen sc1 lds
    s_add_u32 s97, s97, 4096
    s_sub_u32 s60, s97, 151552
    s_min_u32 s97, s97, s60
    v_exp_f32 v128, v128
    v_exp_f32 v129, v129
    v_exp_f32 v130, v130
    v_exp_f32 v131, v131
    v_smfmac_f32_32x32x32_bf16 v[48:63], v[44:47], v[120:127], v2
    ds_read_b32 v30, v4 offset:14208
    s_setprio 0
    v_exp_f32 v132, v132
    v_exp_f32 v133, v133
    v_exp_f32 v134, v134
    v_exp_f32 v135, v135
    v_mfma_f32_32x32x16_bf16 v[80:95], v[20:23], v[8:11], v[80:95]
    ds_read_b128 v[32:35], v5 offset:9472
    s_setprio 1
    s_mov_b32 m0, s88
    s_add_u32 s88, s88, 4096
    buffer_load_dwordx4 v18, s[44:47], s97 offen sc1 lds
    s_add_u32 s97, s97, 4096
    s_sub_u32 s60, s97, 151552
    s_min_u32 s97, s97, s60
    v_exp_f32 v136, v136
    v_exp_f32 v137, v137
    v_exp_f32 v138, v138
    v_exp_f32 v139, v139
    v_smfmac_f32_32x32x32_bf16 v[64:79], v[40:43], v[128:135], v2
    ds_read_b128 v[36:39], v5 offset:10080
    v_exp_f32 v140, v140
    v_exp_f32 v141, v141
    v_exp_f32 v142, v142
    v_exp_f32 v143, v143
    v_mfma_f32_32x32x16_bf16 v[96:111], v[20:23], v[12:15], v[96:111]
    v_exp_f32 v80, v80
    v_exp_f32 v81, v81
    v_exp_f32 v82, v82
    v_exp_f32 v83, v83
    v_smfmac_f32_32x32x32_bf16 v[64:79], v[44:47], v[136:143], v2
    s_waitcnt lgkmcnt(0)
    s_mov_b32 m0, s88
    s_add_u32 s88, s88, 4096
    buffer_load_dwordx4 v18, s[44:47], s97 offen sc1 lds
    s_add_u32 s97, s97, 4096
    s_sub_u32 s60, s97, 151552
    s_min_u32 s97, s97, s60
    v_exp_f32 v84, v84
    v_exp_f32 v85, v85
    v_exp_f32 v86, v86
    v_exp_f32 v87, v87
    v_mfma_f32_32x32x4_2b_bf16 v[112:143], v[30:31], v[16:17], 0
    v_exp_f32 v88, v88
    v_exp_f32 v89, v89
    v_exp_f32 v90, v90
    v_exp_f32 v91, v91
    v_exp_f32 v92, v92
    v_exp_f32 v93, v93
    v_exp_f32 v94, v94
    v_exp_f32 v95, v95
    v_smfmac_f32_32x32x32_bf16 v[48:63], v[32:35], v[80:87], v2
    ds_read_b128 v[20:23], v3 offset:18944
    s_mov_b32 m0, s88
    s_add_u32 s88, s88, 4096
    buffer_load_dwordx4 v18, s[44:47], s97 offen sc1 lds
    s_add_u32 s97, s97, 4096
    s_sub_u32 s60, s97, 151552
    s_min_u32 s97, s97, s60
    v_exp_f32 v96, v96
    v_exp_f32 v97, v97
    v_exp_f32 v98, v98
    v_exp_f32 v99, v99
    v_smfmac_f32_32x32x32_bf16 v[48:63], v[36:39], v[88:95], v2
    ds_read_b32 v28, v4 offset:18944
    s_setprio 0
    v_exp_f32 v100, v100
    v_exp_f32 v101, v101
    v_exp_f32 v102, v102
    v_exp_f32 v103, v103
    v_mfma_f32_32x32x16_bf16 v[112:127], v[24:27], v[8:11], v[112:127]
    ds_read_b128 v[40:43], v5 offset:14208
    s_setprio 1
    s_mov_b32 m0, s88
    s_add_u32 s88, s88, 4096
    buffer_load_dwordx4 v18, s[44:47], s97 offen sc1 lds
    s_add_u32 s97, s97, 4096
    s_sub_u32 s60, s97, 151552
    s_min_u32 s97, s97, s60
    v_exp_f32 v104, v104
    v_exp_f32 v105, v105
    v_exp_f32 v106, v106
    v_exp_f32 v107, v107
    v_smfmac_f32_32x32x32_bf16 v[64:79], v[32:35], v[96:103], v2
    ds_read_b128 v[44:47], v5 offset:14816
    v_exp_f32 v108, v108
    v_exp_f32 v109, v109
    v_exp_f32 v110, v110
    v_exp_f32 v111, v111
    v_mfma_f32_32x32x16_bf16 v[128:143], v[24:27], v[12:15], v[128:143]
    v_exp_f32 v112, v112
    v_exp_f32 v113, v113
    v_exp_f32 v114, v114
    v_exp_f32 v115, v115
    v_smfmac_f32_32x32x32_bf16 v[64:79], v[36:39], v[104:111], v2
    s_waitcnt lgkmcnt(0)
    s_mov_b32 m0, s88
    s_add_u32 s88, s88, 4096
    buffer_load_dwordx4 v18, s[44:47], s97 offen sc1 lds
    s_add_u32 s97, s97, 4096
    s_sub_u32 s60, s97, 151552
    s_min_u32 s97, s97, s60
    v_exp_f32 v116, v116
    v_exp_f32 v117, v117
    v_exp_f32 v118, v118
    v_exp_f32 v119, v119
    v_mfma_f32_32x32x4_2b_bf16 v[80:111], v[28:29], v[16:17], 0
    v_exp_f32 v120, v120
    v_exp_f32 v121, v121
    v_exp_f32 v122, v122
    v_exp_f32 v123, v123
    v_exp_f32 v124, v124
    v_exp_f32 v125, v125
    v_exp_f32 v126, v126
    v_exp_f32 v127, v127
    v_smfmac_f32_32x32x32_bf16 v[48:63], v[40:43], v[112:119], v2
    ds_read_b128 v[24:27], v3 offset:23680
    s_mov_b32 m0, s88
    s_add_u32 s88, s88, 4096
    buffer_load_dwordx4 v18, s[44:47], s97 offen sc1 lds
    s_add_u32 s97, s97, 4096
    s_sub_u32 s60, s97, 151552
    s_min_u32 s97, s97, s60
    v_exp_f32 v128, v128
    v_exp_f32 v129, v129
    v_exp_f32 v130, v130
    v_exp_f32 v131, v131
    v_smfmac_f32_32x32x32_bf16 v[48:63], v[44:47], v[120:127], v2
    ds_read_b32 v30, v4 offset:23680
    s_setprio 0
    v_exp_f32 v132, v132
    v_exp_f32 v133, v133
    v_exp_f32 v134, v134
    v_exp_f32 v135, v135
    v_mfma_f32_32x32x16_bf16 v[80:95], v[20:23], v[8:11], v[80:95]
    ds_read_b128 v[32:35], v5 offset:18944
    s_setprio 1
    s_mov_b32 m0, s88
    s_add_u32 s88, s88, 4096
    buffer_load_dwordx4 v18, s[44:47], s97 offen sc1 lds
    s_add_u32 s97, s97, 4096
    s_sub_u32 s60, s97, 151552
    s_min_u32 s97, s97, s60
    v_exp_f32 v136, v136
    v_exp_f32 v137, v137
    v_exp_f32 v138, v138
    v_exp_f32 v139, v139
    v_smfmac_f32_32x32x32_bf16 v[64:79], v[40:43], v[128:135], v2
    ds_read_b128 v[36:39], v5 offset:19552
    v_exp_f32 v140, v140
    v_exp_f32 v141, v141
    v_exp_f32 v142, v142
    v_exp_f32 v143, v143
    v_mfma_f32_32x32x16_bf16 v[96:111], v[20:23], v[12:15], v[96:111]
    v_exp_f32 v80, v80
    v_exp_f32 v81, v81
    v_exp_f32 v82, v82
    v_exp_f32 v83, v83
    v_smfmac_f32_32x32x32_bf16 v[64:79], v[44:47], v[136:143], v2
    s_waitcnt lgkmcnt(0)
    s_mov_b32 s56, 0
    v_mov_b32 v236, 0
    s_mul_i32 s59, s49, s53
    s_cmp_lt_u32 s59, 2
    s_cbranch_scc1 L_g_24
    s_lshr_b32 s13, s2, 1
    s_cmp_eq_u32 s49, 2
    s_cselect_b32 s59, 128, 0
    s_add_u32 s13, s13, s59
    s_mul_i32 s59, s13, 171
    s_lshr_b32 s59, s59, 10
    s_mul_i32 s56, s59, 59392
    s_mul_i32 s59, s59, 6
    s_sub_u32 s60, s13, s59
    s_lshr_b32 s59, s60, 1
    s_mul_i32 s59, s59, 1216
    s_and_b32 s60, s60, 1
    s_mul_i32 s60, s60, 304
    s_add_u32 s56, s56, s59
    s_add_u32 s56, s56, s60
    s_add_u32 s56, s56, 3604480
    v_subrev_u32 v236, 4, v7
    v_cmp_lt_u32 vcc, 19, v7
    s_cmp_lt_u32 s13, 192
    s_cselect_b32 s56, s56, 0
    v_cndmask_b32 v236, v7, v236, vcc
    v_min_u32 v236, 18, v236
    v_mad_u32_u24 v236, v6, 38, v236
    v_lshlrev_b32 v236, 4, v236
L_g_24:
    v_exp_f32 v84, v84
    v_exp_f32 v85, v85
    v_exp_f32 v86, v86
    v_exp_f32 v87, v87
    v_mfma_f32_32x32x4_2b_bf16 v[112:143], v[30:31], v[16:17], 0
    v_exp_f32 v88, v88
    v_exp_f32 v89, v89
    v_exp_f32 v90, v90
    v_exp_f32 v91, v91
    v_exp_f32 v92, v92
    v_exp_f32 v93, v93
    v_exp_f32 v94, v94
    v_exp_f32 v95, v95
    v_smfmac_f32_32x32x32_bf16 v[48:63], v[32:35], v[80:87], v2
    ds_read_b128 v[20:23], v3 offset:28416
    v_exp_f32 v96, v96
    v_exp_f32 v97, v97
    v_exp_f32 v98, v98
    v_exp_f32 v99, v99
    v_smfmac_f32_32x32x32_bf16 v[48:63], v[36:39], v[88:95], v2
    ds_read_b32 v28, v4 offset:28416
    s_setprio 0
    v_exp_f32 v100, v100
    v_exp_f32 v101, v101
    v_exp_f32 v102, v102
    v_exp_f32 v103, v103
    v_mfma_f32_32x32x16_bf16 v[112:127], v[24:27], v[8:11], v[112:127]
    ds_read_b128 v[40:43], v5 offset:23680
    s_setprio 1
    v_exp_f32 v104, v104
    v_exp_f32 v105, v105
    v_exp_f32 v106, v106
    v_exp_f32 v107, v107
    v_smfmac_f32_32x32x32_bf16 v[64:79], v[32:35], v[96:103], v2
    ds_read_b128 v[44:47], v5 offset:24288
    v_exp_f32 v108, v108
    v_exp_f32 v109, v109
    v_exp_f32 v110, v110
    v_exp_f32 v111, v111
    v_mfma_f32_32x32x16_bf16 v[128:143], v[24:27], v[12:15], v[128:143]
    v_exp_f32 v112, v112
    v_exp_f32 v113, v113
    v_exp_f32 v114, v114
    v_exp_f32 v115, v115
    v_smfmac_f32_32x32x32_bf16 v[64:79], v[36:39], v[104:111], v2
    s_waitcnt lgkmcnt(0)
    v_exp_f32 v116, v116
    v_exp_f32 v117, v117
    v_exp_f32 v118, v118
    v_exp_f32 v119, v119
    v_mfma_f32_32x32x4_2b_bf16 v[80:111], v[28:29], v[16:17], 0
    v_exp_f32 v120, v120
    v_exp_f32 v121, v121
    v_exp_f32 v122, v122
    v_exp_f32 v123, v123
    v_exp_f32 v124, v124
    v_exp_f32 v125, v125
    v_exp_f32 v126, v126
    v_exp_f32 v127, v127
    v_smfmac_f32_32x32x32_bf16 v[48:63], v[40:43], v[112:119], v2
    ds_read_b128 v[24:27], v3 offset:33152
    s_lshr_b32 s57, s2, 3
    s_lshl_b32 s57, s57, 2
    s_add_u32 s57, s57, s49
    s_mul_i32 s57, s57, 5184
    v_mul_u32_u24 v237, 81, v1
    buffer_load_ubyte v238, v237, s[32:35], s57 offen
    v_exp_f32 v128, v128
    v_exp_f32 v129, v129
    v_exp_f32 v130, v130
    v_exp_f32 v131, v131
    v_smfmac_f32_32x32x32_bf16 v[48:63], v[44:47], v[120:127], v2
    ds_read_b32 v30, v4 offset:33152
    s_setprio 0
    v_exp_f32 v132, v132
    v_exp_f32 v133, v133
    v_exp_f32 v134, v134
    v_exp_f32 v135, v135
    v_mfma_f32_32x32x16_bf16 v[80:95], v[20:23], v[8:11], v[80:95]
    ds_read_b128 v[32:35], v5 offset:28416
    s_setprio 1
    v_exp_f32 v136, v136
    v_exp_f32 v137, v137
    v_exp_f32 v138, v138
    v_exp_f32 v139, v139
    v_smfmac_f32_32x32x32_bf16 v[64:79], v[40:43], v[128:135], v2
    ds_read_b128 v[36:39], v5 offset:29024
    v_exp_f32 v140, v140
    v_exp_f32 v141, v141
    v_exp_f32 v142, v142
    v_exp_f32 v143, v143
    v_mfma_f32_32x32x16_bf16 v[96:111], v[20:23], v[12:15], v[96:111]
    v_exp_f32 v80, v80
    v_exp_f32 v81, v81
    v_exp_f32 v82, v82
    v_exp_f32 v83, v83
    v_smfmac_f32_32x32x32_bf16 v[64:79], v[44:47], v[136:143], v2
    s_waitcnt lgkmcnt(0)
    v_exp_f32 v84, v84
    v_exp_f32 v85, v85
    v_exp_f32 v86, v86
    v_exp_f32 v87, v87
    v_mfma_f32_32x32x4_2b_bf16 v[112:143], v[30:31], v[16:17], 0
    v_exp_f32 v88, v88
    v_exp_f32 v89, v89
    v_exp_f32 v90, v90
    v_exp_f32 v91, v91
    v_exp_f32 v92, v92
    v_exp_f32 v93, v93
    v_exp_f32 v94, v94
    v_exp_f32 v95, v95
    v_smfmac_f32_32x32x32_bf16 v[48:63], v[32:35], v[80:87], v2
    ds_read_b128 v[20:23], v3 offset:37888
    v_exp_f32 v96, v96
    v_exp_f32 v97, v97
    v_exp_f32 v98, v98
    v_exp_f32 v99, v99
    v_smfmac_f32_32x32x32_bf16 v[48:63], v[36:39], v[88:95], v2
    ds_read_b32 v28, v4 offset:37888
    s_setprio 0
    v_exp_f32 v100, v100
    v_exp_f32 v101, v101
    v_exp_f32 v102, v102
    v_exp_f32 v103, v103
    v_mfma_f32_32x32x16_bf16 v[112:127], v[24:27], v[8:11], v[112:127]
    ds_read_b128 v[40:43], v5 offset:33152
    s_setprio 1
    v_exp_f32 v104, v104
    v_exp_f32 v105, v105
    v_exp_f32 v106, v106
    v_exp_f32 v107, v107
    v_smfmac_f32_32x32x32_bf16 v[64:79], v[32:35], v[96:103], v2
    ds_read_b128 v[44:47], v5 offset:33760
    v_exp_f32 v108, v108
    v_exp_f32 v109, v109
    v_exp_f32 v110, v110
    v_exp_f32 v111, v111
    v_mfma_f32_32x32x16_bf16 v[128:143], v[24:27], v[12:15], v[128:143]
    v_exp_f32 v112, v112
    v_exp_f32 v113, v113
    v_exp_f32 v114, v114
    v_exp_f32 v115, v115
    v_smfmac_f32_32x32x32_bf16 v[64:79], v[36:39], v[104:111], v2
    s_waitcnt lgkmcnt(0)
    v_exp_f32 v116, v116
    v_exp_f32 v117, v117
    v_exp_f32 v118, v118
    v_exp_f32 v119, v119
    v_mfma_f32_32x32x4_2b_bf16 v[80:111], v[28:29], v[16:17], 0
    v_exp_f32 v120, v120
    v_exp_f32 v121, v121
    v_exp_f32 v122, v122
    v_exp_f32 v123, v123
    v_exp_f32 v124, v124
    v_exp_f32 v125, v125
    v_exp_f32 v126, v126
    v_exp_f32 v127, v127
    v_smfmac_f32_32x32x32_bf16 v[48:63], v[40:43], v[112:119], v2
    ds_read_b128 v[24:27], v3 offset:42624
    v_exp_f32 v128, v128
    v_exp_f32 v129, v129
    v_exp_f32 v130, v130
    v_exp_f32 v131, v131
    v_smfmac_f32_32x32x32_bf16 v[48:63], v[44:47], v[120:127], v2
    ds_read_b32 v30, v4 offset:42624
    s_setprio 0
    v_exp_f32 v132, v132
    v_exp_f32 v133, v133
    v_exp_f32 v134, v134
    v_exp_f32 v135, v135
    v_mfma_f32_32x32x16_bf16 v[80:95], v[20:23], v[8:11], v[80:95]
    ds_read_b128 v[32:35], v5 offset:37888
    s_setprio 1
    v_exp_f32 v136, v136
    v_exp_f32 v137, v137
    v_exp_f32 v138, v138
    v_exp_f32 v139, v139
    v_smfmac_f32_32x32x32_bf16 v[64:79], v[40:43], v[128:135], v2
    ds_read_b128 v[36:39], v5 offset:38496
    v_exp_f32 v140, v140
    v_exp_f32 v141, v141
    v_exp_f32 v142, v142
    v_exp_f32 v143, v143
    v_mfma_f32_32x32x16_bf16 v[96:111], v[20:23], v[12:15], v[96:111]
    s_waitcnt vmcnt(1)
    s_barrier
    v_exp_f32 v80, v80
    v_exp_f32 v81, v81
    v_exp_f32 v82, v82
    v_exp_f32 v83, v83
    v_smfmac_f32_32x32x32_bf16 v[64:79], v[44:47], v[136:143], v2
    s_waitcnt lgkmcnt(0)
    s_cmp_lt_u32 s56, 0x10000
    s_cbranch_scc1 L_g_25
    s_mov_b32 s59, s56
    buffer_load_dwordx4 v[144:147], v236, s[44:47], s59 offen offset:0 sc1
    buffer_load_dwordx4 v[148:151], v236, s[44:47], s59 offen offset:3712 sc1
    s_add_u32 s59, s59, 7424
    buffer_load_dwordx4 v[152:155], v236, s[44:47], s59 offen offset:0 sc1
    buffer_load_dwordx4 v[156:159], v236, s[44:47], s59 offen offset:3712 sc1
    s_add_u32 s59, s59, 7424
    buffer_load_dwordx4 v[160:163], v236, s[44:47], s59 offen offset:0 sc1
    buffer_load_dwordx4 v[164:167], v236, s[44:47], s59 offen offset:3712 sc1
    s_add_u32 s59, s59, 7424
    buffer_load_dwordx4 v[168:171], v236, s[44:47], s59 offen offset:0 sc1
    buffer_load_dwordx4 v[172:175], v236, s[44:47], s59 offen offset:3712 sc1
    s_add_u32 s59, s59, 7424
    buffer_load_dwordx4 v[176:179], v236, s[44:47], s59 offen offset:0 sc1
    buffer_load_dwordx4 v[180:183], v236, s[44:47], s59 offen offset:3712 sc1
    s_add_u32 s59, s59, 7424
    buffer_load_dwordx4 v[184:187], v236, s[44:47], s59 offen offset:0 sc1
    buffer_load_dwordx4 v[188:191], v236, s[44:47], s59 offen offset:3712 sc1
    s_add_u32 s59, s59, 7424
    buffer_load_dwordx4 v[192:195], v236, s[44:47], s59 offen offset:0 sc1
    buffer_load_dwordx4 v[196:199], v236, s[44:47], s59 offen offset:3712 sc1
    s_add_u32 s59, s59, 7424
    buffer_load_dwordx4 v[200:203], v236, s[44:47], s59 offen offset:0 sc1
    buffer_load_dwordx4 v[204:207], v236, s[44:47], s59 offen offset:3712 sc1
L_g_25:
    v_exp_f32 v84, v84
    v_exp_f32 v85, v85
    v_exp_f32 v86, v86
    v_exp_f32 v87, v87
    v_mfma_f32_32x32x4_2b_bf16 v[112:143], v[30:31], v[16:17], 0
    v_exp_f32 v88, v88
    v_exp_f32 v89, v89
    v_exp_f32 v90, v90
    v_exp_f32 v91, v91
    v_exp_f32 v92, v92
    v_exp_f32 v93, v93
    v_exp_f32 v94, v94
    v_exp_f32 v95, v95
    v_smfmac_f32_32x32x32_bf16 v[48:63], v[32:35], v[80:87], v2
    ds_read_b128 v[20:23], v3 offset:47360
    s_cmp_lg_u32 s53, 0
    s_cbranch_scc1 L_g_26
    s_lshl_b32 s57, s12, 4
    s_add_u32 s57, s57, s81
    s_mul_i32 s57, s57, 6144
    s_add_u32 s57, s57, 5603328
    v_mul_u32_u24 v237, 48, v1
    buffer_load_dword v238, v237, s[44:47], s57 offen sc1
L_g_26:
    v_exp_f32 v96, v96
    v_exp_f32 v97, v97
    v_exp_f32 v98, v98
    v_exp_f32 v99, v99
    v_smfmac_f32_32x32x32_bf16 v[48:63], v[36:39], v[88:95], v2
    ds_read_b32 v28, v4 offset:47360
    s_setprio 0
    v_exp_f32 v100, v100
    v_exp_f32 v101, v101
    v_exp_f32 v102, v102
    v_exp_f32 v103, v103
    v_mfma_f32_32x32x16_bf16 v[112:127], v[24:27], v[8:11], v[112:127]
    ds_read_b128 v[40:43], v5 offset:42624
    s_setprio 1
    v_exp_f32 v104, v104
    v_exp_f32 v105, v105
    v_exp_f32 v106, v106
    v_exp_f32 v107, v107
    v_smfmac_f32_32x32x32_bf16 v[64:79], v[32:35], v[96:103], v2
    ds_read_b128 v[44:47], v5 offset:43232
    v_exp_f32 v108, v108
    v_exp_f32 v109, v109
    v_exp_f32 v110, v110
    v_exp_f32 v111, v111
    v_mfma_f32_32x32x16_bf16 v[128:143], v[24:27], v[12:15], v[128:143]
    v_exp_f32 v112, v112
    v_exp_f32 v113, v113
    v_exp_f32 v114, v114
    v_exp_f32 v115, v115
    v_smfmac_f32_32x32x32_bf16 v[64:79], v[36:39], v[104:111], v2
    s_waitcnt lgkmcnt(0)
    v_exp_f32 v116, v116
    v_exp_f32 v117, v117
    v_exp_f32 v118, v118
    v_exp_f32 v119, v119
    v_mfma_f32_32x32x4_2b_bf16 v[80:111], v[28:29], v[16:17], 0
    v_exp_f32 v120, v120
    v_exp_f32 v121, v121
    v_exp_f32 v122, v122
    v_exp_f32 v123, v123
    v_exp_f32 v124, v124
    v_exp_f32 v125, v125
    v_exp_f32 v126, v126
    v_exp_f32 v127, v127
    v_smfmac_f32_32x32x32_bf16 v[48:63], v[40:43], v[112:119], v2
    ds_read_b128 v[24:27], v3 offset:52096
    v_exp_f32 v128, v128
    v_exp_f32 v129, v129
    v_exp_f32 v130, v130
    v_exp_f32 v131, v131
    v_smfmac_f32_32x32x32_bf16 v[48:63], v[44:47], v[120:127], v2
    ds_read_b32 v30, v4 offset:52096
    s_setprio 0
    v_exp_f32 v132, v132
    v_exp_f32 v133, v133
    v_exp_f32 v134, v134
    v_exp_f32 v135, v135
    v_mfma_f32_32x32x16_bf16 v[80:95], v[20:23], v[8:11], v[80:95]
    ds_read_b128 v[32:35], v5 offset:47360
    s_setprio 1
    v_exp_f32 v136, v136
    v_exp_f32 v137, v137
    v_exp_f32 v138, v138
    v_exp_f32 v139, v139
    v_smfmac_f32_32x32x32_bf16 v[64:79], v[40:43], v[128:135], v2
    ds_read_b128 v[36:39], v5 offset:47968
    v_exp_f32 v140, v140
    v_exp_f32 v141, v141
    v_exp_f32 v142, v142
    v_exp_f32 v143, v143
    v_mfma_f32_32x32x16_bf16 v[96:111], v[20:23], v[12:15], v[96:111]
    v_exp_f32 v80, v80
    v_exp_f32 v81, v81
    v_exp_f32 v82, v82
    v_exp_f32 v83, v83
    v_smfmac_f32_32x32x32_bf16 v[64:79], v[44:47], v[136:143], v2
    s_waitcnt lgkmcnt(0)
    v_exp_f32 v84, v84
    v_exp_f32 v85, v85
    v_exp_f32 v86, v86
    v_exp_f32 v87, v87
    v_mfma_f32_32x32x4_2b_bf16 v[112:143], v[30:31], v[16:17], 0
    v_exp_f32 v88, v88
    v_exp_f32 v89, v89
    v_exp_f32 v90, v90
    v_exp_f32 v91, v91
    v_exp_f32 v92, v92
    v_exp_f32 v93, v93
    v_exp_f32 v94, v94
    v_exp_f32 v95, v95
    v_smfmac_f32_32x32x32_bf16 v[48:63], v[32:35], v[80:87], v2
    ds_read_b128 v[20:23], v3 offset:56832
    v_exp_f32 v96, v96
    v_exp_f32 v97, v97
    v_exp_f32 v98, v98
    v_exp_f32 v99, v99
    v_smfmac_f32_32x32x32_bf16 v[48:63], v[36:39], v[88:95], v2
    ds_read_b32 v28, v4 offset:56832
    s_setprio 0
    s_cmp_lt_u32 s56, 0x10000
    s_cbranch_scc1 L_g_27
    s_waitcnt vmcnt(0)
    s_branch L_ck_29
L_rt_28:
    s_mov_b32 s59, s56
    buffer_load_dwordx4 v[144:147], v236, s[44:47], s59 offen offset:0 sc1
    buffer_load_dwordx4 v[148:151], v236, s[44:47], s59 offen offset:3712 sc1
    s_add_u32 s59, s59, 7424
    buffer_load_dwordx4 v[152:155], v236, s[44:47], s59 offen offset:0 sc1
    buffer_load_dwordx4 v[156:159], v236, s[44:47], s59 offen offset:3712 sc1
    s_add_u32 s59, s59, 7424
    buffer_load_dwordx4 v[160:163], v236, s[44:47], s59 offen offset:0 sc1
    buffer_load_dwordx4 v[164:167], v236, s[44:47], s59 offen offset:3712 sc1
    s_add_u32 s59, s59, 7424
    buffer_load_dwordx4 v[168:171], v236, s[44:47], s59 offen offset:0 sc1
    buffer_load_dwordx4 v[172:175], v236, s[44:47], s59 offen offset:3712 sc1
    s_add_u32 s59, s59, 7424
    buffer_load_dwordx4 v[176:179], v236, s[44:47], s59 offen offset:0 sc1
    buffer_load_dwordx4 v[180:183], v236, s[44:47], s59 offen offset:3712 sc1
    s_add_u32 s59, s59, 7424
    buffer_load_dwordx4 v[184:187], v236, s[44:47], s59 offen offset:0 sc1
    buffer_load_dwordx4 v[188:191], v236, s[44:47], s59 offen offset:3712 sc1
    s_add_u32 s59, s59, 7424
    buffer_load_dwordx4 v[192:195], v236, s[44:47], s59 offen offset:0 sc1
    buffer_load_dwordx4 v[196:199], v236, s[44:47], s59 offen offset:3712 sc1
    s_add_u32 s59, s59, 7424
    buffer_load_dwordx4 v[200:203], v236, s[44:47], s59 offen offset:0 sc1
    buffer_load_dwordx4 v[204:207], v236, s[44:47], s59 offen offset:3712 sc1
    s_waitcnt vmcnt(0)
L_ck_29:
    v_xor_b32 v237, v147, v252
    v_bitop3_b32 v237, v237, v151, v252 bitop3:0xf6
    v_bitop3_b32 v237, v237, v155, v252 bitop3:0xf6
    v_bitop3_b32 v237, v237, v159, v252 bitop3:0xf6
    v_bitop3_b32 v237, v237, v163, v252 bitop3:0xf6
    v_bitop3_b32 v237, v237, v167, v252 bitop3:0xf6
    v_bitop3_b32 v237, v237, v171, v252 bitop3:0xf6
    v_bitop3_b32 v237, v237, v175, v252 bitop3:0xf6
    v_bitop3_b32 v237, v237, v179, v252 bitop3:0xf6
    v_bitop3_b32 v237, v237, v183, v252 bitop3:0xf6
    v_bitop3_b32 v237, v237, v187, v252 bitop3:0xf6
    v_bitop3_b32 v237, v237, v191, v252 bitop3:0xf6
    v_bitop3_b32 v237, v237, v195, v252 bitop3:0xf6
    v_bitop3_b32 v237, v237, v199, v252 bitop3:0xf6
    v_bitop3_b32 v237, v237, v203, v252 bitop3:0xf6
    v_bitop3_b32 v237, v237, v207, v252 bitop3:0xf6
    v_cmp_ne_u32 vcc, 0, v237
    s_cbranch_vccz L_ok_30
    s_sub_u32 s84, s84, 1
    s_cmp_gt_i32 s84, 0
    s_cbranch_scc1 L_rt_28
L_ok_30:
    v_add_f32 v144, v144, v176
    v_add_f32 v145, v145, v177
    v_add_f32 v146, v146, v178
    v_add_f32 v148, v148, v180
    v_add_f32 v149, v149, v181
    v_add_f32 v150, v150, v182
    v_add_f32 v152, v152, v184
    v_add_f32 v153, v153, v185
    v_add_f32 v154, v154, v186
    v_add_f32 v156, v156, v188
    v_add_f32 v157, v157, v189
    v_add_f32 v158, v158, v190
    v_add_f32 v160, v160, v192
    v_add_f32 v161, v161, v193
    v_add_f32 v162, v162, v194
    v_add_f32 v164, v164, v196
    v_add_f32 v165, v165, v197
    v_add_f32 v166, v166, v198
    v_add_f32 v168, v168, v200
    v_add_f32 v169, v169, v201
    v_add_f32 v170, v170, v202
    v_add_f32 v172, v172, v204
    v_add_f32 v173, v173, v205
    v_add_f32 v174, v174, v206
    v_add_f32 v144, v144, v160
    v_add_f32 v145, v145, v161
    v_add_f32 v146, v146, v162
    v_add_f32 v148, v148, v164
    v_add_f32 v149, v149, v165
    v_add_f32 v150, v150, v166
    v_add_f32 v152, v152, v168
    v_add_f32 v153, v153, v169
    v_add_f32 v154, v154, v170
    v_add_f32 v156, v156, v172
    v_add_f32 v157, v157, v173
    v_add_f32 v158, v158, v174
    v_add_f32 v144, v144, v152
    v_add_f32 v145, v145, v153
    v_add_f32 v146, v146, v154
    v_add_f32 v148, v148, v156
    v_add_f32 v149, v149, v157
    v_add_f32 v150, v150, v158
    v_add_f32 v144, v144, v148
    v_add_f32 v145, v145, v149
    v_add_f32 v146, v146, v150
    v_mov_b32 v148, v144
    v_mov_b32 v149, v145
    v_mov_b32 v150, v146
    s_lshl_b32 s59, s13, 9
    s_add_u32 s59, s59, 5505024
    v_permlane32_swap_b32 v144, v148
    v_permlane32_swap_b32 v145, v149
    v_permlane32_swap_b32 v146, v150
    v_cvt_pk_bf16_f32 v144, v144, v148
    v_cvt_pk_bf16_f32 v145, v145, v149
    v_cvt_pk_bf16_f32 v146, v146, v150
    s_mov_b32 exec_hi, 0
    buffer_store_dwordx4 v[144:147], v18, s[44:47], s59 offen sc1
    s_mov_b64 exec, -1
L_g_27:
    v_exp_f32 v100, v100
    v_exp_f32 v101, v101
    v_exp_f32 v102, v102
    v_exp_f32 v103, v103
    v_mfma_f32_32x32x16_bf16 v[112:127], v[24:27], v[8:11], v[112:127]
    ds_read_b128 v[40:43], v5 offset:52096
    s_setprio 1
    v_exp_f32 v104, v104
    v_exp_f32 v105, v105
    v_exp_f32 v106, v106
    v_exp_f32 v107, v107
    v_smfmac_f32_32x32x32_bf16 v[64:79], v[32:35], v[96:103], v2
    ds_read_b128 v[44:47], v5 offset:52704
    v_exp_f32 v108, v108
    v_exp_f32 v109, v109
    v_exp_f32 v110, v110
    v_exp_f32 v111, v111
    v_mfma_f32_32x32x16_bf16 v[128:143], v[24:27], v[12:15], v[128:143]
    v_exp_f32 v112, v112
    v_exp_f32 v113, v113
    v_exp_f32 v114, v114
    v_exp_f32 v115, v115
    v_smfmac_f32_32x32x32_bf16 v[64:79], v[36:39], v[104:111], v2
    s_waitcnt lgkmcnt(0)
    s_mov_b32 m0, s88
    s_add_u32 s88, s88, 4096
    buffer_load_dwordx4 v18, s[44:47], s97 offen sc1 lds
    s_add_u32 s97, s97, 4096
    s_sub_u32 s60, s97, 151552
    s_min_u32 s97, s97, s60
    v_exp_f32 v116, v116
    v_exp_f32 v117, v117
    v_exp_f32 v118, v118
    v_exp_f32 v119, v119
    v_mfma_f32_32x32x4_2b_bf16 v[80:111], v[28:29], v[16:17], 0
    v_exp_f32 v120, v120
    v_exp_f32 v121, v121
    v_exp_f32 v122, v122
    v_exp_f32 v123, v123
    v_exp_f32 v124, v124
    v_exp_f32 v125, v125
    v_exp_f32 v126, v126
    v_exp_f32 v127, v127
    v_smfmac_f32_32x32x32_bf16 v[48:63], v[40:43], v[112:119], v2
    ds_read_b128 v[24:27], v3 offset:61568
    s_mov_b32 m0, s88
    s_add_u32 s88, s88, 4096
    buffer_load_dwordx4 v18, s[44:47], s97 offen sc1 lds
    s_add_u32 s97, s97, 4096
    s_sub_u32 s60, s97, 151552
    s_min_u32 s97, s97, s60
    v_exp_f32 v128, v128
    v_exp_f32 v129, v129
    v_exp_f32 v130, v130
    v_exp_f32 v131, v131
    v_smfmac_f32_32x32x32_bf16 v[48:63], v[44:47], v[120:127], v2
    ds_read_b32 v30, v4 offset:61568
    s_setprio 0
    v_exp_f32 v132, v132
    v_exp_f32 v133, v133
    v_exp_f32 v134, v134
    v_exp_f32 v135, v135
    v_mfma_f32_32x32x16_bf16 v[80:95], v[20:23], v[8:11], v[80:95]
    ds_read_b128 v[32:35], v5 offset:56832
    s_setprio 1
    s_mov_b32 m0, s88
    s_add_u32 s88, s88, 4096
    buffer_load_dwordx4 v18, s[44:47], s97 offen sc1 lds
    s_add_u32 s97, s97, 4096
    s_sub_u32 s60, s97, 151552
    s_min_u32 s97, s97, s60
    v_exp_f32 v136, v136
    v_exp_f32 v137, v137
    v_exp_f32 v138, v138
    v_exp_f32 v139, v139
    v_smfmac_f32_32x32x32_bf16 v[64:79], v[40:43], v[128:135], v2
    ds_read_b128 v[36:39], v5 offset:57440
    v_exp_f32 v140, v140
    v_exp_f32 v141, v141
    v_exp_f32 v142, v142
    v_exp_f32 v143, v143
    v_mfma_f32_32x32x16_bf16 v[96:111], v[20:23], v[12:15], v[96:111]
    s_mov_b32 m0, s88
    s_add_u32 s88, s88, 4096
    buffer_load_dwordx4 v18, s[44:47], s97 offen sc1 lds
    s_add_u32 s97, s97, 4096
    s_sub_u32 s60, s97, 151552
    s_min_u32 s97, s97, s60
    v_add_u32 v3, 56832, v3
    v_add_u32 v4, 56832, v4
    s_mov_b32 s57, 56832
    v_mad_u32_u24 v5, v253, s57, v5
    v_exp_f32 v80, v80
    v_exp_f32 v81, v81
    v_exp_f32 v82, v82
    v_exp_f32 v83, v83
    v_smfmac_f32_32x32x32_bf16 v[64:79], v[44:47], v[136:143], v2
    s_waitcnt lgkmcnt(0)
    s_mov_b32 m0, s88
    s_add_u32 s88, s88, 4096
    buffer_load_dwordx4 v18, s[44:47], s97 offen sc1 lds
    s_add_u32 s97, s97, 4096
    s_sub_u32 s60, s97, 151552
    s_min_u32 s97, s97, s60
    v_exp_f32 v84, v84
    v_exp_f32 v85, v85
    v_exp_f32 v86, v86
    v_exp_f32 v87, v87
    v_mfma_f32_32x32x4_2b_bf16 v[112:143], v[30:31], v[16:17], 0
    v_exp_f32 v88, v88
    v_exp_f32 v89, v89
    v_exp_f32 v90, v90
    v_exp_f32 v91, v91
    v_exp_f32 v92, v92
    v_exp_f32 v93, v93
    v_exp_f32 v94, v94
    v_exp_f32 v95, v95
    v_smfmac_f32_32x32x32_bf16 v[48:63], v[32:35], v[80:87], v2
    ds_read_b128 v[20:23], v3 offset:9472
    s_mov_b32 m0, s88
    s_add_u32 s88, s88, 4096
    buffer_load_dwordx4 v18, s[44:47], s97 offen sc1 lds
    s_add_u32 s97, s97, 4096
    s_sub_u32 s60, s97, 151552
    s_min_u32 s97, s97, s60
    v_exp_f32 v96, v96
    v_exp_f32 v97, v97
    v_exp_f32 v98, v98
    v_exp_f32 v99, v99
    v_smfmac_f32_32x32x32_bf16 v[48:63], v[36:39], v[88:95], v2
    ds_read_b32 v28, v4 offset:9472
    s_setprio 0
    v_exp_f32 v100, v100
    v_exp_f32 v101, v101
    v_exp_f32 v102, v102
    v_exp_f32 v103, v103
    v_mfma_f32_32x32x16_bf16 v[112:127], v[24:27], v[8:11], v[112:127]
    ds_read_b128 v[40:43], v5 offset:4736
    s_setprio 1
    s_mov_b32 m0, s88
    s_add_u32 s88, s88, 4096
    buffer_load_dwordx4 v18, s[44:47], s97 offen sc1 lds
    s_add_u32 s97, s97, 4096
    s_sub_u32 s60, s97, 151552
    s_min_u32 s97, s97, s60
    v_exp_f32 v104, v104
    v_exp_f32 v105, v105
    v_exp_f32 v106, v106
    v_exp_f32 v107, v107
    v_smfmac_f32_32x32x32_bf16 v[64:79], v[32:35], v[96:103], v2
    ds_read_b128 v[44:47], v5 offset:5344
    v_exp_f32 v108, v108
    v_exp_f32 v109, v109
    v_exp_f32 v110, v110
    v_exp_f32 v111, v111
    v_mfma_f32_32x32x16_bf16 v[128:143], v[24:27], v[12:15], v[128:143]
    s_mov_b32 m0, s88
    s_add_u32 s88, s88, 4096
    buffer_load_dwordx4 v18, s[44:47], s97 offen sc1 lds
    s_add_u32 s97, s97, 4096
    s_sub_u32 s60, s97, 151552
    s_min_u32 s97, s97, s60
    v_exp_f32 v112, v112
    v_exp_f32 v113, v113
    v_exp_f32 v114, v114
    v_exp_f32 v115, v115
    v_smfmac_f32_32x32x32_bf16 v[64:79], v[36:39], v[104:111], v2
    s_waitcnt lgkmcnt(0)
    s_mov_b32 m0, s88
    s_add_u32 s88, s88, 4096
    buffer_load_dwordx4 v18, s[44:47], s97 offen sc1 lds
    s_add_u32 s97, s97, 4096
    s_sub_u32 s60, s97, 151552
    s_min_u32 s97, s97, s60
    v_exp_f32 v116, v116
    v_exp_f32 v117, v117
    v_exp_f32 v118, v118
    v_exp_f32 v119, v119
    v_mfma_f32_32x32x4_2b_bf16 v[80:111], v[28:29], v[16:17], 0
    v_exp_f32 v120, v120
    v_exp_f32 v121, v121
    v_exp_f32 v122, v122
    v_exp_f32 v123, v123
    v_exp_f32 v124, v124
    v_exp_f32 v125, v125
    v_exp_f32 v126, v126
    v_exp_f32 v127, v127
    v_smfmac_f32_32x32x32_bf16 v[48:63], v[40:43], v[112:119], v2
    ds_read_b128 v[24:27], v3 offset:14208
    s_mov_b32 m0, s88
    s_add_u32 s88, s88, 4096
    buffer_load_dwordx4 v18, s[44:47], s97 offen sc1 lds
    s_add_u32 s97, s97, 4096
    s_sub_u32 s60, s97, 151552
    s_min_u32 s97, s97, s60
    v_exp_f32 v128, v128
    v_exp_f32 v129, v129
    v_exp_f32 v130, v130
    v_exp_f32 v131, v131
    v_smfmac_f32_32x32x32_bf16 v[48:63], v[44:47], v[120:127], v2
    ds_read_b32 v30, v4 offset:14208
    s_setprio 0
    v_exp_f32 v132, v132
    v_exp_f32 v133, v133
    v_exp_f32 v134, v134
    v_exp_f32 v135, v135
    v_mfma_f32_32x32x16_bf16 v[80:95], v[20:23], v[8:11], v[80:95]
    ds_read_b128 v[32:35], v5 offset:9472
    s_setprio 1
    s_mov_b32 m0, s88
    s_add_u32 s88, s88, 4096
    buffer_load_dwordx4 v18, s[44:47], s97 offen sc1 lds
    s_add_u32 s97, s97, 4096
    s_sub_u32 s60, s97, 151552
    s_min_u32 s97, s97, s60
    v_exp_f32 v136, v136
    v_exp_f32 v137, v137
    v_exp_f32 v138, v138
    v_exp_f32 v139, v139
    v_smfmac_f32_32x32x32_bf16 v[64:79], v[40:43], v[128:135], v2
    ds_read_b128 v[36:39], v5 offset:10080
    v_exp_f32 v140, v140
    v_exp_f32 v141, v141
    v_exp_f32 v142, v142
    v_exp_f32 v143, v143
    v_mfma_f32_32x32x16_bf16 v[96:111], v[20:23], v[12:15], v[96:111]
    s_mov_b32 m0, s88
    s_add_u32 s88, s88, 4096
    buffer_load_dwordx4 v18, s[44:47], s97 offen sc1 lds
    s_add_u32 s97, s97, 4096
    s_sub_u32 s60, s97, 151552
    s_min_u32 s97, s97, s60
    v_exp_f32 v80, v80
    v_exp_f32 v81, v81
    v_exp_f32 v82, v82
    v_exp_f32 v83, v83
    v_smfmac_f32_32x32x32_bf16 v[64:79], v[44:47], v[136:143], v2
    s_waitcnt lgkmcnt(0)
    v_exp_f32 v84, v84
    v_exp_f32 v85, v85
    v_exp_f32 v86, v86
    v_exp_f32 v87, v87
    v_mfma_f32_32x32x4_2b_bf16 v[112:143], v[30:31], v[16:17], 0
    v_exp_f32 v88, v88
    v_exp_f32 v89, v89
    v_exp_f32 v90, v90
    v_exp_f32 v91, v91
    v_exp_f32 v92, v92
    v_exp_f32 v93, v93
    v_exp_f32 v94, v94
    v_exp_f32 v95, v95
    v_smfmac_f32_32x32x32_bf16 v[48:63], v[32:35], v[80:87], v2
    ds_read_b128 v[20:23], v3 offset:18944
    s_lshl_b32 s57, s12, 4
    s_add_u32 s57, s57, s81
    s_mul_i32 s57, s57, 6144
    s_add_u32 s57, s57, 5606400
    v_mul_u32_u24 v237, 48, v1
    buffer_load_dword v238, v237, s[44:47], s57 offen sc1
    v_exp_f32 v96, v96
    v_exp_f32 v97, v97
    v_exp_f32 v98, v98
    v_exp_f32 v99, v99
    v_smfmac_f32_32x32x32_bf16 v[48:63], v[36:39], v[88:95], v2
    ds_read_b32 v28, v4 offset:18944
    s_setprio 0
    v_exp_f32 v100, v100
    v_exp_f32 v101, v101
    v_exp_f32 v102, v102
    v_exp_f32 v103, v103
    v_mfma_f32_32x32x16_bf16 v[112:127], v[24:27], v[8:11], v[112:127]
    ds_read_b128 v[40:43], v5 offset:14208
    s_setprio 1
    v_exp_f32 v104, v104
    v_exp_f32 v105, v105
    v_exp_f32 v106, v106
    v_exp_f32 v107, v107
    v_smfmac_f32_32x32x32_bf16 v[64:79], v[32:35], v[96:103], v2
    ds_read_b128 v[44:47], v5 offset:14816
    v_exp_f32 v108, v108
    v_exp_f32 v109, v109
    v_exp_f32 v110, v110
    v_exp_f32 v111, v111
    v_mfma_f32_32x32x16_bf16 v[128:143], v[24:27], v[12:15], v[128:143]
    v_exp_f32 v112, v112
    v_exp_f32 v113, v113
    v_exp_f32 v114, v114
    v_exp_f32 v115, v115
    v_smfmac_f32_32x32x32_bf16 v[64:79], v[36:39], v[104:111], v2
    s_waitcnt lgkmcnt(0)
    v_exp_f32 v116, v116
    v_exp_f32 v117, v117
    v_exp_f32 v118, v118
    v_exp_f32 v119, v119
    v_mfma_f32_32x32x4_2b_bf16 v[80:111], v[28:29], v[16:17], 0
    v_exp_f32 v120, v120
    v_exp_f32 v121, v121
    v_exp_f32 v122, v122
    v_exp_f32 v123, v123
    v_exp_f32 v124, v124
    v_exp_f32 v125, v125
    v_exp_f32 v126, v126
    v_exp_f32 v127, v127
    v_smfmac_f32_32x32x32_bf16 v[48:63], v[40:43], v[112:119], v2
    ds_read_b128 v[24:27], v3 offset:23680
    s_lshr_b32 s57, s2, 3
    s_lshl_b32 s57, s57, 2
    s_add_u32 s57, s57, s49
    s_mul_i32 s57, s57, 5184
    v_mul_u32_u24 v237, 81, v1
    buffer_load_ubyte v238, v237, s[36:39], s57 offen
    v_exp_f32 v128, v128
    v_exp_f32 v129, v129
    v_exp_f32 v130, v130
    v_exp_f32 v131, v131
    v_smfmac_f32_32x32x32_bf16 v[48:63], v[44:47], v[120:127], v2
    ds_read_b32 v30, v4 offset:23680
    s_setprio 0
    v_exp_f32 v132, v132
    v_exp_f32 v133, v133
    v_exp_f32 v134, v134
    v_exp_f32 v135, v135
    v_mfma_f32_32x32x16_bf16 v[80:95], v[20:23], v[8:11], v[80:95]
    ds_read_b128 v[32:35], v5 offset:18944
    s_setprio 1
    v_exp_f32 v136, v136
    v_exp_f32 v137, v137
    v_exp_f32 v138, v138
    v_exp_f32 v139, v139
    v_smfmac_f32_32x32x32_bf16 v[64:79], v[40:43], v[128:135], v2
    ds_read_b128 v[36:39], v5 offset:19552
    v_exp_f32 v140, v140
    v_exp_f32 v141, v141
    v_exp_f32 v142, v142
    v_exp_f32 v143, v143
    v_mfma_f32_32x32x16_bf16 v[96:111], v[20:23], v[12:15], v[96:111]
    v_exp_f32 v80, v80
    v_exp_f32 v81, v81
    v_exp_f32 v82, v82
    v_exp_f32 v83, v83
    v_smfmac_f32_32x32x32_bf16 v[64:79], v[44:47], v[136:143], v2
    s_waitcnt lgkmcnt(0)
    v_exp_f32 v84, v84
    v_exp_f32 v85, v85
    v_exp_f32 v86, v86
    v_exp_f32 v87, v87
    v_mfma_f32_32x32x4_2b_bf16 v[112:143], v[30:31], v[16:17], 0
    v_exp_f32 v88, v88
    v_exp_f32 v89, v89
    v_exp_f32 v90, v90
    v_exp_f32 v91, v91
    v_exp_f32 v92, v92
    v_exp_f32 v93, v93
    v_exp_f32 v94, v94
    v_exp_f32 v95, v95
    v_smfmac_f32_32x32x32_bf16 v[48:63], v[32:35], v[80:87], v2
    ds_read_b128 v[20:23], v3 offset:28416
    v_exp_f32 v96, v96
    v_exp_f32 v97, v97
    v_exp_f32 v98, v98
    v_exp_f32 v99, v99
    v_smfmac_f32_32x32x32_bf16 v[48:63], v[36:39], v[88:95], v2
    ds_read_b32 v28, v4 offset:28416
    s_setprio 0
    v_exp_f32 v100, v100
    v_exp_f32 v101, v101
    v_exp_f32 v102, v102
    v_exp_f32 v103, v103
    v_mfma_f32_32x32x16_bf16 v[112:127], v[24:27], v[8:11], v[112:127]
    ds_read_b128 v[40:43], v5 offset:23680
    s_setprio 1
    v_exp_f32 v104, v104
    v_exp_f32 v105, v105
    v_exp_f32 v106, v106
    v_exp_f32 v107, v107
    v_smfmac_f32_32x32x32_bf16 v[64:79], v[32:35], v[96:103], v2
    ds_read_b128 v[44:47], v5 offset:24288
    v_exp_f32 v108, v108
    v_exp_f32 v109, v109
    v_exp_f32 v110, v110
    v_exp_f32 v111, v111
    v_mfma_f32_32x32x16_bf16 v[128:143], v[24:27], v[12:15], v[128:143]
    v_exp_f32 v112, v112
    v_exp_f32 v113, v113
    v_exp_f32 v114, v114
    v_exp_f32 v115, v115
    v_smfmac_f32_32x32x32_bf16 v[64:79], v[36:39], v[104:111], v2
    s_waitcnt lgkmcnt(0)
    v_exp_f32 v116, v116
    v_exp_f32 v117, v117
    v_exp_f32 v118, v118
    v_exp_f32 v119, v119
    v_mfma_f32_32x32x4_2b_bf16 v[80:111], v[28:29], v[16:17], 0
    v_exp_f32 v120, v120
    v_exp_f32 v121, v121
    v_exp_f32 v122, v122
    v_exp_f32 v123, v123
    v_exp_f32 v124, v124
    v_exp_f32 v125, v125
    v_exp_f32 v126, v126
    v_exp_f32 v127, v127
    v_smfmac_f32_32x32x32_bf16 v[48:63], v[40:43], v[112:119], v2
    ds_read_b128 v[24:27], v3 offset:33152
    v_exp_f32 v128, v128
    v_exp_f32 v129, v129
    v_exp_f32 v130, v130
    v_exp_f32 v131, v131
    v_smfmac_f32_32x32x32_bf16 v[48:63], v[44:47], v[120:127], v2
    ds_read_b32 v30, v4 offset:33152
    s_setprio 0
    v_exp_f32 v132, v132
    v_exp_f32 v133, v133
    v_exp_f32 v134, v134
    v_exp_f32 v135, v135
    v_mfma_f32_32x32x16_bf16 v[80:95], v[20:23], v[8:11], v[80:95]
    ds_read_b128 v[32:35], v5 offset:28416
    s_setprio 1
    v_exp_f32 v136, v136
    v_exp_f32 v137, v137
    v_exp_f32 v138, v138
    v_exp_f32 v139, v139
    v_smfmac_f32_32x32x32_bf16 v[64:79], v[40:43], v[128:135], v2
    ds_read_b128 v[36:39], v5 offset:29024
    v_exp_f32 v140, v140
    v_exp_f32 v141, v141
    v_exp_f32 v142, v142
    v_exp_f32 v143, v143
    v_mfma_f32_32x32x16_bf16 v[96:111], v[20:23], v[12:15], v[96:111]
    s_waitcnt vmcnt(0)
    s_barrier
    v_exp_f32 v80, v80
    v_exp_f32 v81, v81
    v_exp_f32 v82, v82
    v_exp_f32 v83, v83
    v_smfmac_f32_32x32x32_bf16 v[64:79], v[44:47], v[136:143], v2
    s_waitcnt lgkmcnt(0)
    s_cmp_lg_u32 s53, 0
    s_cbranch_scc1 L_g_31
    s_mul_i32 s59, s86, 6144
    s_add_u32 s59, s59, 5505024
    buffer_load_dwordx4 v[144:147], v18, s[44:47], s59 offen offset:0 sc1
    buffer_load_dwordx4 v[148:151], v18, s[44:47], s59 offen offset:1024 sc1
    buffer_load_dwordx4 v[152:155], v18, s[44:47], s59 offen offset:2048 sc1
    s_add_u32 s59, s59, 3072
    buffer_load_dwordx4 v[156:159], v18, s[44:47], s59 offen offset:0 sc1
    buffer_load_dwordx4 v[160:163], v18, s[44:47], s59 offen offset:1024 sc1
    buffer_load_dwordx4 v[164:167], v18, s[44:47], s59 offen offset:2048 sc1
L_g_31:
    s_cmp_eq_u32 s49, 3
    s_cbranch_scc1 L_g_32
    s_add_u32 m0, s75, 0
    s_add_u32 s57, s89, 0
    buffer_load_dwordx4 v240, s[32:35], s57 offen lds
L_g_32:
    v_exp_f32 v84, v84
    v_exp_f32 v85, v85
    v_exp_f32 v86, v86
    v_exp_f32 v87, v87
    v_mfma_f32_32x32x4_2b_bf16 v[112:143], v[30:31], v[16:17], 0
    v_exp_f32 v88, v88
    v_exp_f32 v89, v89
    v_exp_f32 v90, v90
    v_exp_f32 v91, v91
    v_exp_f32 v92, v92
    v_exp_f32 v93, v93
    v_exp_f32 v94, v94
    v_exp_f32 v95, v95
    v_smfmac_f32_32x32x32_bf16 v[48:63], v[32:35], v[80:87], v2
    ds_read_b128 v[20:23], v3 offset:37888
    s_cmp_eq_u32 s49, 3
    s_cbranch_scc1 L_g_33
    s_add_u32 m0, s75, 3072
    s_add_u32 s57, s89, 0
    buffer_load_dwordx4 v241, s[32:35], s57 offen lds
L_g_33:
    v_exp_f32 v96, v96
    v_exp_f32 v97, v97
    v_exp_f32 v98, v98
    v_exp_f32 v99, v99
    v_smfmac_f32_32x32x32_bf16 v[48:63], v[36:39], v[88:95], v2
    ds_read_b32 v28, v4 offset:37888
    s_setprio 0
    s_cmp_eq_u32 s49, 3
    s_cbranch_scc1 L_g_34
    s_add_u32 m0, s75, 6144
    s_add_u32 s57, s89, 0
    buffer_load_dwordx4 v242, s[32:35], s57 offen lds
L_g_34:
    v_exp_f32 v100, v100
    v_exp_f32 v101, v101
    v_exp_f32 v102, v102
    v_exp_f32 v103, v103
    v_mfma_f32_32x32x16_bf16 v[112:127], v[24:27], v[8:11], v[112:127]
    ds_read_b128 v[40:43], v5 offset:33152
    s_setprio 1
    s_cmp_eq_u32 s49, 3
    s_cbranch_scc1 L_g_35
    s_add_u32 m0, s75, 9216
    s_add_u32 s57, s89, 82944
    buffer_load_dwordx4 v240, s[32:35], s57 offen lds
L_g_35:
    v_exp_f32 v104, v104
    v_exp_f32 v105, v105
    v_exp_f32 v106, v106
    v_exp_f32 v107, v107
    v_smfmac_f32_32x32x32_bf16 v[64:79], v[32:35], v[96:103], v2
    ds_read_b128 v[44:47], v5 offset:33760
    s_cmp_eq_u32 s49, 3
    s_cbranch_scc1 L_g_36
    s_add_u32 m0, s75, 12288
    s_add_u32 s57, s89, 82944
    buffer_load_dwordx4 v241, s[32:35], s57 offen lds
L_g_36:
    v_exp_f32 v108, v108
    v_exp_f32 v109, v109
    v_exp_f32 v110, v110
    v_exp_f32 v111, v111
    v_mfma_f32_32x32x16_bf16 v[128:143], v[24:27], v[12:15], v[128:143]
    s_cmp_eq_u32 s49, 3
    s_cbranch_scc1 L_g_37
    s_add_u32 m0, s75, 15360
    s_add_u32 s57, s89, 82944
    buffer_load_dwordx4 v242, s[32:35], s57 offen lds
L_g_37:
    v_exp_f32 v112, v112
    v_exp_f32 v113, v113
    v_exp_f32 v114, v114
    v_exp_f32 v115, v115
    v_smfmac_f32_32x32x32_bf16 v[64:79], v[36:39], v[104:111], v2
    s_waitcnt lgkmcnt(0)
    s_cmp_eq_u32 s49, 3
    s_cbranch_scc1 L_g_38
    s_add_u32 m0, s75, 18432
    s_add_u32 s57, s89, 165888
    buffer_load_dwordx4 v240, s[32:35], s57 offen lds
L_g_38:
    v_exp_f32 v116, v116
    v_exp_f32 v117, v117
    v_exp_f32 v118, v118
    v_exp_f32 v119, v119
    v_mfma_f32_32x32x4_2b_bf16 v[80:111], v[28:29], v[16:17], 0
    v_exp_f32 v120, v120
    v_exp_f32 v121, v121
    v_exp_f32 v122, v122
    v_exp_f32 v123, v123
    v_exp_f32 v124, v124
    v_exp_f32 v125, v125
    v_exp_f32 v126, v126
    v_exp_f32 v127, v127
    v_smfmac_f32_32x32x32_bf16 v[48:63], v[40:43], v[112:119], v2
    ds_read_b128 v[24:27], v3 offset:42624
    s_cmp_eq_u32 s49, 3
    s_cbranch_scc1 L_g_39
    s_add_u32 m0, s75, 21504
    s_add_u32 s57, s89, 165888
    buffer_load_dwordx4 v241, s[32:35], s57 offen lds
L_g_39:
    v_exp_f32 v128, v128
    v_exp_f32 v129, v129
    v_exp_f32 v130, v130
    v_exp_f32 v131, v131
    v_smfmac_f32_32x32x32_bf16 v[48:63], v[44:47], v[120:127], v2
    ds_read_b32 v30, v4 offset:42624
    s_setprio 0
    s_cmp_eq_u32 s49, 3
    s_cbranch_scc1 L_g_40
    s_add_u32 m0, s75, 24576
    s_add_u32 s57, s89, 165888
    buffer_load_dwordx4 v242, s[32:35], s57 offen lds
L_g_40:
    v_exp_f32 v132, v132
    v_exp_f32 v133, v133
    v_exp_f32 v134, v134
    v_exp_f32 v135, v135
    v_mfma_f32_32x32x16_bf16 v[80:95], v[20:23], v[8:11], v[80:95]
    ds_read_b128 v[32:35], v5 offset:37888
    s_setprio 1
    s_cmp_eq_u32 s49, 3
    s_cbranch_scc1 L_g_41
    s_add_u32 m0, s75, 27648
    s_add_u32 s57, s89, 248832
    buffer_load_dwordx4 v240, s[32:35], s57 offen lds
L_g_41:
    v_exp_f32 v136, v136
    v_exp_f32 v137, v137
    v_exp_f32 v138, v138
    v_exp_f32 v139, v139
    v_smfmac_f32_32x32x32_bf16 v[64:79], v[40:43], v[128:135], v2
    ds_read_b128 v[36:39], v5 offset:38496
    s_cmp_eq_u32 s49, 3
    s_cbranch_scc1 L_g_42
    s_add_u32 m0, s75, 30720
    s_add_u32 s57, s89, 248832
    buffer_load_dwordx4 v241, s[32:35], s57 offen lds
L_g_42:
    v_exp_f32 v140, v140
    v_exp_f32 v141, v141
    v_exp_f32 v142, v142
    v_exp_f32 v143, v143
    v_mfma_f32_32x32x16_bf16 v[96:111], v[20:23], v[12:15], v[96:111]
    s_cmp_eq_u32 s49, 3
    s_cbranch_scc1 L_g_43
    s_add_u32 m0, s75, 33792
    s_add_u32 s57, s89, 248832
    buffer_load_dwordx4 v242, s[32:35], s57 offen lds
L_g_43:
    v_exp_f32 v80, v80
    v_exp_f32 v81, v81
    v_exp_f32 v82, v82
    v_exp_f32 v83, v83
    v_smfmac_f32_32x32x32_bf16 v[64:79], v[44:47], v[136:143], v2
    s_waitcnt lgkmcnt(0)
    s_cmp_eq_u32 s49, 3
    s_cbranch_scc1 L_g_44
    s_add_u32 m0, s75, 36864
    s_add_u32 s57, s89, 331776
    buffer_load_dwordx4 v240, s[32:35], s57 offen lds
L_g_44:
    v_exp_f32 v84, v84
    v_exp_f32 v85, v85
    v_exp_f32 v86, v86
    v_exp_f32 v87, v87
    v_mfma_f32_32x32x4_2b_bf16 v[112:143], v[30:31], v[16:17], 0
    v_exp_f32 v88, v88
    v_exp_f32 v89, v89
    v_exp_f32 v90, v90
    v_exp_f32 v91, v91
    v_exp_f32 v92, v92
    v_exp_f32 v93, v93
    v_exp_f32 v94, v94
    v_exp_f32 v95, v95
    v_smfmac_f32_32x32x32_bf16 v[48:63], v[32:35], v[80:87], v2
    ds_read_b128 v[20:23], v3 offset:47360
    s_cmp_eq_u32 s49, 3
    s_cbranch_scc1 L_g_45
    s_add_u32 m0, s75, 39936
    s_add_u32 s57, s89, 331776
    buffer_load_dwordx4 v241, s[32:35], s57 offen lds
L_g_45:
    v_exp_f32 v96, v96
    v_exp_f32 v97, v97
    v_exp_f32 v98, v98
    v_exp_f32 v99, v99
    v_smfmac_f32_32x32x32_bf16 v[48:63], v[36:39], v[88:95], v2
    ds_read_b32 v28, v4 offset:47360
    s_setprio 0
    s_cmp_eq_u32 s49, 3
    s_cbranch_scc1 L_g_46
    s_add_u32 m0, s75, 43008
    s_add_u32 s57, s89, 331776
    buffer_load_dwordx4 v242, s[32:35], s57 offen lds
L_g_46:
    v_exp_f32 v100, v100
    v_exp_f32 v101, v101
    v_exp_f32 v102, v102
    v_exp_f32 v103, v103
    v_mfma_f32_32x32x16_bf16 v[112:127], v[24:27], v[8:11], v[112:127]
    ds_read_b128 v[40:43], v5 offset:42624
    s_setprio 1
    s_cmp_eq_u32 s49, 3
    s_cbranch_scc1 L_g_47
    s_add_u32 m0, s75, 46080
    s_add_u32 s57, s89, 414720
    buffer_load_dwordx4 v240, s[32:35], s57 offen lds
L_g_47:
    v_exp_f32 v104, v104
    v_exp_f32 v105, v105
    v_exp_f32 v106, v106
    v_exp_f32 v107, v107
    v_smfmac_f32_32x32x32_bf16 v[64:79], v[32:35], v[96:103], v2
    ds_read_b128 v[44:47], v5 offset:43232
    s_cmp_eq_u32 s49, 3
    s_cbranch_scc1 L_g_48
    s_add_u32 m0, s75, 49152
    s_add_u32 s57, s89, 414720
    buffer_load_dwordx4 v241, s[32:35], s57 offen lds
L_g_48:
    v_exp_f32 v108, v108
    v_exp_f32 v109, v109
    v_exp_f32 v110, v110
    v_exp_f32 v111, v111
    v_mfma_f32_32x32x16_bf16 v[128:143], v[24:27], v[12:15], v[128:143]
    s_cmp_eq_u32 s49, 3
    s_cbranch_scc1 L_g_49
    s_add_u32 m0, s75, 52224
    s_add_u32 s57, s89, 414720
    buffer_load_dwordx4 v242, s[32:35], s57 offen lds
L_g_49:
    v_exp_f32 v112, v112
    v_exp_f32 v113, v113
    v_exp_f32 v114, v114
    v_exp_f32 v115, v115
    v_smfmac_f32_32x32x32_bf16 v[64:79], v[36:39], v[104:111], v2
    s_waitcnt lgkmcnt(0)
    s_cmp_eq_u32 s49, 3
    s_cbranch_scc1 L_g_50
    s_add_u32 m0, s75, 55296
    s_add_u32 s57, s89, 497664
    buffer_load_dwordx4 v240, s[32:35], s57 offen lds
L_g_50:
    v_exp_f32 v116, v116
    v_exp_f32 v117, v117
    v_exp_f32 v118, v118
    v_exp_f32 v119, v119
    v_mfma_f32_32x32x4_2b_bf16 v[80:111], v[28:29], v[16:17], 0
    v_exp_f32 v120, v120
    v_exp_f32 v121, v121
    v_exp_f32 v122, v122
    v_exp_f32 v123, v123
    v_exp_f32 v124, v124
    v_exp_f32 v125, v125
    v_exp_f32 v126, v126
    v_exp_f32 v127, v127
    v_smfmac_f32_32x32x32_bf16 v[48:63], v[40:43], v[112:119], v2
    ds_read_b128 v[24:27], v3 offset:52096
    s_cmp_lg_u32 s53, 0
    s_cbranch_scc1 L_g_51
    s_waitcnt vmcnt(19)
    s_cmp_lg_u32 s49, 3
    s_cbranch_scc1 L_g_52
    s_waitcnt vmcnt(0)
L_g_52:
    s_branch L_ck_54
L_rt_53:
    s_mul_i32 s59, s86, 6144
    s_add_u32 s59, s59, 5505024
    buffer_load_dwordx4 v[144:147], v18, s[44:47], s59 offen offset:0 sc1
    buffer_load_dwordx4 v[148:151], v18, s[44:47], s59 offen offset:1024 sc1
    buffer_load_dwordx4 v[152:155], v18, s[44:47], s59 offen offset:2048 sc1
    s_add_u32 s59, s59, 3072
    buffer_load_dwordx4 v[156:159], v18, s[44:47], s59 offen offset:0 sc1
    buffer_load_dwordx4 v[160:163], v18, s[44:47], s59 offen offset:1024 sc1
    buffer_load_dwordx4 v[164:167], v18, s[44:47], s59 offen offset:2048 sc1
    s_waitcnt vmcnt(0)
L_ck_54:
    v_xor_b32 v237, v147, v252
    v_bitop3_b32 v237, v237, v151, v252 bitop3:0xf6
    v_bitop3_b32 v237, v237, v155, v252 bitop3:0xf6
    v_bitop3_b32 v237, v237, v159, v252 bitop3:0xf6
    v_bitop3_b32 v237, v237, v163, v252 bitop3:0xf6
    v_bitop3_b32 v237, v237, v167, v252 bitop3:0xf6
    v_cmp_ne_u32 vcc, 0, v237
    s_cbranch_vccz L_ok_55
    s_sub_u32 s84, s84, 1
    s_cmp_gt_i32 s84, 0
    s_cbranch_scc1 L_rt_53
L_ok_55:
    v_mfma_f32_32x32x16_bf16 v[168:183], v[144:147], v[212:215], 0
    v_mfma_f32_32x32x16_bf16 v[184:199], v[156:159], v[224:227], 0
    v_mfma_f32_32x32x16_bf16 v[168:183], v[148:151], v[216:219], v[168:183]
    v_mfma_f32_32x32x16_bf16 v[184:199], v[160:163], v[228:231], v[184:199]
    v_mfma_f32_32x32x16_bf16 v[168:183], v[152:155], v[220:223], v[168:183]
    v_mfma_f32_32x32x16_bf16 v[184:199], v[164:167], v[232:235], v[184:199]
L_g_51:
    s_cmp_eq_u32 s49, 3
    s_cbranch_scc1 L_g_56
    s_add_u32 m0, s75, 58368
    s_add_u32 s57, s89, 497664
    buffer_load_dwordx4 v241, s[32:35], s57 offen lds
L_g_56:
    v_exp_f32 v128, v128
    v_exp_f32 v129, v129
    v_exp_f32 v130, v130
    v_exp_f32 v131, v131
    v_smfmac_f32_32x32x32_bf16 v[48:63], v[44:47], v[120:127], v2
    ds_read_b32 v30, v4 offset:52096
    s_setprio 0
    s_cmp_eq_u32 s49, 3
    s_cbranch_scc1 L_g_57
    s_add_u32 m0, s75, 61440
    s_add_u32 s57, s89, 497664
    buffer_load_dwordx4 v242, s[32:35], s57 offen lds
L_g_57:
    v_exp_f32 v132, v132
    v_exp_f32 v133, v133
    v_exp_f32 v134, v134
    v_exp_f32 v135, v135
    v_mfma_f32_32x32x16_bf16 v[80:95], v[20:23], v[8:11], v[80:95]
    ds_read_b128 v[32:35], v5 offset:47360
    s_setprio 1
    s_cmp_eq_u32 s49, 3
    s_cbranch_scc1 L_g_58
    s_add_u32 m0, s75, 64512
    s_add_u32 s57, s89, 580608
    buffer_load_dwordx4 v240, s[32:35], s57 offen lds
L_g_58:
    v_exp_f32 v136, v136
    v_exp_f32 v137, v137
    v_exp_f32 v138, v138
    v_exp_f32 v139, v139
    v_smfmac_f32_32x32x32_bf16 v[64:79], v[40:43], v[128:135], v2
    ds_read_b128 v[36:39], v5 offset:47968
    s_cmp_eq_u32 s49, 3
    s_cbranch_scc1 L_g_59
    s_add_u32 m0, s75, 67584
    s_add_u32 s57, s89, 580608
    buffer_load_dwordx4 v241, s[32:35], s57 offen lds
L_g_59:
    v_exp_f32 v140, v140
    v_exp_f32 v141, v141
    v_exp_f32 v142, v142
    v_exp_f32 v143, v143
    v_mfma_f32_32x32x16_bf16 v[96:111], v[20:23], v[12:15], v[96:111]
    s_cmp_eq_u32 s49, 3
    s_cbranch_scc1 L_g_60
    s_add_u32 m0, s75, 70656
    s_add_u32 s57, s89, 580608
    buffer_load_dwordx4 v242, s[32:35], s57 offen lds
L_g_60:
    v_exp_f32 v80, v80
    v_exp_f32 v81, v81
    v_exp_f32 v82, v82
    v_exp_f32 v83, v83
    v_smfmac_f32_32x32x32_bf16 v[64:79], v[44:47], v[136:143], v2
    s_waitcnt lgkmcnt(0)
    s_cmp_eq_u32 s49, 3
    s_cbranch_scc1 L_g_61
    s_add_u32 m0, s75, 73728
    s_add_u32 s57, s89, 0
    buffer_load_dwordx4 v243, s[32:35], s57 offen lds
L_g_61:
    v_exp_f32 v84, v84
    v_exp_f32 v85, v85
    v_exp_f32 v86, v86
    v_exp_f32 v87, v87
    v_mfma_f32_32x32x4_2b_bf16 v[112:143], v[30:31], v[16:17], 0
    v_exp_f32 v88, v88
    v_exp_f32 v89, v89
    v_exp_f32 v90, v90
    v_exp_f32 v91, v91
    v_exp_f32 v92, v92
    v_exp_f32 v93, v93
    v_exp_f32 v94, v94
    v_exp_f32 v95, v95
    v_smfmac_f32_32x32x32_bf16 v[48:63], v[32:35], v[80:87], v2
    ds_read_b128 v[20:23], v3 offset:56832
    s_cmp_eq_u32 s49, 3
    s_cbranch_scc1 L_g_62
    s_add_u32 m0, s75, 76800
    s_add_u32 s57, s89, 0
    buffer_load_dwordx4 v244, s[32:35], s57 offen lds
L_g_62:
    v_exp_f32 v96, v96
    v_exp_f32 v97, v97
    v_exp_f32 v98, v98
    v_exp_f32 v99, v99
    v_smfmac_f32_32x32x32_bf16 v[48:63], v[36:39], v[88:95], v2
    ds_read_b32 v28, v4 offset:56832
    s_setprio 0
    s_cmp_eq_u32 s49, 3
    s_cbranch_scc1 L_g_63
    s_add_u32 m0, s75, 79872
    s_add_u32 s57, s89, 0
    buffer_load_dwordx4 v245, s[32:35], s57 offen lds
L_g_63:
    v_exp_f32 v100, v100
    v_exp_f32 v101, v101
    v_exp_f32 v102, v102
    v_exp_f32 v103, v103
    v_mfma_f32_32x32x16_bf16 v[112:127], v[24:27], v[8:11], v[112:127]
    ds_read_b128 v[40:43], v5 offset:52096
    s_setprio 1
    v_exp_f32 v104, v104
    v_exp_f32 v105, v105
    v_exp_f32 v106, v106
    v_exp_f32 v107, v107
    v_smfmac_f32_32x32x32_bf16 v[64:79], v[32:35], v[96:103], v2
    ds_read_b128 v[44:47], v5 offset:52704
    v_exp_f32 v108, v108
    v_exp_f32 v109, v109
    v_exp_f32 v110, v110
    v_exp_f32 v111, v111
    v_mfma_f32_32x32x16_bf16 v[128:143], v[24:27], v[12:15], v[128:143]
    s_cmp_lg_u32 s53, 0
    s_cbranch_scc1 L_g_64
    v_add_f32 v236, 0x358637bd, v178
    v_rcp_f32 v236, v236
    v_add_f32 v238, 0x358637bd, v194
    v_rcp_f32 v238, v238
    v_mul_f32 v236, v236, v19
    v_mul_f32 v168, v168, v236
    v_mul_f32 v169, v169, v236
    v_mul_f32 v170, v170, v236
    v_mul_f32 v171, v171, v236
    v_mul_f32 v172, v172, v236
    v_mul_f32 v173, v173, v236
    v_mul_f32 v174, v174, v236
    v_mul_f32 v175, v175, v236
    v_mul_f32 v176, v176, v236
    v_mul_f32 v177, v177, v236
    v_mul_f32 v238, v238, v19
    v_mul_f32 v184, v184, v238
    v_mul_f32 v185, v185, v238
    v_mul_f32 v186, v186, v238
    v_mul_f32 v187, v187, v238
    v_mul_f32 v188, v188, v238
    v_mul_f32 v189, v189, v238
    v_mul_f32 v190, v190, v238
    v_mul_f32 v191, v191, v238
    v_mul_f32 v192, v192, v238
    v_mul_f32 v193, v193, v238
    v_cvt_pk_bf16_f32 v144, v168, v169
    v_cvt_pk_bf16_f32 v145, v170, v171
    v_cvt_pk_bf16_f32 v146, v172, v173
    v_cvt_pk_bf16_f32 v154, v176, v177
    v_cvt_pk_bf16_f32 v155, v192, v193
    v_mov_b32 v147, v252
    s_lshl_b32 s57, s80, 4
    s_add_u32 s57, s57, s86
    s_mul_i32 s57, s57, 6144
    s_add_u32 s57, s57, 5603328
    v_cvt_pk_bf16_f32 v148, v184, v185
    v_cvt_pk_bf16_f32 v149, v186, v187
    v_cvt_pk_bf16_f32 v150, v188, v189
    v_mov_b32 v151, v252
    v_permlane32_swap_b32 v154, v155
    v_cvt_pk_bf16_f32 v152, v174, v175
    v_cvt_pk_bf16_f32 v153, v190, v191
    v_mov_b32 v155, v252
    s_bitcmp1_b32 s100, 1
    s_cbranch_scc1 L_far_65
    buffer_store_dwordx4 v[144:147], v18, s[44:47], s57 offen offset:0 nt
    buffer_store_dwordx4 v[148:151], v18, s[44:47], s57 offen offset:1024 nt
    buffer_store_dwordx4 v[152:155], v18, s[44:47], s57 offen offset:2048 nt
    s_branch L_nfd_66
L_far_65:
    buffer_store_dwordx4 v[144:147], v18, s[44:47], s57 offen offset:0 sc1
    buffer_store_dwordx4 v[148:151], v18, s[44:47], s57 offen offset:1024 sc1
    buffer_store_dwordx4 v[152:155], v18, s[44:47], s57 offen offset:2048 sc1
L_nfd_66:
L_g_64:
    v_exp_f32 v112, v112
    v_exp_f32 v113, v113
    v_exp_f32 v114, v114
    v_exp_f32 v115, v115
    v_smfmac_f32_32x32x32_bf16 v[64:79], v[36:39], v[104:111], v2
    s_waitcnt lgkmcnt(0)
    v_exp_f32 v116, v116
    v_exp_f32 v117, v117
    v_exp_f32 v118, v118
    v_exp_f32 v119, v119
    v_mfma_f32_32x32x4_2b_bf16 v[80:111], v[28:29], v[16:17], 0
    v_exp_f32 v120, v120
    v_exp_f32 v121, v121
    v_exp_f32 v122, v122
    v_exp_f32 v123, v123
    v_exp_f32 v124, v124
    v_exp_f32 v125, v125
    v_exp_f32 v126, v126
    v_exp_f32 v127, v127
    v_smfmac_f32_32x32x32_bf16 v[48:63], v[40:43], v[112:119], v2
    ds_read_b128 v[24:27], v3 offset:61568
    v_exp_f32 v128, v128
    v_exp_f32 v129, v129
    v_exp_f32 v130, v130
    v_exp_f32 v131, v131
    v_smfmac_f32_32x32x32_bf16 v[48:63], v[44:47], v[120:127], v2
    ds_read_b32 v30, v4 offset:61568
    s_setprio 0
    v_exp_f32 v132, v132
    v_exp_f32 v133, v133
    v_exp_f32 v134, v134
    v_exp_f32 v135, v135
    v_mfma_f32_32x32x16_bf16 v[80:95], v[20:23], v[8:11], v[80:95]
    ds_read_b128 v[32:35], v5 offset:56832
    s_setprio 1
    v_exp_f32 v136, v136
    v_exp_f32 v137, v137
    v_exp_f32 v138, v138
    v_exp_f32 v139, v139
    v_smfmac_f32_32x32x32_bf16 v[64:79], v[40:43], v[128:135], v2
    ds_read_b128 v[36:39], v5 offset:57440
    v_exp_f32 v140, v140
    v_exp_f32 v141, v141
    v_exp_f32 v142, v142
    v_exp_f32 v143, v143
    v_mfma_f32_32x32x16_bf16 v[96:111], v[20:23], v[12:15], v[96:111]
    s_cmp_eq_u32 s53, 0
    s_cbranch_scc1 L_g_67
    s_waitcnt vmcnt(0)
L_g_67:
    s_waitcnt vmcnt(3)
    s_barrier
    v_add_u32 v3, 56832, v3
    v_add_u32 v4, 56832, v4
    s_mov_b32 s57, 56832
    v_mad_u32_u24 v5, v253, s57, v5
    v_exp_f32 v80, v80
    v_exp_f32 v81, v81
    v_exp_f32 v82, v82
    v_exp_f32 v83, v83
    v_smfmac_f32_32x32x32_bf16 v[64:79], v[44:47], v[136:143], v2
    s_waitcnt lgkmcnt(0)
    s_mul_i32 s57, s30, 2304
    s_add_u32 s57, s57, 73728
    s_mov_b32 s64, 0xcccc3333
    s_mov_b32 s65, 0xcccc3333
    v_add_u32 v204, s57, v0
    v_and_b32 v236, 16, v1
    v_mul_u32_u24 v236, 3, v236
    v_mov_b32 v237, 163840
    s_mul_i32 s57, s30, 9216
    v_add_u32 v206, s57, v0
    v_sub_u32 v205, v204, v236
    v_sub_u32 v207, v206, v236
    v_cndmask_b32 v205, v237, v205, s[64:65]
    v_cndmask_b32 v207, v237, v207, s[64:65]
    ds_read_b64_tr_b16 v[192:193], v204 offset:0
    s_cmp_eq_u32 s49, 3
    s_cbranch_scc1 L_g_68
    s_add_u32 m0, s75, 82944
    s_add_u32 s57, s89, 0
    buffer_load_dwordx4 v246, s[36:39], s57 offen lds
L_g_68:
    v_exp_f32 v84, v84
    v_exp_f32 v85, v85
    v_exp_f32 v86, v86
    v_exp_f32 v87, v87
    v_mfma_f32_32x32x4_2b_bf16 v[112:143], v[30:31], v[16:17], 0
    v_exp_f32 v88, v88
    v_exp_f32 v89, v89
    v_exp_f32 v90, v90
    v_exp_f32 v91, v91
    v_exp_f32 v92, v92
    v_exp_f32 v93, v93
    v_exp_f32 v94, v94
    v_exp_f32 v95, v95
    v_smfmac_f32_32x32x32_bf16 v[48:63], v[32:35], v[80:87], v2
    ds_read_b128 v[20:23], v3 offset:9472
    ds_read_b64_tr_b16 v[194:195], v204 offset:144
    s_cmp_eq_u32 s49, 3
    s_cbranch_scc1 L_g_69
    s_add_u32 m0, s75, 86016
    s_add_u32 s57, s89, 0
    buffer_load_dwordx4 v247, s[36:39], s57 offen lds
L_g_69:
    v_exp_f32 v96, v96
    v_exp_f32 v97, v97
    v_exp_f32 v98, v98
    v_exp_f32 v99, v99
    v_smfmac_f32_32x32x32_bf16 v[48:63], v[36:39], v[88:95], v2
    ds_read_b32 v28, v4 offset:9472
    s_setprio 0
    ds_read_b64_tr_b16 v[196:197], v204 offset:64
    s_cmp_eq_u32 s49, 3
    s_cbranch_scc1 L_g_70
    s_add_u32 m0, s75, 89088
    s_add_u32 s57, s89, 0
    buffer_load_dwordx4 v248, s[36:39], s57 offen lds
L_g_70:
    v_exp_f32 v100, v100
    v_exp_f32 v101, v101
    v_exp_f32 v102, v102
    v_exp_f32 v103, v103
    v_mfma_f32_32x32x16_bf16 v[112:127], v[24:27], v[8:11], v[112:127]
    ds_read_b128 v[40:43], v5 offset:4736
    s_setprio 1
    ds_read_b64_tr_b16 v[198:199], v204 offset:208
    s_cmp_eq_u32 s49, 3
    s_cbranch_scc1 L_g_71
    s_add_u32 m0, s75, 92160
    s_add_u32 s57, s89, 82944
    buffer_load_dwordx4 v246, s[36:39], s57 offen lds
L_g_71:
    v_exp_f32 v104, v104
    v_exp_f32 v105, v105
    v_exp_f32 v106, v106
    v_exp_f32 v107, v107
    v_smfmac_f32_32x32x32_bf16 v[64:79], v[32:35], v[96:103], v2
    ds_read_b128 v[44:47], v5 offset:5344
    ds_read_b64_tr_b16 v[200:201], v205 offset:128
    s_cmp_eq_u32 s49, 3
    s_cbranch_scc1 L_g_72
    s_add_u32 m0, s75, 95232
    s_add_u32 s57, s89, 82944
    buffer_load_dwordx4 v247, s[36:39], s57 offen lds
L_g_72:
    v_exp_f32 v108, v108
    v_exp_f32 v109, v109
    v_exp_f32 v110, v110
    v_exp_f32 v111, v111
    v_mfma_f32_32x32x16_bf16 v[128:143], v[24:27], v[12:15], v[128:143]
    ds_read_b64_tr_b16 v[202:203], v205 offset:272
    s_cmp_eq_u32 s49, 3
    s_cbranch_scc1 L_g_73
    s_add_u32 m0, s75, 98304
    s_add_u32 s57, s89, 82944
    buffer_load_dwordx4 v248, s[36:39], s57 offen lds
L_g_73:
    v_exp_f32 v112, v112
    v_exp_f32 v113, v113
    v_exp_f32 v114, v114
    v_exp_f32 v115, v115
    v_smfmac_f32_32x32x32_bf16 v[64:79], v[36:39], v[104:111], v2
    s_waitcnt lgkmcnt(0)
    ds_read_b64_tr_b16 v[208:209], v206 offset:0
    s_cmp_eq_u32 s49, 3
    s_cbranch_scc1 L_g_74
    s_add_u32 m0, s75, 101376
    s_add_u32 s57, s89, 165888
    buffer_load_dwordx4 v246, s[36:39], s57 offen lds
L_g_74:
    v_exp_f32 v116, v116
    v_exp_f32 v117, v117
    v_exp_f32 v118, v118
    v_exp_f32 v119, v119
    v_mfma_f32_32x32x4_2b_bf16 v[80:111], v[28:29], v[16:17], 0
    v_exp_f32 v120, v120
    v_exp_f32 v121, v121
    v_exp_f32 v122, v122
    v_exp_f32 v123, v123
    v_exp_f32 v124, v124
    v_exp_f32 v125, v125
    v_exp_f32 v126, v126
    v_exp_f32 v127, v127
    v_smfmac_f32_32x32x32_bf16 v[48:63], v[40:43], v[112:119], v2
    ds_read_b128 v[24:27], v3 offset:14208
    ds_read_b64_tr_b16 v[210:211], v206 offset:144
    s_cmp_eq_u32 s49, 3
    s_cbranch_scc1 L_g_75
    s_add_u32 m0, s75, 104448
    s_add_u32 s57, s89, 165888
    buffer_load_dwordx4 v247, s[36:39], s57 offen lds
L_g_75:
    v_exp_f32 v128, v128
    v_exp_f32 v129, v129
    v_exp_f32 v130, v130
    v_exp_f32 v131, v131
    v_smfmac_f32_32x32x32_bf16 v[48:63], v[44:47], v[120:127], v2
    ds_read_b32 v30, v4 offset:14208
    s_setprio 0
    ds_read_b64_tr_b16 v[212:213], v206 offset:64
    s_cmp_eq_u32 s49, 3
    s_cbranch_scc1 L_g_76
    s_add_u32 m0, s75, 107520
    s_add_u32 s57, s89, 165888
    buffer_load_dwordx4 v248, s[36:39], s57 offen lds
L_g_76:
    v_exp_f32 v132, v132
    v_exp_f32 v133, v133
    v_exp_f32 v134, v134
    v_exp_f32 v135, v135
    v_mfma_f32_32x32x16_bf16 v[80:95], v[20:23], v[8:11], v[80:95]
    ds_read_b128 v[32:35], v5 offset:9472
    s_setprio 1
    ds_read_b64_tr_b16 v[214:215], v206 offset:208
    v_exp_f32 v136, v136
    v_exp_f32 v137, v137
    v_exp_f32 v138, v138
    v_exp_f32 v139, v139
    v_smfmac_f32_32x32x32_bf16 v[64:79], v[40:43], v[128:135], v2
    ds_read_b128 v[36:39], v5 offset:10080
    ds_read_b64_tr_b16 v[216:217], v207 offset:128
    v_exp_f32 v140, v140
    v_exp_f32 v141, v141
    v_exp_f32 v142, v142
    v_exp_f32 v143, v143
    v_mfma_f32_32x32x16_bf16 v[96:111], v[20:23], v[12:15], v[96:111]
    ds_read_b64_tr_b16 v[218:219], v207 offset:272
    v_exp_f32 v80, v80
    v_exp_f32 v81, v81
    v_exp_f32 v82, v82
    v_exp_f32 v83, v83
    v_smfmac_f32_32x32x32_bf16 v[64:79], v[44:47], v[136:143], v2
    s_waitcnt lgkmcnt(0)
    ds_read_b64_tr_b16 v[220:221], v206 offset:2304
    s_mov_b32 s58, s90
    buffer_load_dwordx4 v[144:147], v18, s[44:47], s58 offen offset:0 sc1
    v_exp_f32 v84, v84
    v_exp_f32 v85, v85
    v_exp_f32 v86, v86
    v_exp_f32 v87, v87
    v_mfma_f32_32x32x4_2b_bf16 v[112:143], v[30:31], v[16:17], 0
    v_exp_f32 v88, v88
    v_exp_f32 v89, v89
    v_exp_f32 v90, v90
    v_exp_f32 v91, v91
    v_exp_f32 v92, v92
    v_exp_f32 v93, v93
    v_exp_f32 v94, v94
    v_exp_f32 v95, v95
    v_smfmac_f32_32x32x32_bf16 v[48:63], v[32:35], v[80:87], v2
    ds_read_b128 v[20:23], v3 offset:18944
    ds_read_b64_tr_b16 v[222:223], v206 offset:2448
    buffer_load_dwordx4 v[148:151], v18, s[44:47], s58 offen offset:1024 sc1
    v_exp_f32 v96, v96
    v_exp_f32 v97, v97
    v_exp_f32 v98, v98
    v_exp_f32 v99, v99
    v_smfmac_f32_32x32x32_bf16 v[48:63], v[36:39], v[88:95], v2
    ds_read_b32 v28, v4 offset:18944
    s_setprio 0
    ds_read_b64_tr_b16 v[224:225], v206 offset:2368
    buffer_load_dwordx4 v[152:155], v18, s[44:47], s58 offen offset:2048 sc1
    s_add_u32 s58, s58, 6144
    v_exp_f32 v100, v100
    v_exp_f32 v101, v101
    v_exp_f32 v102, v102
    v_exp_f32 v103, v103
    v_mfma_f32_32x32x16_bf16 v[112:127], v[24:27], v[8:11], v[112:127]
    ds_read_b128 v[40:43], v5 offset:14208
    s_setprio 1
    ds_read_b64_tr_b16 v[226:227], v206 offset:2512
    buffer_load_dwordx4 v[156:159], v18, s[44:47], s58 offen offset:0 sc1
    v_exp_f32 v104, v104
    v_exp_f32 v105, v105
    v_exp_f32 v106, v106
    v_exp_f32 v107, v107
    v_smfmac_f32_32x32x32_bf16 v[64:79], v[32:35], v[96:103], v2
    ds_read_b128 v[44:47], v5 offset:14816
    ds_read_b64_tr_b16 v[228:229], v207 offset:2432
    buffer_load_dwordx4 v[160:163], v18, s[44:47], s58 offen offset:1024 sc1
    v_exp_f32 v108, v108
    v_exp_f32 v109, v109
    v_exp_f32 v110, v110
    v_exp_f32 v111, v111
    v_mfma_f32_32x32x16_bf16 v[128:143], v[24:27], v[12:15], v[128:143]
    ds_read_b64_tr_b16 v[230:231], v207 offset:2576
    buffer_load_dwordx4 v[164:167], v18, s[44:47], s58 offen offset:2048 sc1
    s_add_u32 s58, s58, 43008
    v_exp_f32 v112, v112
    v_exp_f32 v113, v113
    v_exp_f32 v114, v114
    v_exp_f32 v115, v115
    v_smfmac_f32_32x32x32_bf16 v[64:79], v[36:39], v[104:111], v2
    s_waitcnt lgkmcnt(0)
    buffer_load_dwordx4 v[168:171], v18, s[44:47], s58 offen offset:0 sc1
    v_exp_f32 v116, v116
    v_exp_f32 v117, v117
    v_exp_f32 v118, v118
    v_exp_f32 v119, v119
    v_mfma_f32_32x32x4_2b_bf16 v[80:111], v[28:29], v[16:17], 0
    v_exp_f32 v120, v120
    v_exp_f32 v121, v121
    v_exp_f32 v122, v122
    v_exp_f32 v123, v123
    v_exp_f32 v124, v124
    v_exp_f32 v125, v125
    v_exp_f32 v126, v126
    v_exp_f32 v127, v127
    v_smfmac_f32_32x32x32_bf16 v[48:63], v[40:43], v[112:119], v2
    ds_read_b128 v[24:27], v3 offset:23680
    buffer_load_dwordx4 v[172:175], v18, s[44:47], s58 offen offset:1024 sc1
    v_exp_f32 v128, v128
    v_exp_f32 v129, v129
    v_exp_f32 v130, v130
    v_exp_f32 v131, v131
    v_smfmac_f32_32x32x32_bf16 v[48:63], v[44:47], v[120:127], v2
    ds_read_b32 v30, v4 offset:23680
    s_setprio 0
    buffer_load_dwordx4 v[176:179], v18, s[44:47], s58 offen offset:2048 sc1
    s_add_u32 s58, s58, 6144
    v_exp_f32 v132, v132
    v_exp_f32 v133, v133
    v_exp_f32 v134, v134
    v_exp_f32 v135, v135
    v_mfma_f32_32x32x16_bf16 v[80:95], v[20:23], v[8:11], v[80:95]
    ds_read_b128 v[32:35], v5 offset:18944
    s_setprio 1
    buffer_load_dwordx4 v[180:183], v18, s[44:47], s58 offen offset:0 sc1
    v_exp_f32 v136, v136
    v_exp_f32 v137, v137
    v_exp_f32 v138, v138
    v_exp_f32 v139, v139
    v_smfmac_f32_32x32x32_bf16 v[64:79], v[40:43], v[128:135], v2
    ds_read_b128 v[36:39], v5 offset:19552
    buffer_load_dwordx4 v[184:187], v18, s[44:47], s58 offen offset:1024 sc1
    v_exp_f32 v140, v140
    v_exp_f32 v141, v141
    v_exp_f32 v142, v142
    v_exp_f32 v143, v143
    v_mfma_f32_32x32x16_bf16 v[96:111], v[20:23], v[12:15], v[96:111]
    buffer_load_dwordx4 v[188:191], v18, s[44:47], s58 offen offset:2048 sc1
    s_barrier
    v_exp_f32 v80, v80
    v_exp_f32 v81, v81
    v_exp_f32 v82, v82
    v_exp_f32 v83, v83
    v_smfmac_f32_32x32x32_bf16 v[64:79], v[44:47], v[136:143], v2
    s_waitcnt lgkmcnt(0)
    s_cmp_eq_u32 s49, 3
    s_cbranch_scc1 L_g_77
    s_add_u32 m0, s75, 110592
    s_add_u32 s57, s89, 248832
    buffer_load_dwordx4 v246, s[36:39], s57 offen lds
L_g_77:
    v_exp_f32 v84, v84
    v_exp_f32 v85, v85
    v_exp_f32 v86, v86
    v_exp_f32 v87, v87
    v_mfma_f32_32x32x4_2b_bf16 v[112:143], v[30:31], v[16:17], 0
    v_exp_f32 v88, v88
    v_exp_f32 v89, v89
    v_exp_f32 v90, v90
    v_exp_f32 v91, v91
    v_exp_f32 v92, v92
    v_exp_f32 v93, v93
    v_exp_f32 v94, v94
    v_exp_f32 v95, v95
    v_smfmac_f32_32x32x32_bf16 v[48:63], v[32:35], v[80:87], v2
    ds_read_b128 v[20:23], v3 offset:28416
    s_cmp_eq_u32 s49, 3
    s_cbranch_scc1 L_g_78
    s_add_u32 m0, s75, 113664
    s_add_u32 s57, s89, 248832
    buffer_load_dwordx4 v247, s[36:39], s57 offen lds
L_g_78:
    v_exp_f32 v96, v96
    v_exp_f32 v97, v97
    v_exp_f32 v98, v98
    v_exp_f32 v99, v99
    v_smfmac_f32_32x32x32_bf16 v[48:63], v[36:39], v[88:95], v2
    ds_read_b32 v28, v4 offset:28416
    s_setprio 0
    v_exp_f32 v100, v100
    v_exp_f32 v101, v101
    v_exp_f32 v102, v102
    v_exp_f32 v103, v103
    v_mfma_f32_32x32x16_bf16 v[112:127], v[24:27], v[8:11], v[112:127]
    ds_read_b128 v[40:43], v5 offset:23680
    s_setprio 1
    s_cmp_eq_u32 s49, 3
    s_cbranch_scc1 L_g_79
    s_add_u32 m0, s75, 116736
    s_add_u32 s57, s89, 248832
    buffer_load_dwordx4 v248, s[36:39], s57 offen lds
L_g_79:
    v_exp_f32 v104, v104
    v_exp_f32 v105, v105
    v_exp_f32 v106, v106
    v_exp_f32 v107, v107
    v_smfmac_f32_32x32x32_bf16 v[64:79], v[32:35], v[96:103], v2
    ds_read_b128 v[44:47], v5 offset:24288
    s_cmp_eq_u32 s49, 3
    s_cbranch_scc1 L_g_80
    s_add_u32 m0, s75, 119808
    s_add_u32 s57, s89, 331776
    buffer_load_dwordx4 v246, s[36:39], s57 offen lds
L_g_80:
    v_exp_f32 v108, v108
    v_exp_f32 v109, v109
    v_exp_f32 v110, v110
    v_exp_f32 v111, v111
    v_mfma_f32_32x32x16_bf16 v[128:143], v[24:27], v[12:15], v[128:143]
    s_cmp_eq_u32 s49, 3
    s_cbranch_scc1 L_g_81
    s_add_u32 m0, s75, 122880
    s_add_u32 s57, s89, 331776
    buffer_load_dwordx4 v247, s[36:39], s57 offen lds
L_g_81:
    v_exp_f32 v112, v112
    v_exp_f32 v113, v113
    v_exp_f32 v114, v114
    v_exp_f32 v115, v115
    v_smfmac_f32_32x32x32_bf16 v[64:79], v[36:39], v[104:111], v2
    s_waitcnt lgkmcnt(0)
    s_cmp_eq_u32 s49, 3
    s_cbranch_scc1 L_g_82
    s_add_u32 m0, s75, 125952
    s_add_u32 s57, s89, 331776
    buffer_load_dwordx4 v248, s[36:39], s57 offen lds
L_g_82:
    v_exp_f32 v116, v116
    v_exp_f32 v117, v117
    v_exp_f32 v118, v118
    v_exp_f32 v119, v119
    v_mfma_f32_32x32x4_2b_bf16 v[80:111], v[28:29], v[16:17], 0
    v_exp_f32 v120, v120
    v_exp_f32 v121, v121
    v_exp_f32 v122, v122
    v_exp_f32 v123, v123
    v_exp_f32 v124, v124
    v_exp_f32 v125, v125
    v_exp_f32 v126, v126
    v_exp_f32 v127, v127
    v_smfmac_f32_32x32x32_bf16 v[48:63], v[40:43], v[112:119], v2
    ds_read_b128 v[24:27], v3 offset:33152
    s_cmp_eq_u32 s49, 3
    s_cbranch_scc1 L_g_83
    s_add_u32 m0, s75, 73728
    s_add_u32 s57, s89, 0
    buffer_load_dwordx4 v249, s[36:39], s57 offen lds
L_g_83:
    v_exp_f32 v128, v128
    v_exp_f32 v129, v129
    v_exp_f32 v130, v130
    v_exp_f32 v131, v131
    v_smfmac_f32_32x32x32_bf16 v[48:63], v[44:47], v[120:127], v2
    ds_read_b32 v30, v4 offset:33152
    s_setprio 0
    v_exp_f32 v132, v132
    v_exp_f32 v133, v133
    v_exp_f32 v134, v134
    v_exp_f32 v135, v135
    v_mfma_f32_32x32x16_bf16 v[80:95], v[20:23], v[8:11], v[80:95]
    ds_read_b128 v[32:35], v5 offset:28416
    s_setprio 1
    s_cmp_eq_u32 s49, 3
    s_cbranch_scc1 L_g_84
    s_add_u32 m0, s75, 76800
    s_add_u32 s57, s89, 0
    buffer_load_dwordx4 v250, s[36:39], s57 offen lds
L_g_84:
    v_exp_f32 v136, v136
    v_exp_f32 v137, v137
    v_exp_f32 v138, v138
    v_exp_f32 v139, v139
    v_smfmac_f32_32x32x32_bf16 v[64:79], v[40:43], v[128:135], v2
    ds_read_b128 v[36:39], v5 offset:29024
    s_cmp_eq_u32 s49, 3
    s_cbranch_scc1 L_g_85
    s_add_u32 m0, s75, 79872
    s_add_u32 s57, s89, 0
    buffer_load_dwordx4 v251, s[36:39], s57 offen lds
L_g_85:
    v_exp_f32 v140, v140
    v_exp_f32 v141, v141
    v_exp_f32 v142, v142
    v_exp_f32 v143, v143
    v_mfma_f32_32x32x16_bf16 v[96:111], v[20:23], v[12:15], v[96:111]
    s_barrier
    v_exp_f32 v80, v80
    v_exp_f32 v81, v81
    v_exp_f32 v82, v82
    v_exp_f32 v83, v83
    v_smfmac_f32_32x32x32_bf16 v[64:79], v[44:47], v[136:143], v2
    s_waitcnt lgkmcnt(0)
    s_cmp_eq_u32 s49, 3
    s_cbranch_scc1 L_g_86
    s_add_u32 m0, s75, 129024
    s_add_u32 s57, s89, 414720
    buffer_load_dwordx4 v246, s[36:39], s57 offen lds
L_g_86:
    v_exp_f32 v84, v84
    v_exp_f32 v85, v85
    v_exp_f32 v86, v86
    v_exp_f32 v87, v87
    v_mfma_f32_32x32x4_2b_bf16 v[112:143], v[30:31], v[16:17], 0
    v_exp_f32 v88, v88
    v_exp_f32 v89, v89
    v_exp_f32 v90, v90
    v_exp_f32 v91, v91
    v_exp_f32 v92, v92
    v_exp_f32 v93, v93
    v_exp_f32 v94, v94
    v_exp_f32 v95, v95
    v_smfmac_f32_32x32x32_bf16 v[48:63], v[32:35], v[80:87], v2
    s_cmp_eq_u32 s49, 3
    s_cbranch_scc1 L_g_87
    s_add_u32 m0, s75, 132096
    s_add_u32 s57, s89, 414720
    buffer_load_dwordx4 v247, s[36:39], s57 offen lds
L_g_87:
    v_exp_f32 v96, v96
    v_exp_f32 v97, v97
    v_exp_f32 v98, v98
    v_exp_f32 v99, v99
    v_smfmac_f32_32x32x32_bf16 v[48:63], v[36:39], v[88:95], v2
    v_exp_f32 v100, v100
    v_exp_f32 v101, v101
    v_exp_f32 v102, v102
    v_exp_f32 v103, v103
    v_mfma_f32_32x32x16_bf16 v[112:127], v[24:27], v[8:11], v[112:127]
    ds_read_b128 v[40:43], v5 offset:33152
    s_cmp_eq_u32 s49, 3
    s_cbranch_scc1 L_g_88
    s_add_u32 m0, s75, 135168
    s_add_u32 s57, s89, 414720
    buffer_load_dwordx4 v248, s[36:39], s57 offen lds
L_g_88:
    v_exp_f32 v104, v104
    v_exp_f32 v105, v105
    v_exp_f32 v106, v106
    v_exp_f32 v107, v107
    v_smfmac_f32_32x32x32_bf16 v[64:79], v[32:35], v[96:103], v2
    ds_read_b128 v[44:47], v5 offset:33760
    v_exp_f32 v108, v108
    v_exp_f32 v109, v109
    v_exp_f32 v110, v110
    v_exp_f32 v111, v111
    v_mfma_f32_32x32x16_bf16 v[128:143], v[24:27], v[12:15], v[128:143]
    v_exp_f32 v112, v112
    v_exp_f32 v113, v113
    v_exp_f32 v114, v114
    v_exp_f32 v115, v115
    v_smfmac_f32_32x32x32_bf16 v[64:79], v[36:39], v[104:111], v2
    s_waitcnt lgkmcnt(0)
    v_exp_f32 v116, v116
    v_exp_f32 v117, v117
    v_exp_f32 v118, v118
    v_exp_f32 v119, v119
    v_exp_f32 v120, v120
    v_exp_f32 v121, v121
    v_exp_f32 v122, v122
    v_exp_f32 v123, v123
    v_exp_f32 v124, v124
    v_exp_f32 v125, v125
    v_exp_f32 v126, v126
    v_exp_f32 v127, v127
    v_smfmac_f32_32x32x32_bf16 v[48:63], v[40:43], v[112:119], v2
    v_exp_f32 v128, v128
    v_exp_f32 v129, v129
    v_exp_f32 v130, v130
    v_exp_f32 v131, v131
    v_smfmac_f32_32x32x32_bf16 v[48:63], v[44:47], v[120:127], v2
    v_exp_f32 v132, v132
    v_exp_f32 v133, v133
    v_exp_f32 v134, v134
    v_exp_f32 v135, v135
    v_exp_f32 v136, v136
    v_exp_f32 v137, v137
    v_exp_f32 v138, v138
    v_exp_f32 v139, v139
    v_smfmac_f32_32x32x32_bf16 v[64:79], v[40:43], v[128:135], v2
    v_exp_f32 v140, v140
    v_exp_f32 v141, v141
    v_exp_f32 v142, v142
    v_exp_f32 v143, v143
    s_nop 1
    v_smfmac_f32_32x32x32_bf16 v[64:79], v[44:47], v[136:143], v2
    s_mul_i32 s57, s49, 9216
    v_add_u32 v20, s57, v18
    v_lshl_add_u32 v21, v7, 3, s57
    s_lshl_b32 s57, s49, 8
    s_add_u32 s57, s57, 156672
    v_lshl_add_u32 v22, v7, 2, s57
    s_setprio 0
    s_nop 0
    ds_write_b128 v20, v[48:51] offset:0
    ds_write_b128 v20, v[52:55] offset:1024
    s_nop 1
    ds_write_b128 v20, v[64:67] offset:2304
    ds_write_b128 v20, v[68:71] offset:3328
    s_mov_b32 exec_hi, 0
    ds_write_b64 v21, v[56:57] offset:2048
    ds_write_b32 v22, v58 offset:0
    ds_write_b64 v21, v[72:73] offset:4352
    ds_write_b32 v22, v74 offset:128
    s_mov_b64 exec, -1
    s_waitcnt vmcnt(12)
    s_cmp_lg_u32 s48, 3
    s_cbranch_scc1 L_g_89
    s_waitcnt vmcnt(0)
L_g_89:
    s_waitcnt lgkmcnt(0)
    s_barrier
    s_cmp_eq_u32 s49, 3
    s_cbranch_scc1 L_g_90
    s_add_u32 m0, s75, 138240
    s_add_u32 s57, s89, 497664
    buffer_load_dwordx4 v246, s[36:39], s57 offen lds
    s_add_u32 m0, s75, 141312
    s_add_u32 s57, s89, 497664
    buffer_load_dwordx4 v247, s[36:39], s57 offen lds
    s_add_u32 m0, s75, 144384
    s_add_u32 s57, s89, 497664
    buffer_load_dwordx4 v248, s[36:39], s57 offen lds
    s_add_u32 m0, s75, 147456
    s_add_u32 s57, s89, 580608
    buffer_load_dwordx4 v246, s[36:39], s57 offen lds
    s_add_u32 m0, s75, 150528
    s_add_u32 s57, s89, 580608
    buffer_load_dwordx4 v247, s[36:39], s57 offen lds
    s_add_u32 m0, s75, 153600
    s_add_u32 s57, s89, 580608
    buffer_load_dwordx4 v248, s[36:39], s57 offen lds
L_g_90:
    s_branch L_ck_92
L_rt_91:
    s_add_u32 s58, s90, 0
    buffer_load_dwordx4 v[144:147], v18, s[44:47], s58 offen offset:0 sc1
    buffer_load_dwordx4 v[148:151], v18, s[44:47], s58 offen offset:1024 sc1
    buffer_load_dwordx4 v[152:155], v18, s[44:47], s58 offen offset:2048 sc1
    s_add_u32 s58, s58, 6144
    buffer_load_dwordx4 v[156:159], v18, s[44:47], s58 offen offset:0 sc1
    buffer_load_dwordx4 v[160:163], v18, s[44:47], s58 offen offset:1024 sc1
    buffer_load_dwordx4 v[164:167], v18, s[44:47], s58 offen offset:2048 sc1
    s_add_u32 s58, s58, 43008
    buffer_load_dwordx4 v[168:171], v18, s[44:47], s58 offen offset:0 sc1
    buffer_load_dwordx4 v[172:175], v18, s[44:47], s58 offen offset:1024 sc1
    buffer_load_dwordx4 v[176:179], v18, s[44:47], s58 offen offset:2048 sc1
    s_add_u32 s58, s58, 6144
    buffer_load_dwordx4 v[180:183], v18, s[44:47], s58 offen offset:0 sc1
    buffer_load_dwordx4 v[184:187], v18, s[44:47], s58 offen offset:1024 sc1
    buffer_load_dwordx4 v[188:191], v18, s[44:47], s58 offen offset:2048 sc1
    s_waitcnt vmcnt(0)
L_ck_92:
    v_xor_b32 v44, v147, v252
    v_bitop3_b32 v44, v44, v151, v252 bitop3:0xf6
    v_bitop3_b32 v44, v44, v155, v252 bitop3:0xf6
    v_bitop3_b32 v44, v44, v159, v252 bitop3:0xf6
    v_bitop3_b32 v44, v44, v163, v252 bitop3:0xf6
    v_bitop3_b32 v44, v44, v167, v252 bitop3:0xf6
    v_bitop3_b32 v44, v44, v171, v252 bitop3:0xf6
    v_bitop3_b32 v44, v44, v175, v252 bitop3:0xf6
    v_bitop3_b32 v44, v44, v179, v252 bitop3:0xf6
    v_bitop3_b32 v44, v44, v183, v252 bitop3:0xf6
    v_bitop3_b32 v44, v44, v187, v252 bitop3:0xf6
    v_bitop3_b32 v44, v44, v191, v252 bitop3:0xf6
    v_cmp_ne_u32 vcc, 0, v44
    s_cbranch_vccz L_ok_93
    s_sub_u32 s84, s84, 1
    s_cmp_gt_i32 s84, 0
    s_cbranch_scc1 L_rt_91
L_ok_93:
    v_mov_b32 v147, v152
    v_mov_b32 v151, v153
    v_mov_b32 v44, v154
    v_mov_b32 v159, v164
    v_mov_b32 v163, v165
    v_mov_b32 v45, v166
    v_mov_b32 v171, v176
    v_mov_b32 v175, v177
    v_mov_b32 v46, v178
    v_mov_b32 v183, v188
    v_mov_b32 v187, v189
    v_mov_b32 v47, v190
    s_nop 1
    v_mfma_f32_32x32x16_bf16 v[48:63], v[192:195], v[44:47], 0
    ds_read_b64_tr_b16 v[192:193], v206 offset:4608
    ds_read_b64_tr_b16 v[194:195], v206 offset:4752
    v_mfma_f32_32x32x16_bf16 v[64:79], v[196:199], v[44:47], 0
    ds_read_b64_tr_b16 v[196:197], v206 offset:4672
    ds_read_b64_tr_b16 v[198:199], v206 offset:4816
    v_mfma_f32_16x16x32_bf16 v[80:83], v[200:203], v[44:47], 0
    ds_read_b64_tr_b16 v[200:201], v207 offset:4736
    ds_read_b64_tr_b16 v[202:203], v207 offset:4880
    v_mfma_f32_32x32x16_bf16 v[48:63], v[208:211], v[144:147], v[48:63]
    ds_read_b64_tr_b16 v[208:209], v206 offset:6912
    ds_read_b64_tr_b16 v[210:211], v206 offset:7056
    v_mfma_f32_32x32x16_bf16 v[64:79], v[212:215], v[144:147], v[64:79]
    ds_read_b64_tr_b16 v[212:213], v206 offset:6976
    ds_read_b64_tr_b16 v[214:215], v206 offset:7120
    v_mfma_f32_16x16x32_bf16 v[80:83], v[216:219], v[144:147], v[80:83]
    ds_read_b64_tr_b16 v[216:217], v207 offset:7040
    ds_read_b64_tr_b16 v[218:219], v207 offset:7184
    v_mfma_f32_32x32x16_bf16 v[48:63], v[220:223], v[148:151], v[48:63]
    ds_read_b64_tr_b16 v[220:221], v206 offset:36864
    ds_read_b64_tr_b16 v[222:223], v206 offset:37008
    v_mfma_f32_32x32x16_bf16 v[64:79], v[224:227], v[148:151], v[64:79]
    ds_read_b64_tr_b16 v[224:225], v206 offset:36928
    ds_read_b64_tr_b16 v[226:227], v206 offset:37072
    v_mfma_f32_16x16x32_bf16 v[80:83], v[228:231], v[148:151], v[80:83]
    ds_read_b64_tr_b16 v[228:229], v207 offset:36992
    ds_read_b64_tr_b16 v[230:231], v207 offset:37136
    s_waitcnt lgkmcnt(12)
    v_mfma_f32_32x32x16_bf16 v[48:63], v[192:195], v[156:159], v[48:63]
    ds_read_b64_tr_b16 v[192:193], v206 offset:39168
    ds_read_b64_tr_b16 v[194:195], v206 offset:39312
    v_mfma_f32_32x32x16_bf16 v[64:79], v[196:199], v[156:159], v[64:79]
    ds_read_b64_tr_b16 v[196:197], v206 offset:39232
    ds_read_b64_tr_b16 v[198:199], v206 offset:39376
    v_mfma_f32_16x16x32_bf16 v[80:83], v[200:203], v[156:159], v[80:83]
    ds_read_b64_tr_b16 v[200:201], v207 offset:39296
    ds_read_b64_tr_b16 v[202:203], v207 offset:39440
    s_waitcnt lgkmcnt(12)
    v_mfma_f32_32x32x16_bf16 v[48:63], v[208:211], v[160:163], v[48:63]
    ds_read_b64_tr_b16 v[208:209], v206 offset:41472
    ds_read_b64_tr_b16 v[210:211], v206 offset:41616
    v_mfma_f32_32x32x16_bf16 v[64:79], v[212:215], v[160:163], v[64:79]
    ds_read_b64_tr_b16 v[212:213], v206 offset:41536
    ds_read_b64_tr_b16 v[214:215], v206 offset:41680
    v_mfma_f32_16x16x32_bf16 v[80:83], v[216:219], v[160:163], v[80:83]
    ds_read_b64_tr_b16 v[216:217], v207 offset:41600
    ds_read_b64_tr_b16 v[218:219], v207 offset:41744
    s_waitcnt lgkmcnt(12)
    v_mfma_f32_32x32x16_bf16 v[48:63], v[220:223], v[168:171], v[48:63]
    ds_read_b64_tr_b16 v[220:221], v206 offset:43776
    ds_read_b64_tr_b16 v[222:223], v206 offset:43920
    v_mfma_f32_32x32x16_bf16 v[64:79], v[224:227], v[168:171], v[64:79]
    ds_read_b64_tr_b16 v[224:225], v206 offset:43840
    ds_read_b64_tr_b16 v[226:227], v206 offset:43984
    v_mfma_f32_16x16x32_bf16 v[80:83], v[228:231], v[168:171], v[80:83]
    ds_read_b64_tr_b16 v[228:229], v207 offset:43904
    ds_read_b64_tr_b16 v[230:231], v207 offset:44048
    s_waitcnt lgkmcnt(12)
    v_mfma_f32_32x32x16_bf16 v[48:63], v[192:195], v[172:175], v[48:63]
    v_mfma_f32_32x32x16_bf16 v[64:79], v[196:199], v[172:175], v[64:79]
    v_mfma_f32_16x16x32_bf16 v[80:83], v[200:203], v[172:175], v[80:83]
    s_waitcnt lgkmcnt(6)
    v_mfma_f32_32x32x16_bf16 v[48:63], v[208:211], v[180:183], v[48:63]
    v_mfma_f32_32x32x16_bf16 v[64:79], v[212:215], v[180:183], v[64:79]
    v_mfma_f32_16x16x32_bf16 v[80:83], v[216:219], v[180:183], v[80:83]
    s_waitcnt lgkmcnt(0)
    s_add_u32 s58, s90, 3072
    v_mfma_f32_32x32x16_bf16 v[48:63], v[220:223], v[184:187], v[48:63]
    buffer_load_dwordx4 v[96:99], v18, s[44:47], s58 offen offset:0 sc1
    v_mfma_f32_32x32x16_bf16 v[64:79], v[224:227], v[184:187], v[64:79]
    buffer_load_dwordx4 v[100:103], v18, s[44:47], s58 offen offset:1024 sc1
    v_mfma_f32_16x16x32_bf16 v[80:83], v[228:231], v[184:187], v[80:83]
    buffer_load_dwordx4 v[104:107], v18, s[44:47], s58 offen offset:2048 sc1
    s_add_u32 s58, s58, 6144
    buffer_load_dwordx4 v[108:111], v18, s[44:47], s58 offen offset:0 sc1
    buffer_load_dwordx4 v[112:115], v18, s[44:47], s58 offen offset:1024 sc1
    buffer_load_dwordx4 v[116:119], v18, s[44:47], s58 offen offset:2048 sc1
    s_add_u32 s58, s58, 43008
    buffer_load_dwordx4 v[120:123], v18, s[44:47], s58 offen offset:0 sc1
    buffer_load_dwordx4 v[124:127], v18, s[44:47], s58 offen offset:1024 sc1
    buffer_load_dwordx4 v[128:131], v18, s[44:47], s58 offen offset:2048 sc1
    s_add_u32 s58, s58, 6144
    buffer_load_dwordx4 v[132:135], v18, s[44:47], s58 offen offset:0 sc1
    buffer_load_dwordx4 v[136:139], v18, s[44:47], s58 offen offset:1024 sc1
    buffer_load_dwordx4 v[140:143], v18, s[44:47], s58 offen offset:2048 sc1
    v_add_u32 v12, 82944, v206
    v_add_u32 v13, 82944, v207
    v_cndmask_b32 v13, v207, v13, s[64:65]
    s_lshl_b32 s57, s30, 2
    s_add_u32 s57, s57, s31
    s_mul_i32 s57, s57, 4608
    v_lshl_add_u32 v14, v6, 6, v7
    v_mul_u32_u24 v14, 144, v14
    v_add_u32 v14, s57, v14
    v_and_b32 v16, 15, v1
    v_lshl_add_u32 v16, v6, 4, v16
    v_and_b32 v17, 16, v1
    v_lshl_add_u32 v16, v17, 2, v16
    v_mul_u32_u24 v16, 144, v16
    v_add_u32 v16, s57, v16
    s_mul_i32 s85, s82, 73728
    s_add_u32 s85, s85, s89
    v_add_u32 v238, s75, v18
    v_add_u32 v239, 36864, v238
    s_lshl_b32 s57, s48, 6
    v_add_u32 v15, s57, v1
    v_mul_u32_u24 v3, 7282, v15
    v_lshrrev_b32 v3, 16, v3
    v_mul_u32_u24 v4, 1008, v3
    v_lshl_add_u32 v236, v15, 4, v4
    v_add_u32 v15, 512, v1
    v_mul_u32_u24 v3, 7282, v15
    v_lshrrev_b32 v3, 16, v3
    v_mul_u32_u24 v4, 1008, v3
    v_lshl_add_u32 v237, v15, 4, v4
    s_waitcnt vmcnt(12)
    s_barrier
    s_branch L_phase3
L_exit0:
    s_endpgm
L_upper:
    s_load_dword s83, s[28:29], 163840
    s_lshl_b32 s75, s48, 10
    s_mov_b32 s84, 65536
    v_lshlrev_b32 v18, 4, v1
    v_lshrrev_b32 v6, 5, v1
    v_and_b32 v7, 31, v1
    s_mov_b32 s44, s28
    s_and_b32 s45, s29, 0xffff
    s_mov_b32 s46, 11894784
    s_mov_b32 s47, 0x00020000
    s_mov_b32 s91, 9
    s_lshl_b32 s66, s54, 7
    s_add_u32 s66, s66, s56
    s_add_u32 m0, s74, 0
    s_nop 0
    buffer_load_dwordx4 v70, s[32:35], s66 offen lds
    s_add_u32 m0, s74, 1024
    s_nop 0
    buffer_load_dwordx4 v71, s[32:35], s66 offen lds
    s_add_u32 m0, s74, 2048
    s_add_u32 s66, s66, 18432
    buffer_load_dwordx4 v70, s[32:35], s66 offen lds
    s_add_u32 m0, s74, 3072
    s_nop 0
    buffer_load_dwordx4 v71, s[32:35], s66 offen lds
    s_mul_i32 s67, s54, s63
    s_add_u32 m0, s96, 16384
    s_nop 0
    buffer_load_dwordx4 v34, s[36:39], s67 offen lds
    s_add_u32 m0, s96, 17408
    s_nop 0
    buffer_load_dwordx4 v35, s[36:39], s67 offen lds
    s_add_u32 m0, s96, 18432
    s_nop 0
    buffer_load_dwordx4 v36, s[36:39], s67 offen lds
    s_add_u32 m0, s96, 19456
    s_nop 0
    buffer_load_dwordx4 v37, s[36:39], s67 offen lds
    s_add_u32 m0, s96, 20480
    s_add_u32 s54, s54, 1
    buffer_load_dwordx4 v38, s[36:39], s67 offen lds
    s_cmp_eq_u32 s54, 9
    s_cselect_b32 s54, 0, s54
    s_waitcnt vmcnt(9)
L_vw_94:
    s_waitcnt lgkmcnt(0)
    s_barrier
    s_mul_i32 s83, s83, 0x9e3779b1
    s_add_u32 s83, s83, 0x7f4a7c15
    s_and_b32 s61, s83, 0xbfffbfff
    v_mov_b32 v252, s61
    s_cmp_lg_u32 s48, 5
    s_cbranch_scc1 L_g_95
    s_cmp_eq_u32 s53, 0
    s_cselect_b32 s58, 16, 24
    v_mad_u32_u24 v56, v6, s58, v7
    s_bfm_b32 s92, s58, 0
    s_mov_b32 s93, s92
    s_lshl_b32 s58, s58, 5
    s_mov_b32 s57, 147968
    v_lshl_add_u32 v56, v56, 4, s57
    v_add_u32 v57, s58, v56
    ds_read_b128 v[192:195], v56 offset:0
    ds_read_b128 v[196:199], v57 offset:0
    ds_read_b128 v[200:203], v56 offset:1024
    ds_read_b128 v[204:207], v56 offset:1536
    ds_read_b128 v[208:211], v57 offset:1536
    ds_read_b128 v[212:215], v56 offset:2560
    ds_read_b128 v[40:43], v56 offset:3072
    ds_read_b128 v[44:47], v57 offset:3072
    ds_read_b128 v[48:51], v56 offset:4096
    ds_read_b128 v[76:79], v56 offset:4608
    ds_read_b128 v[80:83], v57 offset:4608
    ds_read_b128 v[84:87], v56 offset:5632
    s_sub_u32 s91, 11, s53
    s_waitcnt lgkmcnt(0)
    v_add_f32 v192, v192, v204
    v_add_f32 v40, v76, v40
    v_add_f32 v193, v193, v205
    v_add_f32 v41, v77, v41
    v_add_f32 v194, v194, v206
    v_add_f32 v42, v78, v42
    v_add_f32 v195, v195, v207
    v_add_f32 v43, v79, v43
    v_add_f32 v196, v196, v208
    v_add_f32 v44, v80, v44
    v_add_f32 v197, v197, v209
    v_add_f32 v45, v81, v45
    v_add_f32 v198, v198, v210
    v_add_f32 v46, v82, v46
    v_add_f32 v199, v199, v211
    v_add_f32 v47, v83, v47
    v_add_f32 v202, v202, v214
    v_add_f32 v50, v86, v50
    v_add_f32 v203, v203, v215
    v_add_f32 v51, v87, v51
    v_add_f32 v192, v192, v40
    v_add_f32 v193, v193, v41
    v_add_f32 v194, v194, v42
    v_add_f32 v195, v195, v43
    v_add_f32 v196, v196, v44
    v_add_f32 v197, v197, v45
    v_add_f32 v198, v198, v46
    v_add_f32 v199, v199, v47
    v_add_f32 v202, v202, v50
    v_add_f32 v203, v203, v51
    v_cvt_pk_bf16_f32 v40, v192, v193
    v_cvt_pk_bf16_f32 v41, v194, v195
    v_cvt_pk_bf16_f32 v42, v196, v197
    v_cvt_pk_bf16_f32 v43, v198, v199
    v_cvt_pk_bf16_f32 v44, v202, v203
    s_lshr_b32 s57, s52, 1
    s_lshl_b32 s58, s51, 2
    s_add_u32 s57, s57, s58
    s_mul_i32 s57, s57, 2368
    s_and_b32 s58, s52, 1
    s_cmp_lg_u32 s53, 0
    s_cbranch_scc1 L_av_96
    s_lshl_b32 s59, s58, 8
    s_add_u32 s59, s59, s57
    s_lshl_b32 s58, s58, 6
    s_add_u32 s58, s58, s57
    v_lshlrev_b32 v56, 2, v1
    s_mov_b64 exec, s[92:93]
    buffer_store_dwordx4 v[40:43], v18, s[44:47], s59 offen sc1
    s_mov_b32 exec_hi, 0
    buffer_store_dword v44, v56, s[44:47], s58 offen offset:1024 sc1
    s_branch L_ad_97
L_av_96:
    v_permlane32_swap_b32 v40, v42
    v_permlane32_swap_b32 v41, v43
    v_cmp_eq_u32 vcc, 16, v7
    v_cmp_lt_u32 s[92:93], 16, v7
    v_subrev_u32 v56, 2, v7
    v_mov_b32 v57, 0x3f803f80
    v_cndmask_b32 v56, v7, v56, s[92:93]
    v_cndmask_b32 v56, v56, 18, vcc
    v_cndmask_b32 v40, v40, v57, vcc
    v_cndmask_b32 v41, v41, v57, vcc
    v_cndmask_b32 v42, v42, v57, vcc
    v_cndmask_b32 v43, v43, v57, vcc
    v_mul_u32_u24 v57, 304, v6
    v_lshl_add_u32 v56, v56, 4, v57
    s_mul_i32 s58, s58, 608
    s_add_u32 s58, s58, s57
    s_mov_b32 exec_lo, 0xdffff
    s_mov_b32 exec_hi, 0xdffff
    buffer_store_dwordx4 v[40:43], v56, s[44:47], s58 offen offset:1152 sc1
L_ad_97:
    s_mov_b64 exec, -1
L_g_95:
    s_lshl_b32 s66, s54, 7
    s_add_u32 s66, s66, s56
    s_add_u32 m0, s74, 36992
    s_nop 0
    buffer_load_dwordx4 v70, s[32:35], s66 offen lds
    s_add_u32 m0, s74, 38016
    s_nop 0
    buffer_load_dwordx4 v71, s[32:35], s66 offen lds
    s_add_u32 m0, s74, 39040
    s_add_u32 s66, s66, 18432
    buffer_load_dwordx4 v70, s[32:35], s66 offen lds
    s_add_u32 m0, s74, 40064
    s_nop 0
    buffer_load_dwordx4 v71, s[32:35], s66 offen lds
    s_mul_i32 s67, s54, s63
    s_add_u32 m0, s96, 53376
    s_nop 0
    buffer_load_dwordx4 v34, s[36:39], s67 offen lds
    s_add_u32 m0, s96, 54400
    s_nop 0
    buffer_load_dwordx4 v35, s[36:39], s67 offen lds
    s_add_u32 m0, s96, 55424
    s_nop 0
    buffer_load_dwordx4 v36, s[36:39], s67 offen lds
    s_add_u32 m0, s96, 56448
    s_nop 0
    buffer_load_dwordx4 v37, s[36:39], s67 offen lds
    s_add_u32 m0, s96, 57472
    s_add_u32 s54, s54, 1
    buffer_load_dwordx4 v38, s[36:39], s67 offen lds
    s_cmp_eq_u32 s54, 9
    s_cselect_b32 s54, 0, s54
    s_waitcnt vmcnt(11)
    s_cmp_ge_u32 s91, 11
    s_cbranch_scc1 L_vw_98
    s_waitcnt vmcnt(10)
    s_cmp_ge_u32 s91, 10
    s_cbranch_scc1 L_vw_98
    s_waitcnt vmcnt(9)
L_vw_98:
    s_barrier
    s_lshl_b32 s66, s54, 7
    s_add_u32 s66, s66, s56
    s_add_u32 m0, s74, 73984
    s_nop 0
    buffer_load_dwordx4 v70, s[32:35], s66 offen lds
    s_add_u32 m0, s74, 75008
    s_nop 0
    buffer_load_dwordx4 v71, s[32:35], s66 offen lds
    s_add_u32 m0, s74, 76032
    s_add_u32 s66, s66, 18432
    buffer_load_dwordx4 v70, s[32:35], s66 offen lds
    s_add_u32 m0, s74, 77056
    s_nop 0
    buffer_load_dwordx4 v71, s[32:35], s66 offen lds
    s_mul_i32 s67, s54, s63
    s_add_u32 m0, s96, 90368
    s_nop 0
    buffer_load_dwordx4 v34, s[36:39], s67 offen lds
    s_add_u32 m0, s96, 91392
    s_nop 0
    buffer_load_dwordx4 v35, s[36:39], s67 offen lds
    s_add_u32 m0, s96, 92416
    s_nop 0
    buffer_load_dwordx4 v36, s[36:39], s67 offen lds
    s_add_u32 m0, s96, 93440
    s_nop 0
    buffer_load_dwordx4 v37, s[36:39], s67 offen lds
    s_add_u32 m0, s96, 94464
    s_add_u32 s54, s54, 1
    buffer_load_dwordx4 v38, s[36:39], s67 offen lds
    s_cmp_eq_u32 s54, 9
    s_cselect_b32 s54, 0, s54
    s_waitcnt vmcnt(9)
L_vw_99:
    s_barrier
    s_cmp_lg_u32 s48, 5
    s_cbranch_scc1 L_g_100
    s_lshl_b32 s57, s2, 4
    s_add_u32 s57, s57, 167936
    s_getreg_b32 s58, hwreg(HW_REG_XCC_ID, 0, 4)
    v_mov_b32 v46, v252
    v_mov_b32 v47, s58
    s_mov_b64 exec, 1
    buffer_store_dwordx2 v[46:47], off, s[44:47], s57 sc1
    s_mov_b64 exec, -1
L_g_100:
    s_lshl_b32 s66, s54, 7
    s_add_u32 s66, s66, s56
    s_add_u32 m0, s74, 110976
    s_nop 0
    buffer_load_dwordx4 v70, s[32:35], s66 offen lds
    s_add_u32 m0, s74, 112000
    s_nop 0
    buffer_load_dwordx4 v71, s[32:35], s66 offen lds
    s_add_u32 m0, s74, 113024
    s_add_u32 s66, s66, 18432
    buffer_load_dwordx4 v70, s[32:35], s66 offen lds
    s_add_u32 m0, s74, 114048
    s_nop 0
    buffer_load_dwordx4 v71, s[32:35], s66 offen lds
    v_bfe_u32 v32, v1, 2, 2
    v_bfe_u32 v61, v1, 4, 1
    v_and_b32 v62, 3, v1
    v_lshl_add_u32 v33, v61, 2, v62
    v_mov_b32 v59, 163840
    v_cmp_eq_u32 s[78:79], 1, v61
    v_cmp_eq_u32 s[76:77], 1, v6
    v_mov_b64 v[240:241], 0
    v_mov_b64 v[242:243], 0
    v_mov_b64 v[244:245], 0
    v_mov_b64 v[246:247], 0
    v_mov_b64 v[248:249], 0
    v_mov_b64 v[250:251], 0
    s_xor_b32 s58, s49, 1
    s_lshl_b32 s80, s51, 2
    s_add_u32 s80, s80, s58
    s_and_b32 s58, s2, 7
    s_lshl_b32 s82, s58, 2
    s_bfe_u32 s59, s2, 0x20003
    s_or_b32 s82, s82, s59
    s_lshl_b32 s13, s58, 1
    s_and_b32 s59, s59, 1
    s_or_b32 s13, s13, s59
    s_lshl_b32 s12, s13, 2
    s_add_u32 s12, s12, s49
    s_lshr_b32 s81, s2, 4
    s_and_b32 s58, s49, 1
    s_lshl_b32 s86, s52, 1
    s_add_u32 s86, s86, s58
    s_lshl_b32 s85, s12, 4
    s_add_u32 s85, s85, s81
    s_mul_i32 s85, s85, 3328
    s_add_u32 s85, s85, 196608
    s_mul_i32 s67, s54, s63
    s_add_u32 m0, s96, 127360
    s_nop 0
    buffer_load_dwordx4 v34, s[36:39], s67 offen lds
    s_add_u32 m0, s96, 128384
    s_nop 0
    buffer_load_dwordx4 v35, s[36:39], s67 offen lds
    s_add_u32 m0, s96, 129408
    s_nop 0
    buffer_load_dwordx4 v36, s[36:39], s67 offen lds
    s_add_u32 m0, s96, 130432
    s_nop 0
    buffer_load_dwordx4 v37, s[36:39], s67 offen lds
    s_add_u32 m0, s96, 131456
    s_add_u32 s54, s54, 1
    buffer_load_dwordx4 v38, s[36:39], s67 offen lds
    s_cmp_eq_u32 s54, 9
    s_cselect_b32 s54, 0, s54
    s_waitcnt vmcnt(10)
    s_cmp_ge_u32 s91, 10
    s_cbranch_scc1 L_vw_101
    s_waitcnt vmcnt(9)
L_vw_101:
    s_barrier
    s_lshl_b32 s66, s54, 7
    s_add_u32 s66, s66, s56
    s_add_u32 m0, s74, 0
    s_nop 0
    buffer_load_dwordx4 v70, s[32:35], s66 offen lds
    s_add_u32 m0, s74, 1024
    s_nop 0
    buffer_load_dwordx4 v71, s[32:35], s66 offen lds
    s_add_u32 m0, s74, 2048
    s_add_u32 s66, s66, 18432
    buffer_load_dwordx4 v70, s[32:35], s66 offen lds
    s_add_u32 m0, s74, 3072
    s_nop 0
    buffer_load_dwordx4 v71, s[32:35], s66 offen lds
    s_mul_i32 s89, s52, 144
    s_add_u32 s58, s52, s48
    s_and_b32 s30, s58, 3
    s_bfe_u32 s31, s58, 0x10002
    s_lshl_b32 s90, s82, 1
    s_add_u32 s90, s90, s31
    s_lshl_b32 s90, s90, 3
    s_add_u32 s90, s90, s30
    s_mul_i32 s90, s90, 12288
    s_add_u32 s90, s90, 5603328
    v_mov_b32 v2, 0xdddd
    v_add_u32 v3, 2368, v18
    v_lshlrev_b32 v4, 2, v7
    v_add_u32 v4, 3392, v4
    v_mul_u32_u24 v58, 304, v6
    v_lshl_add_u32 v5, v7, 4, v58
    v_add_u32 v5, 3520, v5
    v_cmp_gt_u32 vcc, 19, v7
    v_mov_b32 v29, 0x3f803f80
    v_mov_b32 v31, 0x3f803f80
    v_cndmask_b32 v5, v59, v5, vcc
    v_cndmask_b32 v253, 0, 1, vcc
    v_lshl_add_u32 v0, v32, 1, v6
    v_mul_u32_u24 v0, 288, v0
    v_lshl_add_u32 v0, v33, 3, v0
    s_lshl_b32 s101, s80, 4
    s_add_u32 s101, s101, s86
    s_mul_i32 s101, s101, 3328
    s_add_u32 s101, s101, 196608
    v_lshlrev_b32 v25, 3, v7
    s_and_b32 s60, s49, 1
    s_xor_b32 s58, s49, 1
    s_lshl_b32 s58, s58, 5
    s_mul_i32 s67, s54, s63
    s_add_u32 m0, s96, 16384
    s_nop 0
    buffer_load_dwordx4 v34, s[36:39], s67 offen lds
    s_add_u32 m0, s96, 17408
    s_nop 0
    buffer_load_dwordx4 v35, s[36:39], s67 offen lds
    s_add_u32 m0, s96, 18432
    s_nop 0
    buffer_load_dwordx4 v36, s[36:39], s67 offen lds
    s_add_u32 m0, s96, 19456
    s_nop 0
    buffer_load_dwordx4 v37, s[36:39], s67 offen lds
    s_add_u32 m0, s96, 20480
    s_add_u32 s54, s54, 1
    buffer_load_dwordx4 v38, s[36:39], s67 offen lds
    s_cmp_eq_u32 s54, 9
    s_cselect_b32 s54, 0, s54
    s_waitcnt vmcnt(9)
L_vw_102:
    s_barrier
    s_lshl_b32 s66, s54, 7
    s_add_u32 s66, s66, s56
    s_add_u32 m0, s74, 36992
    s_nop 0
    buffer_load_dwordx4 v70, s[32:35], s66 offen lds
    s_add_u32 m0, s74, 38016
    s_nop 0
    buffer_load_dwordx4 v71, s[32:35], s66 offen lds
    s_add_u32 m0, s74, 39040
    s_add_u32 s66, s66, 18432
    buffer_load_dwordx4 v70, s[32:35], s66 offen lds
    s_add_u32 m0, s74, 40064
    s_nop 0
    buffer_load_dwordx4 v71, s[32:35], s66 offen lds
    v_add_u32 v58, s58, v7
    s_mul_i32 s58, s60, 10240
    s_add_u32 s58, s58, 143360
    v_mad_u32_u24 v60, v58, 40, s58
    v_lshl_add_u32 v228, v6, 3, v60
    s_movk_i32 s59, 5120
    v_mad_u32_u24 v229, v6, s59, v60
    v_lshl_add_u32 v58, v58, 1, v6
    s_mul_i32 s58, s60, 20480
    s_add_u32 s58, s58, 102400
    v_mad_u32_u24 v230, v58, 40, s58
    v_lshl_add_u32 v58, v6, 3, v32
    v_and_b32 v60, 1, v33
    v_lshl_add_u32 v60, v58, 1, v60
    s_mul_i32 s58, s49, 10240
    s_add_u32 s58, s58, 102424
    v_mad_u32_u24 v232, v60, 40, s58
    v_lshrrev_b32 v60, 1, v33
    v_cmp_gt_u32 vcc, 4, v33
    v_lshl_add_u32 v232, v60, 3, v232
    s_mul_i32 s58, s49, 5120
    s_add_u32 s58, s58, 143360
    v_cndmask_b32 v232, v59, v232, vcc
    v_mad_u32_u24 v233, v58, 40, s58
    v_min_u32 v60, 4, v33
    v_lshl_add_u32 v233, v60, 3, v233
    s_lshl_b32 s55, s52, 2
    s_add_u32 s55, s55, s49
    s_lshl_b32 s55, s55, 4
    s_add_u32 s55, s55, s51
    s_mul_i32 s55, s55, 3712
    s_add_u32 s55, s55, 3606912
    v_mad_u32_u24 v239, v6, 19, v7
    s_mul_i32 s67, s54, s63
    s_add_u32 m0, s96, 53376
    s_nop 0
    buffer_load_dwordx4 v34, s[36:39], s67 offen lds
    s_add_u32 m0, s96, 54400
    s_nop 0
    buffer_load_dwordx4 v35, s[36:39], s67 offen lds
    s_add_u32 m0, s96, 55424
    s_nop 0
    buffer_load_dwordx4 v36, s[36:39], s67 offen lds
    s_add_u32 m0, s96, 56448
    s_nop 0
    buffer_load_dwordx4 v37, s[36:39], s67 offen lds
    s_add_u32 m0, s96, 57472
    s_add_u32 s54, s54, 1
    buffer_load_dwordx4 v38, s[36:39], s67 offen lds
    s_cmp_eq_u32 s54, 9
    s_cselect_b32 s54, 0, s54
    s_waitcnt vmcnt(9)
L_vw_103:
    s_barrier
    s_mov_b32 s100, 167936
    s_cmp_lg_u32 s48, 4
    s_cbranch_scc1 L_g_104
    buffer_load_dwordx2 v[40:41], v18, s[44:47], s100 offen offset:0 sc1
    buffer_load_dwordx2 v[42:43], v18, s[44:47], s100 offen offset:1024 sc1
    buffer_load_dwordx2 v[44:45], v18, s[44:47], s100 offen offset:2048 sc1
    buffer_load_dwordx2 v[46:47], v18, s[44:47], s100 offen offset:3072 sc1
L_g_104:
    s_lshl_b32 s66, s54, 7
    s_add_u32 s66, s66, s56
    s_add_u32 m0, s74, 73984
    s_nop 0
    buffer_load_dwordx4 v70, s[32:35], s66 offen lds
    s_add_u32 m0, s74, 75008
    s_nop 0
    buffer_load_dwordx4 v71, s[32:35], s66 offen lds
    s_add_u32 m0, s74, 76032
    s_add_u32 s66, s66, 18432
    buffer_load_dwordx4 v70, s[32:35], s66 offen lds
    s_add_u32 m0, s74, 77056
    s_nop 0
    buffer_load_dwordx4 v71, s[32:35], s66 offen lds
    v_lshlrev_b32 v239, 4, v239
    v_lshlrev_b32 v58, 3, v62
    v_cndmask_b32 v58, v58, 40, s[78:79]
    v_mad_u32_u24 v58, v32, 48, v58
    s_mul_i32 s59, s60, 1728
    s_add_u32 s59, s59, 159744
    v_add_u32 v27, s59, v58
    v_mul_u32_u24 v60, 192, v6
    v_add_u32 v30, v27, v60
    s_lshl_b32 s58, s49, 12
    s_add_u32 s58, s58, 53248
    v_add_u32 v224, s58, v18
    s_xor_b32 s58, s49, 1
    s_lshl_b32 s58, s58, 10
    s_add_u32 s58, s58, 69632
    v_lshl_add_u32 v225, v7, 4, s58
    s_add_u32 s58, s58, 77312
    v_lshl_add_u32 v226, v7, 2, s58
    v_mov_b32 v62, 0x3fb8aa3b
    v_mov_b32 v63, 0xbfb8aa3b
    v_mov_b32 v61, 156160
    s_cmp_eq_u32 s53, 0
    s_cselect_b32 s94, 0x3eae1a93, 1.0
    s_mov_b32 s95, s94
    s_bfe_u32 s59, s2, 0x20003
    s_mul_i32 s97, s59, 37888
    s_lshl_b32 s88, s49, 10
    s_add_u32 s97, s97, s88
    s_sub_u32 s60, s97, 151552
    s_min_u32 s97, s97, s60
    s_mul_i32 s67, s54, s63
    s_add_u32 m0, s96, 90368
    s_nop 0
    buffer_load_dwordx4 v34, s[36:39], s67 offen lds
    s_add_u32 m0, s96, 91392
    s_nop 0
    buffer_load_dwordx4 v35, s[36:39], s67 offen lds
    s_add_u32 m0, s96, 92416
    s_nop 0
    buffer_load_dwordx4 v36, s[36:39], s67 offen lds
    s_add_u32 m0, s96, 93440
    s_nop 0
    buffer_load_dwordx4 v37, s[36:39], s67 offen lds
    s_add_u32 m0, s96, 94464
    s_add_u32 s54, s54, 1
    buffer_load_dwordx4 v38, s[36:39], s67 offen lds
    s_cmp_eq_u32 s54, 9
    s_cselect_b32 s54, 0, s54
    s_waitcnt vmcnt(9)
L_vw_105:
    s_barrier
    s_cmp_lg_u32 s48, 4
    s_cbranch_scc1 L_g_106
    s_branch L_ck_108
L_rt_107:
    buffer_load_dwordx2 v[40:41], v18, s[44:47], s100 offen offset:0 sc1
    buffer_load_dwordx2 v[42:43], v18, s[44:47], s100 offen offset:1024 sc1
    buffer_load_dwordx2 v[44:45], v18, s[44:47], s100 offen offset:2048 sc1
    buffer_load_dwordx2 v[46:47], v18, s[44:47], s100 offen offset:3072 sc1
    s_waitcnt vmcnt(0)
L_ck_108:
    v_xor_b32 v48, v40, v252
    v_bitop3_b32 v48, v48, v42, v252 bitop3:0xf6
    v_bitop3_b32 v48, v48, v44, v252 bitop3:0xf6
    v_bitop3_b32 v48, v48, v46, v252 bitop3:0xf6
    v_cmp_ne_u32 vcc, 0, v48
    s_cbranch_vccz L_ok_109
    s_sub_u32 s84, s84, 1
    s_cmp_gt_i32 s84, 0
    s_cbranch_scc1 L_rt_107
L_ok_109:
    s_getreg_b32 s57, hwreg(HW_REG_XCC_ID, 0, 4)
    s_and_b32 s58, s2, 7
    v_and_b32 v48, 7, v1
    v_cmp_eq_u32 s[92:93], s58, v48
    v_xor_b32 v48, s57, v41
    v_bitop3_b32 v48, v48, v43, s57 bitop3:0xf6
    v_bitop3_b32 v48, v48, v45, s57 bitop3:0xf6
    v_bitop3_b32 v48, v48, v47, s57 bitop3:0xf6
    v_cmp_ne_u32 vcc, 0, v48
    v_mov_b32 v49, 156160
    s_and_b64 vcc, vcc, s[92:93]
    s_cselect_b32 s57, 3, 0
    v_mov_b32 v48, s57
    ds_write_b32 v49, v48
    s_waitcnt lgkmcnt(0)
L_g_106:
    s_lshl_b32 s66, s54, 7
    s_add_u32 s66, s66, s56
    s_add_u32 m0, s74, 110976
    s_nop 0
    buffer_load_dwordx4 v70, s[32:35], s66 offen lds
    s_add_u32 m0, s74, 112000
    s_nop 0
    buffer_load_dwordx4 v71, s[32:35], s66 offen lds
    s_add_u32 m0, s74, 113024
    s_add_u32 s66, s66, 18432
    buffer_load_dwordx4 v70, s[32:35], s66 offen lds
    s_add_u32 m0, s74, 114048
    s_nop 0
    buffer_load_dwordx4 v71, s[32:35], s66 offen lds
    s_mul_i32 s67, s54, s63
    s_add_u32 m0, s96, 127360
    s_nop 0
    buffer_load_dwordx4 v34, s[36:39], s67 offen lds
    s_add_u32 m0, s96, 128384
    s_nop 0
    buffer_load_dwordx4 v35, s[36:39], s67 offen lds
    s_add_u32 m0, s96, 129408
    s_nop 0
    buffer_load_dwordx4 v36, s[36:39], s67 offen lds
    s_add_u32 m0, s96, 130432
    s_nop 0
    buffer_load_dwordx4 v37, s[36:39], s67 offen lds
    s_add_u32 m0, s96, 131456
    s_add_u32 s54, s54, 1
    buffer_load_dwordx4 v38, s[36:39], s67 offen lds
    s_cmp_eq_u32 s54, 9
    s_cselect_b32 s54, 0, s54
    s_waitcnt vmcnt(9)
L_vw_110:
    s_barrier
    s_mov_b32 m0, s88
    s_add_u32 s88, s88, 4096
    buffer_load_dwordx4 v18, s[44:47], s97 offen sc1 lds
    s_add_u32 s97, s97, 4096
    s_sub_u32 s60, s97, 151552
    s_min_u32 s97, s97, s60
    s_mov_b32 m0, s88
    s_add_u32 s88, s88, 4096
    buffer_load_dwordx4 v18, s[44:47], s97 offen sc1 lds
    s_add_u32 s97, s97, 4096
    s_sub_u32 s60, s97, 151552
    s_min_u32 s97, s97, s60
    s_mov_b32 m0, s88
    s_add_u32 s88, s88, 4096
    buffer_load_dwordx4 v18, s[44:47], s97 offen sc1 lds
    s_add_u32 s97, s97, 4096
    s_sub_u32 s60, s97, 151552
    s_min_u32 s97, s97, s60
    s_mov_b32 m0, s88
    s_add_u32 s88, s88, 4096
    buffer_load_dwordx4 v18, s[44:47], s97 offen sc1 lds
    s_add_u32 s97, s97, 4096
    s_sub_u32 s60, s97, 151552
    s_min_u32 s97, s97, s60
    s_mov_b32 m0, s88
    s_add_u32 s88, s88, 4096
    buffer_load_dwordx4 v18, s[44:47], s97 offen sc1 lds
    s_add_u32 s97, s97, 4096
    s_sub_u32 s60, s97, 151552
    s_min_u32 s97, s97, s60
    s_mov_b32 m0, s88
    s_add_u32 s88, s88, 4096
    buffer_load_dwordx4 v18, s[44:47], s97 offen sc1 lds
    s_add_u32 s97, s97, 4096
    s_sub_u32 s60, s97, 151552
    s_min_u32 s97, s97, s60
    s_mov_b32 m0, s88
    s_add_u32 s88, s88, 4096
    buffer_load_dwordx4 v18, s[44:47], s97 offen sc1 lds
    s_add_u32 s97, s97, 4096
    s_sub_u32 s60, s97, 151552
    s_min_u32 s97, s97, s60
    s_mov_b32 m0, s88
    s_add_u32 s88, s88, 4096
    buffer_load_dwordx4 v18, s[44:47], s97 offen sc1 lds
    s_add_u32 s97, s97, 4096
    s_sub_u32 s60, s97, 151552
    s_min_u32 s97, s97, s60
    s_mov_b32 m0, s88
    s_add_u32 s88, s88, 4096
    buffer_load_dwordx4 v18, s[44:47], s97 offen sc1 lds
    s_add_u32 s97, s97, 4096
    s_sub_u32 s60, s97, 151552
    s_min_u32 s97, s97, s60
    s_mov_b32 s32, s10
    s_and_b32 s33, s11, 0xffff
    s_mov_b32 s34, 663552
    s_mov_b32 s35, 0x00020000
    s_mov_b32 s36, s20
    s_and_b32 s37, s21, 0xffff
    s_mov_b32 s38, 663552
    s_mov_b32 s39, 0x00020000
    s_mov_b32 s40, s24
    s_and_b32 s41, s25, 0xffff
    s_mov_b32 s42, 2359296
    s_mov_b32 s43, 0x00020000
    s_waitcnt vmcnt(9)
    s_barrier
    s_mov_b32 m0, s88
    s_add_u32 s88, s88, 4096
    buffer_load_dwordx4 v18, s[44:47], s97 offen sc1 lds
    s_add_u32 s97, s97, 4096
    s_sub_u32 s60, s97, 151552
    s_min_u32 s97, s97, s60
    s_mov_b32 m0, s88
    s_add_u32 s88, s88, 4096
    buffer_load_dwordx4 v18, s[44:47], s97 offen sc1 lds
    s_add_u32 s97, s97, 4096
    s_sub_u32 s60, s97, 151552
    s_min_u32 s97, s97, s60
    s_mov_b32 m0, s88
    s_add_u32 s88, s88, 4096
    buffer_load_dwordx4 v18, s[44:47], s97 offen sc1 lds
    s_add_u32 s97, s97, 4096
    s_sub_u32 s60, s97, 151552
    s_min_u32 s97, s97, s60
    s_mov_b32 m0, s88
    s_add_u32 s88, s88, 4096
    buffer_load_dwordx4 v18, s[44:47], s97 offen sc1 lds
    s_add_u32 s97, s97, 4096
    s_sub_u32 s60, s97, 151552
    s_min_u32 s97, s97, s60
    s_cmp_lg_u32 s53, 0
    s_cbranch_scc1 L_g_111
    v_mul_u32_u24 v56, 52, v1
    buffer_load_dword v57, v56, s[44:47], s85 offen sc1
L_g_111:
    ds_read_b64_tr_b16 v[40:41], v30
    ds_read_b64_tr_b16 v[42:43], v30 offset:384
    ds_read_b64_tr_b16 v[44:45], v30 offset:960
    ds_read_b64_tr_b16 v[46:47], v30 offset:1344
    ds_read_b64_tr_b16 v[48:49], v27 offset:768
    ds_read_b32 v60, v61
    s_waitcnt vmcnt(10) lgkmcnt(0)
    s_setprio 2
    s_barrier
    ds_read_b128 v[132:135], v225 offset:512
    ds_read_b128 v[72:75], v224 offset:0
    ds_read_b128 v[88:91], v224 offset:1024
    ds_read_b128 v[128:131], v225
    ds_read_b32 v140, v226 offset:1024
    ds_read_b128 v[64:67], v224 offset:2048
    ds_read_b128 v[80:83], v224 offset:3072
    s_waitcnt lgkmcnt(6)
    v_cvt_pk_bf16_f32 v132, v132, v133
    v_cvt_pk_bf16_f32 v133, v134, v135
    v_cndmask_b32 v48, v48, 0, s[76:77]
    v_cndmask_b32 v49, 0, v49, s[76:77]
    v_readfirstlane_b32 s100, v60
    s_and_b32 s57, s51, 2
    s_or_b32 s100, s100, s57
    v_mfma_f32_32x32x4_2b_bf16 v[144:175], v[48:49], v[132:133], 0
    s_waitcnt lgkmcnt(0)
    s_nop 15
    s_nop 0
    v_mfma_f32_32x32x16_bf16 v[144:159], v[40:43], v[72:75], v[144:159]
    v_mfma_f32_32x32x16_bf16 v[160:175], v[44:47], v[88:91], v[160:175]
    s_branch L_epi
L_stream1:
    v_exp_f32 v80, v80
    v_exp_f32 v81, v81
    v_exp_f32 v82, v82
    v_exp_f32 v83, v83
    s_waitcnt lgkmcnt(0)
    v_exp_f32 v84, v84
    v_exp_f32 v85, v85
    v_exp_f32 v86, v86
    v_exp_f32 v87, v87
    v_mfma_f32_32x32x4_2b_bf16 v[112:143], v[30:31], v[16:17], 0
    v_exp_f32 v88, v88
    v_exp_f32 v89, v89
    v_exp_f32 v90, v90
    v_exp_f32 v91, v91
    v_exp_f32 v92, v92
    v_exp_f32 v93, v93
    v_exp_f32 v94, v94
    v_exp_f32 v95, v95
    v_smfmac_f32_32x32x32_bf16 v[48:63], v[32:35], v[80:87], v2
    ds_read_b128 v[20:23], v3 offset:9472
    v_exp_f32 v96, v96
    v_exp_f32 v97, v97
    v_exp_f32 v98, v98
    v_exp_f32 v99, v99
    v_smfmac_f32_32x32x32_bf16 v[48:63], v[36:39], v[88:95], v2
    ds_read_b32 v28, v4 offset:9472
    s_setprio 0
    v_exp_f32 v100, v100
    v_exp_f32 v101, v101
    v_exp_f32 v102, v102
    v_exp_f32 v103, v103
    v_mfma_f32_32x32x16_bf16 v[112:127], v[24:27], v[8:11], v[112:127]
    ds_read_b128 v[40:43], v5 offset:4736
    s_setprio 1
    v_exp_f32 v104, v104
    v_exp_f32 v105, v105
    v_exp_f32 v106, v106
    v_exp_f32 v107, v107
    v_smfmac_f32_32x32x32_bf16 v[64:79], v[32:35], v[96:103], v2
    ds_read_b128 v[44:47], v5 offset:5344
    v_exp_f32 v108, v108
    v_exp_f32 v109, v109
    v_exp_f32 v110, v110
    v_exp_f32 v111, v111
    v_mfma_f32_32x32x16_bf16 v[128:143], v[24:27], v[12:15], v[128:143]
    v_exp_f32 v112, v112
    v_exp_f32 v113, v113
    v_exp_f32 v114, v114
    v_exp_f32 v115, v115
    v_smfmac_f32_32x32x32_bf16 v[64:79], v[36:39], v[104:111], v2
    s_waitcnt lgkmcnt(0)
    v_exp_f32 v116, v116
    v_exp_f32 v117, v117
    v_exp_f32 v118, v118
    v_exp_f32 v119, v119
    v_mfma_f32_32x32x4_2b_bf16 v[80:111], v[28:29], v[16:17], 0
    v_exp_f32 v120, v120
    v_exp_f32 v121, v121
    v_exp_f32 v122, v122
    v_exp_f32 v123, v123
    v_exp_f32 v124, v124
    v_exp_f32 v125, v125
    v_exp_f32 v126, v126
    v_exp_f32 v127, v127
    v_smfmac_f32_32x32x32_bf16 v[48:63], v[40:43], v[112:119], v2
    ds_read_b128 v[24:27], v3 offset:14208
    v_exp_f32 v128, v128
    v_exp_f32 v129, v129
    v_exp_f32 v130, v130
    v_exp_f32 v131, v131
    v_smfmac_f32_32x32x32_bf16 v[48:63], v[44:47], v[120:127], v2
    ds_read_b32 v30, v4 offset:14208
    s_setprio 0
    v_exp_f32 v132, v132
    v_exp_f32 v133, v133
    v_exp_f32 v134, v134
    v_exp_f32 v135, v135
    v_mfma_f32_32x32x16_bf16 v[80:95], v[20:23], v[8:11], v[80:95]
    ds_read_b128 v[32:35], v5 offset:9472
    s_setprio 1
    v_exp_f32 v136, v136
    v_exp_f32 v137, v137
    v_exp_f32 v138, v138
    v_exp_f32 v139, v139
    v_smfmac_f32_32x32x32_bf16 v[64:79], v[40:43], v[128:135], v2
    ds_read_b128 v[36:39], v5 offset:10080
    v_exp_f32 v140, v140
    v_exp_f32 v141, v141
    v_exp_f32 v142, v142
    v_exp_f32 v143, v143
    v_mfma_f32_32x32x16_bf16 v[96:111], v[20:23], v[12:15], v[96:111]
    v_exp_f32 v80, v80
    v_exp_f32 v81, v81
    v_exp_f32 v82, v82
    v_exp_f32 v83, v83
    v_smfmac_f32_32x32x32_bf16 v[64:79], v[44:47], v[136:143], v2
    s_waitcnt lgkmcnt(0)
    v_exp_f32 v84, v84
    v_exp_f32 v85, v85
    v_exp_f32 v86, v86
    v_exp_f32 v87, v87
    v_mfma_f32_32x32x4_2b_bf16 v[112:143], v[30:31], v[16:17], 0
    v_exp_f32 v88, v88
    v_exp_f32 v89, v89
    v_exp_f32 v90, v90
    v_exp_f32 v91, v91
    v_exp_f32 v92, v92
    v_exp_f32 v93, v93
    v_exp_f32 v94, v94
    v_exp_f32 v95, v95
    v_smfmac_f32_32x32x32_bf16 v[48:63], v[32:35], v[80:87], v2
    ds_read_b128 v[20:23], v3 offset:18944
    v_exp_f32 v96, v96
    v_exp_f32 v97, v97
    v_exp_f32 v98, v98
    v_exp_f32 v99, v99
    v_smfmac_f32_32x32x32_bf16 v[48:63], v[36:39], v[88:95], v2
    ds_read_b32 v28, v4 offset:18944
    s_setprio 0
    v_exp_f32 v100, v100
    v_exp_f32 v101, v101
    v_exp_f32 v102, v102
    v_exp_f32 v103, v103
    v_mfma_f32_32x32x16_bf16 v[112:127], v[24:27], v[8:11], v[112:127]
    ds_read_b128 v[40:43], v5 offset:14208
    s_setprio 1
    v_exp_f32 v104, v104
    v_exp_f32 v105, v105
    v_exp_f32 v106, v106
    v_exp_f32 v107, v107
    v_smfmac_f32_32x32x32_bf16 v[64:79], v[32:35], v[96:103], v2
    ds_read_b128 v[44:47], v5 offset:14816
    v_exp_f32 v108, v108
    v_exp_f32 v109, v109
    v_exp_f32 v110, v110
    v_exp_f32 v111, v111
    v_mfma_f32_32x32x16_bf16 v[128:143], v[24:27], v[12:15], v[128:143]
    v_exp_f32 v112, v112
    v_exp_f32 v113, v113
    v_exp_f32 v114, v114
    v_exp_f32 v115, v115
    v_smfmac_f32_32x32x32_bf16 v[64:79], v[36:39], v[104:111], v2
    s_waitcnt lgkmcnt(0)
    v_exp_f32 v116, v116
    v_exp_f32 v117, v117
    v_exp_f32 v118, v118
    v_exp_f32 v119, v119
    v_mfma_f32_32x32x4_2b_bf16 v[80:111], v[28:29], v[16:17], 0
    v_exp_f32 v120, v120
    v_exp_f32 v121, v121
    v_exp_f32 v122, v122
    v_exp_f32 v123, v123
    v_exp_f32 v124, v124
    v_exp_f32 v125, v125
    v_exp_f32 v126, v126
    v_exp_f32 v127, v127
    v_smfmac_f32_32x32x32_bf16 v[48:63], v[40:43], v[112:119], v2
    ds_read_b128 v[24:27], v3 offset:23680
    v_exp_f32 v128, v128
    v_exp_f32 v129, v129
    v_exp_f32 v130, v130
    v_exp_f32 v131, v131
    v_smfmac_f32_32x32x32_bf16 v[48:63], v[44:47], v[120:127], v2
    ds_read_b32 v30, v4 offset:23680
    s_setprio 0
    v_exp_f32 v132, v132
    v_exp_f32 v133, v133
    v_exp_f32 v134, v134
    v_exp_f32 v135, v135
    v_mfma_f32_32x32x16_bf16 v[80:95], v[20:23], v[8:11], v[80:95]
    ds_read_b128 v[32:35], v5 offset:18944
    s_setprio 1
    v_exp_f32 v136, v136
    v_exp_f32 v137, v137
    v_exp_f32 v138, v138
    v_exp_f32 v139, v139
    v_smfmac_f32_32x32x32_bf16 v[64:79], v[40:43], v[128:135], v2
    ds_read_b128 v[36:39], v5 offset:19552
    v_exp_f32 v140, v140
    v_exp_f32 v141, v141
    v_exp_f32 v142, v142
    v_exp_f32 v143, v143
    v_mfma_f32_32x32x16_bf16 v[96:111], v[20:23], v[12:15], v[96:111]
    v_exp_f32 v80, v80
    v_exp_f32 v81, v81
    v_exp_f32 v82, v82
    v_exp_f32 v83, v83
    v_smfmac_f32_32x32x32_bf16 v[64:79], v[44:47], v[136:143], v2
    s_waitcnt lgkmcnt(0)
    v_exp_f32 v84, v84
    v_exp_f32 v85, v85
    v_exp_f32 v86, v86
    v_exp_f32 v87, v87
    v_mfma_f32_32x32x4_2b_bf16 v[112:143], v[30:31], v[16:17], 0
    v_exp_f32 v88, v88
    v_exp_f32 v89, v89
    v_exp_f32 v90, v90
    v_exp_f32 v91, v91
    v_exp_f32 v92, v92
    v_exp_f32 v93, v93
    v_exp_f32 v94, v94
    v_exp_f32 v95, v95
    v_smfmac_f32_32x32x32_bf16 v[48:63], v[32:35], v[80:87], v2
    ds_read_b128 v[20:23], v3 offset:28416
    v_exp_f32 v96, v96
    v_exp_f32 v97, v97
    v_exp_f32 v98, v98
    v_exp_f32 v99, v99
    v_smfmac_f32_32x32x32_bf16 v[48:63], v[36:39], v[88:95], v2
    ds_read_b32 v28, v4 offset:28416
    s_setprio 0
    v_exp_f32 v100, v100
    v_exp_f32 v101, v101
    v_exp_f32 v102, v102
    v_exp_f32 v103, v103
    v_mfma_f32_32x32x16_bf16 v[112:127], v[24:27], v[8:11], v[112:127]
    ds_read_b128 v[40:43], v5 offset:23680
    s_setprio 1
    v_exp_f32 v104, v104
    v_exp_f32 v105, v105
    v_exp_f32 v106, v106
    v_exp_f32 v107, v107
    v_smfmac_f32_32x32x32_bf16 v[64:79], v[32:35], v[96:103], v2
    ds_read_b128 v[44:47], v5 offset:24288
    v_exp_f32 v108, v108
    v_exp_f32 v109, v109
    v_exp_f32 v110, v110
    v_exp_f32 v111, v111
    v_mfma_f32_32x32x16_bf16 v[128:143], v[24:27], v[12:15], v[128:143]
    v_exp_f32 v112, v112
    v_exp_f32 v113, v113
    v_exp_f32 v114, v114
    v_exp_f32 v115, v115
    v_smfmac_f32_32x32x32_bf16 v[64:79], v[36:39], v[104:111], v2
    s_waitcnt lgkmcnt(0)
    v_exp_f32 v116, v116
    v_exp_f32 v117, v117
    v_exp_f32 v118, v118
    v_exp_f32 v119, v119
    v_mfma_f32_32x32x4_2b_bf16 v[80:111], v[28:29], v[16:17], 0
    v_exp_f32 v120, v120
    v_exp_f32 v121, v121
    v_exp_f32 v122, v122
    v_exp_f32 v123, v123
    v_exp_f32 v124, v124
    v_exp_f32 v125, v125
    v_exp_f32 v126, v126
    v_exp_f32 v127, v127
    v_smfmac_f32_32x32x32_bf16 v[48:63], v[40:43], v[112:119], v2
    ds_read_b128 v[24:27], v3 offset:33152
    v_exp_f32 v128, v128
    v_exp_f32 v129, v129
    v_exp_f32 v130, v130
    v_exp_f32 v131, v131
    v_smfmac_f32_32x32x32_bf16 v[48:63], v[44:47], v[120:127], v2
    ds_read_b32 v30, v4 offset:33152
    s_setprio 0
    v_exp_f32 v132, v132
    v_exp_f32 v133, v133
    v_exp_f32 v134, v134
    v_exp_f32 v135, v135
    v_mfma_f32_32x32x16_bf16 v[80:95], v[20:23], v[8:11], v[80:95]
    ds_read_b128 v[32:35], v5 offset:28416
    s_setprio 1
    v_exp_f32 v136, v136
    v_exp_f32 v137, v137
    v_exp_f32 v138, v138
    v_exp_f32 v139, v139
    v_smfmac_f32_32x32x32_bf16 v[64:79], v[40:43], v[128:135], v2
    ds_read_b128 v[36:39], v5 offset:29024
    v_exp_f32 v140, v140
    v_exp_f32 v141, v141
    v_exp_f32 v142, v142
    v_exp_f32 v143, v143
    v_mfma_f32_32x32x16_bf16 v[96:111], v[20:23], v[12:15], v[96:111]
    v_exp_f32 v80, v80
    v_exp_f32 v81, v81
    v_exp_f32 v82, v82
    v_exp_f32 v83, v83
    v_smfmac_f32_32x32x32_bf16 v[64:79], v[44:47], v[136:143], v2
    s_waitcnt lgkmcnt(0)
    v_exp_f32 v84, v84
    v_exp_f32 v85, v85
    v_exp_f32 v86, v86
    v_exp_f32 v87, v87
    v_mfma_f32_32x32x4_2b_bf16 v[112:143], v[30:31], v[16:17], 0
    v_exp_f32 v88, v88
    v_exp_f32 v89, v89
    v_exp_f32 v90, v90
    v_exp_f32 v91, v91
    v_exp_f32 v92, v92
    v_exp_f32 v93, v93
    v_exp_f32 v94, v94
    v_exp_f32 v95, v95
    v_smfmac_f32_32x32x32_bf16 v[48:63], v[32:35], v[80:87], v2
    ds_read_b128 v[20:23], v3 offset:37888
    v_exp_f32 v96, v96
    v_exp_f32 v97, v97
    v_exp_f32 v98, v98
    v_exp_f32 v99, v99
    v_smfmac_f32_32x32x32_bf16 v[48:63], v[36:39], v[88:95], v2
    ds_read_b32 v28, v4 offset:37888
    s_setprio 0
    v_exp_f32 v100, v100
    v_exp_f32 v101, v101
    v_exp_f32 v102, v102
    v_exp_f32 v103, v103
    v_mfma_f32_32x32x16_bf16 v[112:127], v[24:27], v[8:11], v[112:127]
    ds_read_b128 v[40:43], v5 offset:33152
    s_setprio 1
    v_exp_f32 v104, v104
    v_exp_f32 v105, v105
    v_exp_f32 v106, v106
    v_exp_f32 v107, v107
    v_smfmac_f32_32x32x32_bf16 v[64:79], v[32:35], v[96:103], v2
    ds_read_b128 v[44:47], v5 offset:33760
    v_exp_f32 v108, v108
    v_exp_f32 v109, v109
    v_exp_f32 v110, v110
    v_exp_f32 v111, v111
    v_mfma_f32_32x32x16_bf16 v[128:143], v[24:27], v[12:15], v[128:143]
    v_exp_f32 v112, v112
    v_exp_f32 v113, v113
    v_exp_f32 v114, v114
    v_exp_f32 v115, v115
    v_smfmac_f32_32x32x32_bf16 v[64:79], v[36:39], v[104:111], v2
    s_waitcnt lgkmcnt(0)
    v_exp_f32 v116, v116
    v_exp_f32 v117, v117
    v_exp_f32 v118, v118
    v_exp_f32 v119, v119
    v_mfma_f32_32x32x4_2b_bf16 v[80:111], v[28:29], v[16:17], 0
    v_exp_f32 v120, v120
    v_exp_f32 v121, v121
    v_exp_f32 v122, v122
    v_exp_f32 v123, v123
    v_exp_f32 v124, v124
    v_exp_f32 v125, v125
    v_exp_f32 v126, v126
    v_exp_f32 v127, v127
    v_smfmac_f32_32x32x32_bf16 v[48:63], v[40:43], v[112:119], v2
    ds_read_b128 v[24:27], v3 offset:42624
    v_exp_f32 v128, v128
    v_exp_f32 v129, v129
    v_exp_f32 v130, v130
    v_exp_f32 v131, v131
    v_smfmac_f32_32x32x32_bf16 v[48:63], v[44:47], v[120:127], v2
    ds_read_b32 v30, v4 offset:42624
    s_setprio 0
    v_exp_f32 v132, v132
    v_exp_f32 v133, v133
    v_exp_f32 v134, v134
    v_exp_f32 v135, v135
    v_mfma_f32_32x32x16_bf16 v[80:95], v[20:23], v[8:11], v[80:95]
    ds_read_b128 v[32:35], v5 offset:37888
    s_setprio 1
    v_exp_f32 v136, v136
    v_exp_f32 v137, v137
    v_exp_f32 v138, v138
    v_exp_f32 v139, v139
    v_smfmac_f32_32x32x32_bf16 v[64:79], v[40:43], v[128:135], v2
    ds_read_b128 v[36:39], v5 offset:38496
    v_exp_f32 v140, v140
    v_exp_f32 v141, v141
    v_exp_f32 v142, v142
    v_exp_f32 v143, v143
    v_mfma_f32_32x32x16_bf16 v[96:111], v[20:23], v[12:15], v[96:111]
    s_barrier
    v_exp_f32 v80, v80
    v_exp_f32 v81, v81
    v_exp_f32 v82, v82
    v_exp_f32 v83, v83
    v_smfmac_f32_32x32x32_bf16 v[64:79], v[44:47], v[136:143], v2
    s_waitcnt lgkmcnt(0)
    v_exp_f32 v84, v84
    v_exp_f32 v85, v85
    v_exp_f32 v86, v86
    v_exp_f32 v87, v87
    v_mfma_f32_32x32x4_2b_bf16 v[112:143], v[30:31], v[16:17], 0
    v_exp_f32 v88, v88
    v_exp_f32 v89, v89
    v_exp_f32 v90, v90
    v_exp_f32 v91, v91
    v_exp_f32 v92, v92
    v_exp_f32 v93, v93
    v_exp_f32 v94, v94
    v_exp_f32 v95, v95
    v_smfmac_f32_32x32x32_bf16 v[48:63], v[32:35], v[80:87], v2
    ds_read_b128 v[20:23], v3 offset:47360
    v_exp_f32 v96, v96
    v_exp_f32 v97, v97
    v_exp_f32 v98, v98
    v_exp_f32 v99, v99
    v_smfmac_f32_32x32x32_bf16 v[48:63], v[36:39], v[88:95], v2
    ds_read_b32 v28, v4 offset:47360
    s_setprio 0
    v_exp_f32 v100, v100
    v_exp_f32 v101, v101
    v_exp_f32 v102, v102
    v_exp_f32 v103, v103
    v_mfma_f32_32x32x16_bf16 v[112:127], v[24:27], v[8:11], v[112:127]
    ds_read_b128 v[40:43], v5 offset:42624
    s_setprio 1
    v_exp_f32 v104, v104
    v_exp_f32 v105, v105
    v_exp_f32 v106, v106
    v_exp_f32 v107, v107
    v_smfmac_f32_32x32x32_bf16 v[64:79], v[32:35], v[96:103], v2
    ds_read_b128 v[44:47], v5 offset:43232
    v_exp_f32 v108, v108
    v_exp_f32 v109, v109
    v_exp_f32 v110, v110
    v_exp_f32 v111, v111
    v_mfma_f32_32x32x16_bf16 v[128:143], v[24:27], v[12:15], v[128:143]
    v_exp_f32 v112, v112
    v_exp_f32 v113, v113
    v_exp_f32 v114, v114
    v_exp_f32 v115, v115
    v_smfmac_f32_32x32x32_bf16 v[64:79], v[36:39], v[104:111], v2
    s_waitcnt lgkmcnt(0)
    v_exp_f32 v116, v116
    v_exp_f32 v117, v117
    v_exp_f32 v118, v118
    v_exp_f32 v119, v119
    v_mfma_f32_32x32x4_2b_bf16 v[80:111], v[28:29], v[16:17], 0
    v_exp_f32 v120, v120
    v_exp_f32 v121, v121
    v_exp_f32 v122, v122
    v_exp_f32 v123, v123
    v_exp_f32 v124, v124
    v_exp_f32 v125, v125
    v_exp_f32 v126, v126
    v_exp_f32 v127, v127
    v_smfmac_f32_32x32x32_bf16 v[48:63], v[40:43], v[112:119], v2
    ds_read_b128 v[24:27], v3 offset:52096
    v_exp_f32 v128, v128
    v_exp_f32 v129, v129
    v_exp_f32 v130, v130
    v_exp_f32 v131, v131
    v_smfmac_f32_32x32x32_bf16 v[48:63], v[44:47], v[120:127], v2
    ds_read_b32 v30, v4 offset:52096
    s_setprio 0
    v_exp_f32 v132, v132
    v_exp_f32 v133, v133
    v_exp_f32 v134, v134
    v_exp_f32 v135, v135
    v_mfma_f32_32x32x16_bf16 v[80:95], v[20:23], v[8:11], v[80:95]
    ds_read_b128 v[32:35], v5 offset:47360
    s_setprio 1
    v_exp_f32 v136, v136
    v_exp_f32 v137, v137
    v_exp_f32 v138, v138
    v_exp_f32 v139, v139
    v_smfmac_f32_32x32x32_bf16 v[64:79], v[40:43], v[128:135], v2
    ds_read_b128 v[36:39], v5 offset:47968
    v_exp_f32 v140, v140
    v_exp_f32 v141, v141
    v_exp_f32 v142, v142
    v_exp_f32 v143, v143
    v_mfma_f32_32x32x16_bf16 v[96:111], v[20:23], v[12:15], v[96:111]
    v_exp_f32 v80, v80
    v_exp_f32 v81, v81
    v_exp_f32 v82, v82
    v_exp_f32 v83, v83
    v_smfmac_f32_32x32x32_bf16 v[64:79], v[44:47], v[136:143], v2
    s_waitcnt lgkmcnt(0)
    v_exp_f32 v84, v84
    v_exp_f32 v85, v85
    v_exp_f32 v86, v86
    v_exp_f32 v87, v87
    v_mfma_f32_32x32x4_2b_bf16 v[112:143], v[30:31], v[16:17], 0
    v_exp_f32 v88, v88
    v_exp_f32 v89, v89
    v_exp_f32 v90, v90
    v_exp_f32 v91, v91
    v_exp_f32 v92, v92
    v_exp_f32 v93, v93
    v_exp_f32 v94, v94
    v_exp_f32 v95, v95
    v_smfmac_f32_32x32x32_bf16 v[48:63], v[32:35], v[80:87], v2
    ds_read_b128 v[20:23], v3 offset:56832
    v_exp_f32 v96, v96
    v_exp_f32 v97, v97
    v_exp_f32 v98, v98
    v_exp_f32 v99, v99
    v_smfmac_f32_32x32x32_bf16 v[48:63], v[36:39], v[88:95], v2
    ds_read_b32 v28, v4 offset:56832
    s_setprio 0
    v_exp_f32 v100, v100
    v_exp_f32 v101, v101
    v_exp_f32 v102, v102
    v_exp_f32 v103, v103
    v_mfma_f32_32x32x16_bf16 v[112:127], v[24:27], v[8:11], v[112:127]
    ds_read_b128 v[40:43], v5 offset:52096
    s_setprio 1
    v_exp_f32 v104, v104
    v_exp_f32 v105, v105
    v_exp_f32 v106, v106
    v_exp_f32 v107, v107
    v_smfmac_f32_32x32x32_bf16 v[64:79], v[32:35], v[96:103], v2
    ds_read_b128 v[44:47], v5 offset:52704
    v_exp_f32 v108, v108
    v_exp_f32 v109, v109
    v_exp_f32 v110, v110
    v_exp_f32 v111, v111
    v_mfma_f32_32x32x16_bf16 v[128:143], v[24:27], v[12:15], v[128:143]
    v_exp_f32 v112, v112
    v_exp_f32 v113, v113
    v_exp_f32 v114, v114
    v_exp_f32 v115, v115
    v_smfmac_f32_32x32x32_bf16 v[64:79], v[36:39], v[104:111], v2
    s_waitcnt lgkmcnt(0)
    v_exp_f32 v116, v116
    v_exp_f32 v117, v117
    v_exp_f32 v118, v118
    v_exp_f32 v119, v119
    v_mfma_f32_32x32x4_2b_bf16 v[80:111], v[28:29], v[16:17], 0
    v_exp_f32 v120, v120
    v_exp_f32 v121, v121
    v_exp_f32 v122, v122
    v_exp_f32 v123, v123
    v_exp_f32 v124, v124
    v_exp_f32 v125, v125
    v_exp_f32 v126, v126
    v_exp_f32 v127, v127
    v_smfmac_f32_32x32x32_bf16 v[48:63], v[40:43], v[112:119], v2
    ds_read_b128 v[24:27], v3 offset:61568
    v_exp_f32 v128, v128
    v_exp_f32 v129, v129
    v_exp_f32 v130, v130
    v_exp_f32 v131, v131
    v_smfmac_f32_32x32x32_bf16 v[48:63], v[44:47], v[120:127], v2
    ds_read_b32 v30, v4 offset:61568
    s_setprio 0
    v_exp_f32 v132, v132
    v_exp_f32 v133, v133
    v_exp_f32 v134, v134
    v_exp_f32 v135, v135
    v_mfma_f32_32x32x16_bf16 v[80:95], v[20:23], v[8:11], v[80:95]
    ds_read_b128 v[32:35], v5 offset:56832
    s_setprio 1
    v_exp_f32 v136, v136
    v_exp_f32 v137, v137
    v_exp_f32 v138, v138
    v_exp_f32 v139, v139
    v_smfmac_f32_32x32x32_bf16 v[64:79], v[40:43], v[128:135], v2
    ds_read_b128 v[36:39], v5 offset:57440
    v_exp_f32 v140, v140
    v_exp_f32 v141, v141
    v_exp_f32 v142, v142
    v_exp_f32 v143, v143
    v_mfma_f32_32x32x16_bf16 v[96:111], v[20:23], v[12:15], v[96:111]
    v_add_u32 v3, 56832, v3
    v_add_u32 v4, 56832, v4
    s_mov_b32 s57, 56832
    v_mad_u32_u24 v5, v253, s57, v5
    v_exp_f32 v80, v80
    v_exp_f32 v81, v81
    v_exp_f32 v82, v82
    v_exp_f32 v83, v83
    v_smfmac_f32_32x32x32_bf16 v[64:79], v[44:47], v[136:143], v2
    s_waitcnt lgkmcnt(0)
    v_exp_f32 v84, v84
    v_exp_f32 v85, v85
    v_exp_f32 v86, v86
    v_exp_f32 v87, v87
    v_mfma_f32_32x32x4_2b_bf16 v[112:143], v[30:31], v[16:17], 0
    v_exp_f32 v88, v88
    v_exp_f32 v89, v89
    v_exp_f32 v90, v90
    v_exp_f32 v91, v91
    v_exp_f32 v92, v92
    v_exp_f32 v93, v93
    v_exp_f32 v94, v94
    v_exp_f32 v95, v95
    v_smfmac_f32_32x32x32_bf16 v[48:63], v[32:35], v[80:87], v2
    ds_read_b128 v[20:23], v3 offset:9472
    v_exp_f32 v96, v96
    v_exp_f32 v97, v97
    v_exp_f32 v98, v98
    v_exp_f32 v99, v99
    v_smfmac_f32_32x32x32_bf16 v[48:63], v[36:39], v[88:95], v2
    ds_read_b32 v28, v4 offset:9472
    s_setprio 0
    v_exp_f32 v100, v100
    v_exp_f32 v101, v101
    v_exp_f32 v102, v102
    v_exp_f32 v103, v103
    v_mfma_f32_32x32x16_bf16 v[112:127], v[24:27], v[8:11], v[112:127]
    ds_read_b128 v[40:43], v5 offset:4736
    s_setprio 1
    v_exp_f32 v104, v104
    v_exp_f32 v105, v105
    v_exp_f32 v106, v106
    v_exp_f32 v107, v107
    v_smfmac_f32_32x32x32_bf16 v[64:79], v[32:35], v[96:103], v2
    ds_read_b128 v[44:47], v5 offset:5344
    v_exp_f32 v108, v108
    v_exp_f32 v109, v109
    v_exp_f32 v110, v110
    v_exp_f32 v111, v111
    v_mfma_f32_32x32x16_bf16 v[128:143], v[24:27], v[12:15], v[128:143]
    v_exp_f32 v112, v112
    v_exp_f32 v113, v113
    v_exp_f32 v114, v114
    v_exp_f32 v115, v115
    v_smfmac_f32_32x32x32_bf16 v[64:79], v[36:39], v[104:111], v2
    s_waitcnt lgkmcnt(0)
    v_exp_f32 v116, v116
    v_exp_f32 v117, v117
    v_exp_f32 v118, v118
    v_exp_f32 v119, v119
    v_mfma_f32_32x32x4_2b_bf16 v[80:111], v[28:29], v[16:17], 0
    v_exp_f32 v120, v120
    v_exp_f32 v121, v121
    v_exp_f32 v122, v122
    v_exp_f32 v123, v123
    v_exp_f32 v124, v124
    v_exp_f32 v125, v125
    v_exp_f32 v126, v126
    v_exp_f32 v127, v127
    v_smfmac_f32_32x32x32_bf16 v[48:63], v[40:43], v[112:119], v2
    ds_read_b128 v[24:27], v3 offset:14208
    v_exp_f32 v128, v128
    v_exp_f32 v129, v129
    v_exp_f32 v130, v130
    v_exp_f32 v131, v131
    v_smfmac_f32_32x32x32_bf16 v[48:63], v[44:47], v[120:127], v2
    ds_read_b32 v30, v4 offset:14208
    s_setprio 0
    v_exp_f32 v132, v132
    v_exp_f32 v133, v133
    v_exp_f32 v134, v134
    v_exp_f32 v135, v135
    v_mfma_f32_32x32x16_bf16 v[80:95], v[20:23], v[8:11], v[80:95]
    ds_read_b128 v[32:35], v5 offset:9472
    s_setprio 1
    v_exp_f32 v136, v136
    v_exp_f32 v137, v137
    v_exp_f32 v138, v138
    v_exp_f32 v139, v139
    v_smfmac_f32_32x32x32_bf16 v[64:79], v[40:43], v[128:135], v2
    ds_read_b128 v[36:39], v5 offset:10080
    v_exp_f32 v140, v140
    v_exp_f32 v141, v141
    v_exp_f32 v142, v142
    v_exp_f32 v143, v143
    v_mfma_f32_32x32x16_bf16 v[96:111], v[20:23], v[12:15], v[96:111]
    v_exp_f32 v80, v80
    v_exp_f32 v81, v81
    v_exp_f32 v82, v82
    v_exp_f32 v83, v83
    v_smfmac_f32_32x32x32_bf16 v[64:79], v[44:47], v[136:143], v2
    s_waitcnt lgkmcnt(0)
    v_exp_f32 v84, v84
    v_exp_f32 v85, v85
    v_exp_f32 v86, v86
    v_exp_f32 v87, v87
    v_mfma_f32_32x32x4_2b_bf16 v[112:143], v[30:31], v[16:17], 0
    v_exp_f32 v88, v88
    v_exp_f32 v89, v89
    v_exp_f32 v90, v90
    v_exp_f32 v91, v91
    v_exp_f32 v92, v92
    v_exp_f32 v93, v93
    v_exp_f32 v94, v94
    v_exp_f32 v95, v95
    v_smfmac_f32_32x32x32_bf16 v[48:63], v[32:35], v[80:87], v2
    ds_read_b128 v[20:23], v3 offset:18944
    v_exp_f32 v96, v96
    v_exp_f32 v97, v97
    v_exp_f32 v98, v98
    v_exp_f32 v99, v99
    v_smfmac_f32_32x32x32_bf16 v[48:63], v[36:39], v[88:95], v2
    ds_read_b32 v28, v4 offset:18944
    s_setprio 0
    v_exp_f32 v100, v100
    v_exp_f32 v101, v101
    v_exp_f32 v102, v102
    v_exp_f32 v103, v103
    v_mfma_f32_32x32x16_bf16 v[112:127], v[24:27], v[8:11], v[112:127]
    ds_read_b128 v[40:43], v5 offset:14208
    s_setprio 1
    v_exp_f32 v104, v104
    v_exp_f32 v105, v105
    v_exp_f32 v106, v106
    v_exp_f32 v107, v107
    v_smfmac_f32_32x32x32_bf16 v[64:79], v[32:35], v[96:103], v2
    ds_read_b128 v[44:47], v5 offset:14816
    v_exp_f32 v108, v108
    v_exp_f32 v109, v109
    v_exp_f32 v110, v110
    v_exp_f32 v111, v111
    v_mfma_f32_32x32x16_bf16 v[128:143], v[24:27], v[12:15], v[128:143]
    v_exp_f32 v112, v112
    v_exp_f32 v113, v113
    v_exp_f32 v114, v114
    v_exp_f32 v115, v115
    v_smfmac_f32_32x32x32_bf16 v[64:79], v[36:39], v[104:111], v2
    s_waitcnt lgkmcnt(0)
    v_exp_f32 v116, v116
    v_exp_f32 v117, v117
    v_exp_f32 v118, v118
    v_exp_f32 v119, v119
    v_mfma_f32_32x32x4_2b_bf16 v[80:111], v[28:29], v[16:17], 0
    v_exp_f32 v120, v120
    v_exp_f32 v121, v121
    v_exp_f32 v122, v122
    v_exp_f32 v123, v123
    v_exp_f32 v124, v124
    v_exp_f32 v125, v125
    v_exp_f32 v126, v126
    v_exp_f32 v127, v127
    v_smfmac_f32_32x32x32_bf16 v[48:63], v[40:43], v[112:119], v2
    ds_read_b128 v[24:27], v3 offset:23680
    v_exp_f32 v128, v128
    v_exp_f32 v129, v129
    v_exp_f32 v130, v130
    v_exp_f32 v131, v131
    v_smfmac_f32_32x32x32_bf16 v[48:63], v[44:47], v[120:127], v2
    ds_read_b32 v30, v4 offset:23680
    s_setprio 0
    v_exp_f32 v132, v132
    v_exp_f32 v133, v133
    v_exp_f32 v134, v134
    v_exp_f32 v135, v135
    v_mfma_f32_32x32x16_bf16 v[80:95], v[20:23], v[8:11], v[80:95]
    ds_read_b128 v[32:35], v5 offset:18944
    s_setprio 1
    v_exp_f32 v136, v136
    v_exp_f32 v137, v137
    v_exp_f32 v138, v138
    v_exp_f32 v139, v139
    v_smfmac_f32_32x32x32_bf16 v[64:79], v[40:43], v[128:135], v2
    ds_read_b128 v[36:39], v5 offset:19552
    v_exp_f32 v140, v140
    v_exp_f32 v141, v141
    v_exp_f32 v142, v142
    v_exp_f32 v143, v143
    v_mfma_f32_32x32x16_bf16 v[96:111], v[20:23], v[12:15], v[96:111]
    v_exp_f32 v80, v80
    v_exp_f32 v81, v81
    v_exp_f32 v82, v82
    v_exp_f32 v83, v83
    v_smfmac_f32_32x32x32_bf16 v[64:79], v[44:47], v[136:143], v2
    s_waitcnt lgkmcnt(0)
    v_exp_f32 v84, v84
    v_exp_f32 v85, v85
    v_exp_f32 v86, v86
    v_exp_f32 v87, v87
    v_mfma_f32_32x32x4_2b_bf16 v[112:143], v[30:31], v[16:17], 0
    v_exp_f32 v88, v88
    v_exp_f32 v89, v89
    v_exp_f32 v90, v90
    v_exp_f32 v91, v91
    v_exp_f32 v92, v92
    v_exp_f32 v93, v93
    v_exp_f32 v94, v94
    v_exp_f32 v95, v95
    v_smfmac_f32_32x32x32_bf16 v[48:63], v[32:35], v[80:87], v2
    ds_read_b128 v[20:23], v3 offset:28416
    v_exp_f32 v96, v96
    v_exp_f32 v97, v97
    v_exp_f32 v98, v98
    v_exp_f32 v99, v99
    v_smfmac_f32_32x32x32_bf16 v[48:63], v[36:39], v[88:95], v2
    ds_read_b32 v28, v4 offset:28416
    s_setprio 0
    v_exp_f32 v100, v100
    v_exp_f32 v101, v101
    v_exp_f32 v102, v102
    v_exp_f32 v103, v103
    v_mfma_f32_32x32x16_bf16 v[112:127], v[24:27], v[8:11], v[112:127]
    ds_read_b128 v[40:43], v5 offset:23680
    s_setprio 1
    v_exp_f32 v104, v104
    v_exp_f32 v105, v105
    v_exp_f32 v106, v106
    v_exp_f32 v107, v107
    v_smfmac_f32_32x32x32_bf16 v[64:79], v[32:35], v[96:103], v2
    ds_read_b128 v[44:47], v5 offset:24288
    v_exp_f32 v108, v108
    v_exp_f32 v109, v109
    v_exp_f32 v110, v110
    v_exp_f32 v111, v111
    v_mfma_f32_32x32x16_bf16 v[128:143], v[24:27], v[12:15], v[128:143]
    v_exp_f32 v112, v112
    v_exp_f32 v113, v113
    v_exp_f32 v114, v114
    v_exp_f32 v115, v115
    v_smfmac_f32_32x32x32_bf16 v[64:79], v[36:39], v[104:111], v2
    s_waitcnt lgkmcnt(0)
    v_exp_f32 v116, v116
    v_exp_f32 v117, v117
    v_exp_f32 v118, v118
    v_exp_f32 v119, v119
    v_mfma_f32_32x32x4_2b_bf16 v[80:111], v[28:29], v[16:17], 0
    v_exp_f32 v120, v120
    v_exp_f32 v121, v121
    v_exp_f32 v122, v122
    v_exp_f32 v123, v123
    v_exp_f32 v124, v124
    v_exp_f32 v125, v125
    v_exp_f32 v126, v126
    v_exp_f32 v127, v127
    v_smfmac_f32_32x32x32_bf16 v[48:63], v[40:43], v[112:119], v2
    ds_read_b128 v[24:27], v3 offset:33152
    v_exp_f32 v128, v128
    v_exp_f32 v129, v129
    v_exp_f32 v130, v130
    v_exp_f32 v131, v131
    v_smfmac_f32_32x32x32_bf16 v[48:63], v[44:47], v[120:127], v2
    ds_read_b32 v30, v4 offset:33152
    s_setprio 0
    v_exp_f32 v132, v132
    v_exp_f32 v133, v133
    v_exp_f32 v134, v134
    v_exp_f32 v135, v135
    v_mfma_f32_32x32x16_bf16 v[80:95], v[20:23], v[8:11], v[80:95]
    ds_read_b128 v[32:35], v5 offset:28416
    s_setprio 1
    v_exp_f32 v136, v136
    v_exp_f32 v137, v137
    v_exp_f32 v138, v138
    v_exp_f32 v139, v139
    v_smfmac_f32_32x32x32_bf16 v[64:79], v[40:43], v[128:135], v2
    ds_read_b128 v[36:39], v5 offset:29024
    v_exp_f32 v140, v140
    v_exp_f32 v141, v141
    v_exp_f32 v142, v142
    v_exp_f32 v143, v143
    v_mfma_f32_32x32x16_bf16 v[96:111], v[20:23], v[12:15], v[96:111]
    s_cmp_lg_u32 s53, 0
    s_cbranch_scc1 L_g_112
    s_mul_i32 s59, s86, 6144
    s_add_u32 s59, s59, 5505024
    buffer_load_dwordx4 v[144:147], v18, s[44:47], s59 offen offset:0 sc1
    buffer_load_dwordx4 v[148:151], v18, s[44:47], s59 offen offset:1024 sc1
    buffer_load_dwordx4 v[152:155], v18, s[44:47], s59 offen offset:2048 sc1
    s_add_u32 s59, s59, 3072
    buffer_load_dwordx4 v[156:159], v18, s[44:47], s59 offen offset:0 sc1
    buffer_load_dwordx4 v[160:163], v18, s[44:47], s59 offen offset:1024 sc1
    buffer_load_dwordx4 v[164:167], v18, s[44:47], s59 offen offset:2048 sc1
L_g_112:
    s_barrier
    v_exp_f32 v80, v80
    v_exp_f32 v81, v81
    v_exp_f32 v82, v82
    v_exp_f32 v83, v83
    v_smfmac_f32_32x32x32_bf16 v[64:79], v[44:47], v[136:143], v2
    s_waitcnt lgkmcnt(0)
    v_exp_f32 v84, v84
    v_exp_f32 v85, v85
    v_exp_f32 v86, v86
    v_exp_f32 v87, v87
    v_mfma_f32_32x32x4_2b_bf16 v[112:143], v[30:31], v[16:17], 0
    v_exp_f32 v88, v88
    v_exp_f32 v89, v89
    v_exp_f32 v90, v90
    v_exp_f32 v91, v91
    v_exp_f32 v92, v92
    v_exp_f32 v93, v93
    v_exp_f32 v94, v94
    v_exp_f32 v95, v95
    v_smfmac_f32_32x32x32_bf16 v[48:63], v[32:35], v[80:87], v2
    ds_read_b128 v[20:23], v3 offset:37888
    v_exp_f32 v96, v96
    v_exp_f32 v97, v97
    v_exp_f32 v98, v98
    v_exp_f32 v99, v99
    v_smfmac_f32_32x32x32_bf16 v[48:63], v[36:39], v[88:95], v2
    ds_read_b32 v28, v4 offset:37888
    s_setprio 0
    v_exp_f32 v100, v100
    v_exp_f32 v101, v101
    v_exp_f32 v102, v102
    v_exp_f32 v103, v103
    v_mfma_f32_32x32x16_bf16 v[112:127], v[24:27], v[8:11], v[112:127]
    ds_read_b128 v[40:43], v5 offset:33152
    s_setprio 1
    v_exp_f32 v104, v104
    v_exp_f32 v105, v105
    v_exp_f32 v106, v106
    v_exp_f32 v107, v107
    v_smfmac_f32_32x32x32_bf16 v[64:79], v[32:35], v[96:103], v2
    ds_read_b128 v[44:47], v5 offset:33760
    v_exp_f32 v108, v108
    v_exp_f32 v109, v109
    v_exp_f32 v110, v110
    v_exp_f32 v111, v111
    v_mfma_f32_32x32x16_bf16 v[128:143], v[24:27], v[12:15], v[128:143]
    v_exp_f32 v112, v112
    v_exp_f32 v113, v113
    v_exp_f32 v114, v114
    v_exp_f32 v115, v115
    v_smfmac_f32_32x32x32_bf16 v[64:79], v[36:39], v[104:111], v2
    s_waitcnt lgkmcnt(0)
    v_exp_f32 v116, v116
    v_exp_f32 v117, v117
    v_exp_f32 v118, v118
    v_exp_f32 v119, v119
    v_mfma_f32_32x32x4_2b_bf16 v[80:111], v[28:29], v[16:17], 0
    v_exp_f32 v120, v120
    v_exp_f32 v121, v121
    v_exp_f32 v122, v122
    v_exp_f32 v123, v123
    v_exp_f32 v124, v124
    v_exp_f32 v125, v125
    v_exp_f32 v126, v126
    v_exp_f32 v127, v127
    v_smfmac_f32_32x32x32_bf16 v[48:63], v[40:43], v[112:119], v2
    ds_read_b128 v[24:27], v3 offset:42624
    v_exp_f32 v128, v128
    v_exp_f32 v129, v129
    v_exp_f32 v130, v130
    v_exp_f32 v131, v131
    v_smfmac_f32_32x32x32_bf16 v[48:63], v[44:47], v[120:127], v2
    ds_read_b32 v30, v4 offset:42624
    s_setprio 0
    v_exp_f32 v132, v132
    v_exp_f32 v133, v133
    v_exp_f32 v134, v134
    v_exp_f32 v135, v135
    v_mfma_f32_32x32x16_bf16 v[80:95], v[20:23], v[8:11], v[80:95]
    ds_read_b128 v[32:35], v5 offset:37888
    s_setprio 1
    v_exp_f32 v136, v136
    v_exp_f32 v137, v137
    v_exp_f32 v138, v138
    v_exp_f32 v139, v139
    v_smfmac_f32_32x32x32_bf16 v[64:79], v[40:43], v[128:135], v2
    ds_read_b128 v[36:39], v5 offset:38496
    v_exp_f32 v140, v140
    v_exp_f32 v141, v141
    v_exp_f32 v142, v142
    v_exp_f32 v143, v143
    v_mfma_f32_32x32x16_bf16 v[96:111], v[20:23], v[12:15], v[96:111]
    s_cmp_lg_u32 s53, 0
    s_cbranch_scc1 L_g_113
    s_waitcnt vmcnt(0)
    s_branch L_ck_115
L_rt_114:
    s_mul_i32 s59, s86, 6144
    s_add_u32 s59, s59, 5505024
    buffer_load_dwordx4 v[144:147], v18, s[44:47], s59 offen offset:0 sc1
    buffer_load_dwordx4 v[148:151], v18, s[44:47], s59 offen offset:1024 sc1
    buffer_load_dwordx4 v[152:155], v18, s[44:47], s59 offen offset:2048 sc1
    s_add_u32 s59, s59, 3072
    buffer_load_dwordx4 v[156:159], v18, s[44:47], s59 offen offset:0 sc1
    buffer_load_dwordx4 v[160:163], v18, s[44:47], s59 offen offset:1024 sc1
    buffer_load_dwordx4 v[164:167], v18, s[44:47], s59 offen offset:2048 sc1
    s_waitcnt vmcnt(0)
L_ck_115:
    v_xor_b32 v237, v147, v252
    v_bitop3_b32 v237, v237, v151, v252 bitop3:0xf6
    v_bitop3_b32 v237, v237, v155, v252 bitop3:0xf6
    v_bitop3_b32 v237, v237, v159, v252 bitop3:0xf6
    v_bitop3_b32 v237, v237, v163, v252 bitop3:0xf6
    v_bitop3_b32 v237, v237, v167, v252 bitop3:0xf6
    v_cmp_ne_u32 vcc, 0, v237
    s_cbranch_vccz L_ok_116
    s_sub_u32 s84, s84, 1
    s_cmp_gt_i32 s84, 0
    s_cbranch_scc1 L_rt_114
L_ok_116:
    v_mfma_f32_32x32x16_bf16 v[168:183], v[144:147], v[212:215], 0
    v_mfma_f32_32x32x16_bf16 v[184:199], v[156:159], v[224:227], 0
    v_mfma_f32_32x32x16_bf16 v[168:183], v[148:151], v[216:219], v[168:183]
    v_mfma_f32_32x32x16_bf16 v[184:199], v[160:163], v[228:231], v[184:199]
    v_mfma_f32_32x32x16_bf16 v[168:183], v[152:155], v[220:223], v[168:183]
    v_mfma_f32_32x32x16_bf16 v[184:199], v[164:167], v[232:235], v[184:199]
L_g_113:
    v_exp_f32 v80, v80
    v_exp_f32 v81, v81
    v_exp_f32 v82, v82
    v_exp_f32 v83, v83
    v_smfmac_f32_32x32x32_bf16 v[64:79], v[44:47], v[136:143], v2
    s_waitcnt lgkmcnt(0)
    v_exp_f32 v84, v84
    v_exp_f32 v85, v85
    v_exp_f32 v86, v86
    v_exp_f32 v87, v87
    v_mfma_f32_32x32x4_2b_bf16 v[112:143], v[30:31], v[16:17], 0
    v_exp_f32 v88, v88
    v_exp_f32 v89, v89
    v_exp_f32 v90, v90
    v_exp_f32 v91, v91
    v_exp_f32 v92, v92
    v_exp_f32 v93, v93
    v_exp_f32 v94, v94
    v_exp_f32 v95, v95
    v_smfmac_f32_32x32x32_bf16 v[48:63], v[32:35], v[80:87], v2
    ds_read_b128 v[20:23], v3 offset:47360
    s_cmp_lg_u32 s53, 0
    s_cbranch_scc1 L_g_117
    v_add_f32 v236, 0x358637bd, v178
    v_rcp_f32 v236, v236
    v_add_f32 v238, 0x358637bd, v194
    v_rcp_f32 v238, v238
    v_mul_f32 v236, v236, v19
    v_mul_f32 v168, v168, v236
    v_mul_f32 v169, v169, v236
    v_mul_f32 v170, v170, v236
    v_mul_f32 v171, v171, v236
    v_mul_f32 v172, v172, v236
    v_mul_f32 v173, v173, v236
    v_mul_f32 v174, v174, v236
    v_mul_f32 v175, v175, v236
    v_mul_f32 v176, v176, v236
    v_mul_f32 v177, v177, v236
    v_mul_f32 v238, v238, v19
    v_mul_f32 v184, v184, v238
    v_mul_f32 v185, v185, v238
    v_mul_f32 v186, v186, v238
    v_mul_f32 v187, v187, v238
    v_mul_f32 v188, v188, v238
    v_mul_f32 v189, v189, v238
    v_mul_f32 v190, v190, v238
    v_mul_f32 v191, v191, v238
    v_mul_f32 v192, v192, v238
    v_mul_f32 v193, v193, v238
    v_cvt_pk_bf16_f32 v144, v168, v169
    v_cvt_pk_bf16_f32 v145, v170, v171
    v_cvt_pk_bf16_f32 v146, v172, v173
    v_cvt_pk_bf16_f32 v154, v176, v177
    v_cvt_pk_bf16_f32 v155, v192, v193
    v_mov_b32 v147, v252
    s_lshl_b32 s57, s80, 4
    s_add_u32 s57, s57, s86
    s_mul_i32 s57, s57, 6144
    s_add_u32 s57, s57, 5603328
    v_cvt_pk_bf16_f32 v148, v184, v185
    v_cvt_pk_bf16_f32 v149, v186, v187
    v_cvt_pk_bf16_f32 v150, v188, v189
    v_mov_b32 v151, v252
    v_permlane32_swap_b32 v154, v155
    v_cvt_pk_bf16_f32 v152, v174, v175
    v_cvt_pk_bf16_f32 v153, v190, v191
    v_mov_b32 v155, v252
    s_bitcmp1_b32 s100, 1
    s_cbranch_scc1 L_far_118
    buffer_store_dwordx4 v[144:147], v18, s[44:47], s57 offen offset:0 nt
    buffer_store_dwordx4 v[148:151], v18, s[44:47], s57 offen offset:1024 nt
    buffer_store_dwordx4 v[152:155], v18, s[44:47], s57 offen offset:2048 nt
    s_branch L_nfd_119
L_far_118:
    buffer_store_dwordx4 v[144:147], v18, s[44:47], s57 offen offset:0 sc1
    buffer_store_dwordx4 v[148:151], v18, s[44:47], s57 offen offset:1024 sc1
    buffer_store_dwordx4 v[152:155], v18, s[44:47], s57 offen offset:2048 sc1
L_nfd_119:
L_g_117:
    v_exp_f32 v96, v96
    v_exp_f32 v97, v97
    v_exp_f32 v98, v98
    v_exp_f32 v99, v99
    v_smfmac_f32_32x32x32_bf16 v[48:63], v[36:39], v[88:95], v2
    ds_read_b32 v28, v4 offset:47360
    s_setprio 0
    v_exp_f32 v100, v100
    v_exp_f32 v101, v101
    v_exp_f32 v102, v102
    v_exp_f32 v103, v103
    v_mfma_f32_32x32x16_bf16 v[112:127], v[24:27], v[8:11], v[112:127]
    ds_read_b128 v[40:43], v5 offset:42624
    s_setprio 1
    v_exp_f32 v104, v104
    v_exp_f32 v105, v105
    v_exp_f32 v106, v106
    v_exp_f32 v107, v107
    v_smfmac_f32_32x32x32_bf16 v[64:79], v[32:35], v[96:103], v2
    ds_read_b128 v[44:47], v5 offset:43232
    v_exp_f32 v108, v108
    v_exp_f32 v109, v109
    v_exp_f32 v110, v110
    v_exp_f32 v111, v111
    v_mfma_f32_32x32x16_bf16 v[128:143], v[24:27], v[12:15], v[128:143]
    v_exp_f32 v112, v112
    v_exp_f32 v113, v113
    v_exp_f32 v114, v114
    v_exp_f32 v115, v115
    v_smfmac_f32_32x32x32_bf16 v[64:79], v[36:39], v[104:111], v2
    s_waitcnt lgkmcnt(0)
    v_exp_f32 v116, v116
    v_exp_f32 v117, v117
    v_exp_f32 v118, v118
    v_exp_f32 v119, v119
    v_mfma_f32_32x32x4_2b_bf16 v[80:111], v[28:29], v[16:17], 0
    v_exp_f32 v120, v120
    v_exp_f32 v121, v121
    v_exp_f32 v122, v122
    v_exp_f32 v123, v123
    v_exp_f32 v124, v124
    v_exp_f32 v125, v125
    v_exp_f32 v126, v126
    v_exp_f32 v127, v127
    v_smfmac_f32_32x32x32_bf16 v[48:63], v[40:43], v[112:119], v2
    ds_read_b128 v[24:27], v3 offset:52096
    v_exp_f32 v128, v128
    v_exp_f32 v129, v129
    v_exp_f32 v130, v130
    v_exp_f32 v131, v131
    v_smfmac_f32_32x32x32_bf16 v[48:63], v[44:47], v[120:127], v2
    ds_read_b32 v30, v4 offset:52096
    s_setprio 0
    v_exp_f32 v132, v132
    v_exp_f32 v133, v133
    v_exp_f32 v134, v134
    v_exp_f32 v135, v135
    v_mfma_f32_32x32x16_bf16 v[80:95], v[20:23], v[8:11], v[80:95]
    ds_read_b128 v[32:35], v5 offset:47360
    s_setprio 1
    v_exp_f32 v136, v136
    v_exp_f32 v137, v137
    v_exp_f32 v138, v138
    v_exp_f32 v139, v139
    v_smfmac_f32_32x32x32_bf16 v[64:79], v[40:43], v[128:135], v2
    ds_read_b128 v[36:39], v5 offset:47968
    v_exp_f32 v140, v140
    v_exp_f32 v141, v141
    v_exp_f32 v142, v142
    v_exp_f32 v143, v143
    v_mfma_f32_32x32x16_bf16 v[96:111], v[20:23], v[12:15], v[96:111]
    v_exp_f32 v80, v80
    v_exp_f32 v81, v81
    v_exp_f32 v82, v82
    v_exp_f32 v83, v83
    v_smfmac_f32_32x32x32_bf16 v[64:79], v[44:47], v[136:143], v2
    s_waitcnt lgkmcnt(0)
    v_exp_f32 v84, v84
    v_exp_f32 v85, v85
    v_exp_f32 v86, v86
    v_exp_f32 v87, v87
    v_mfma_f32_32x32x4_2b_bf16 v[112:143], v[30:31], v[16:17], 0
    v_exp_f32 v88, v88
    v_exp_f32 v89, v89
    v_exp_f32 v90, v90
    v_exp_f32 v91, v91
    v_exp_f32 v92, v92
    v_exp_f32 v93, v93
    v_exp_f32 v94, v94
    v_exp_f32 v95, v95
    v_smfmac_f32_32x32x32_bf16 v[48:63], v[32:35], v[80:87], v2
    ds_read_b128 v[20:23], v3 offset:56832
    v_exp_f32 v96, v96
    v_exp_f32 v97, v97
    v_exp_f32 v98, v98
    v_exp_f32 v99, v99
    v_smfmac_f32_32x32x32_bf16 v[48:63], v[36:39], v[88:95], v2
    ds_read_b32 v28, v4 offset:56832
    s_setprio 0
    v_exp_f32 v100, v100
    v_exp_f32 v101, v101
    v_exp_f32 v102, v102
    v_exp_f32 v103, v103
    v_mfma_f32_32x32x16_bf16 v[112:127], v[24:27], v[8:11], v[112:127]
    ds_read_b128 v[40:43], v5 offset:52096
    s_setprio 1
    v_exp_f32 v104, v104
    v_exp_f32 v105, v105
    v_exp_f32 v106, v106
    v_exp_f32 v107, v107
    v_smfmac_f32_32x32x32_bf16 v[64:79], v[32:35], v[96:103], v2
    ds_read_b128 v[44:47], v5 offset:52704
    v_exp_f32 v108, v108
    v_exp_f32 v109, v109
    v_exp_f32 v110, v110
    v_exp_f32 v111, v111
    v_mfma_f32_32x32x16_bf16 v[128:143], v[24:27], v[12:15], v[128:143]
    v_exp_f32 v112, v112
    v_exp_f32 v113, v113
    v_exp_f32 v114, v114
    v_exp_f32 v115, v115
    v_smfmac_f32_32x32x32_bf16 v[64:79], v[36:39], v[104:111], v2
    s_waitcnt lgkmcnt(0)
    v_exp_f32 v116, v116
    v_exp_f32 v117, v117
    v_exp_f32 v118, v118
    v_exp_f32 v119, v119
    v_mfma_f32_32x32x4_2b_bf16 v[80:111], v[28:29], v[16:17], 0
    v_exp_f32 v120, v120
    v_exp_f32 v121, v121
    v_exp_f32 v122, v122
    v_exp_f32 v123, v123
    v_exp_f32 v124, v124
    v_exp_f32 v125, v125
    v_exp_f32 v126, v126
    v_exp_f32 v127, v127
    v_smfmac_f32_32x32x32_bf16 v[48:63], v[40:43], v[112:119], v2
    ds_read_b128 v[24:27], v3 offset:61568
    s_lshr_b32 s57, s2, 3
    s_xor_b32 s59, s48, 7
    s_or_b32 s57, s57, s59
    s_cbranch_scc1 L_g_120
    buffer_wbl2 sc1
L_g_120:
    v_exp_f32 v128, v128
    v_exp_f32 v129, v129
    v_exp_f32 v130, v130
    v_exp_f32 v131, v131
    v_smfmac_f32_32x32x32_bf16 v[48:63], v[44:47], v[120:127], v2
    ds_read_b32 v30, v4 offset:61568
    s_setprio 0
    v_exp_f32 v132, v132
    v_exp_f32 v133, v133
    v_exp_f32 v134, v134
    v_exp_f32 v135, v135
    v_mfma_f32_32x32x16_bf16 v[80:95], v[20:23], v[8:11], v[80:95]
    ds_read_b128 v[32:35], v5 offset:56832
    s_setprio 1
    v_exp_f32 v136, v136
    v_exp_f32 v137, v137
    v_exp_f32 v138, v138
    v_exp_f32 v139, v139
    v_smfmac_f32_32x32x32_bf16 v[64:79], v[40:43], v[128:135], v2
    ds_read_b128 v[36:39], v5 offset:57440
    v_exp_f32 v140, v140
    v_exp_f32 v141, v141
    v_exp_f32 v142, v142
    v_exp_f32 v143, v143
    v_mfma_f32_32x32x16_bf16 v[96:111], v[20:23], v[12:15], v[96:111]
    s_barrier
    v_add_u32 v3, 56832, v3
    v_add_u32 v4, 56832, v4
    s_mov_b32 s57, 56832
    v_mad_u32_u24 v5, v253, s57, v5
    v_exp_f32 v80, v80
    v_exp_f32 v81, v81
    v_exp_f32 v82, v82
    v_exp_f32 v83, v83
    v_smfmac_f32_32x32x32_bf16 v[64:79], v[44:47], v[136:143], v2
    s_waitcnt lgkmcnt(0)
    s_mul_i32 s57, s30, 2304
    s_add_u32 s57, s57, 73728
    s_mov_b32 s64, 0xcccc3333
    s_mov_b32 s65, 0xcccc3333
    v_add_u32 v204, s57, v0
    v_and_b32 v236, 16, v1
    v_mul_u32_u24 v236, 3, v236
    v_mov_b32 v237, 163840
    s_mul_i32 s57, s30, 9216
    v_add_u32 v206, s57, v0
    v_sub_u32 v205, v204, v236
    v_sub_u32 v207, v206, v236
    v_cndmask_b32 v205, v237, v205, s[64:65]
    v_cndmask_b32 v207, v237, v207, s[64:65]
    ds_read_b64_tr_b16 v[192:193], v204 offset:0
    v_exp_f32 v84, v84
    v_exp_f32 v85, v85
    v_exp_f32 v86, v86
    v_exp_f32 v87, v87
    v_mfma_f32_32x32x4_2b_bf16 v[112:143], v[30:31], v[16:17], 0
    v_exp_f32 v88, v88
    v_exp_f32 v89, v89
    v_exp_f32 v90, v90
    v_exp_f32 v91, v91
    v_exp_f32 v92, v92
    v_exp_f32 v93, v93
    v_exp_f32 v94, v94
    v_exp_f32 v95, v95
    v_smfmac_f32_32x32x32_bf16 v[48:63], v[32:35], v[80:87], v2
    ds_read_b128 v[20:23], v3 offset:9472
    ds_read_b64_tr_b16 v[194:195], v204 offset:144
    v_exp_f32 v96, v96
    v_exp_f32 v97, v97
    v_exp_f32 v98, v98
    v_exp_f32 v99, v99
    v_smfmac_f32_32x32x32_bf16 v[48:63], v[36:39], v[88:95], v2
    ds_read_b32 v28, v4 offset:9472
    s_setprio 0
    ds_read_b64_tr_b16 v[196:197], v204 offset:64
    v_exp_f32 v100, v100
    v_exp_f32 v101, v101
    v_exp_f32 v102, v102
    v_exp_f32 v103, v103
    v_mfma_f32_32x32x16_bf16 v[112:127], v[24:27], v[8:11], v[112:127]
    ds_read_b128 v[40:43], v5 offset:4736
    s_setprio 1
    ds_read_b64_tr_b16 v[198:199], v204 offset:208
    v_exp_f32 v104, v104
    v_exp_f32 v105, v105
    v_exp_f32 v106, v106
    v_exp_f32 v107, v107
    v_smfmac_f32_32x32x32_bf16 v[64:79], v[32:35], v[96:103], v2
    ds_read_b128 v[44:47], v5 offset:5344
    ds_read_b64_tr_b16 v[200:201], v205 offset:128
    v_exp_f32 v108, v108
    v_exp_f32 v109, v109
    v_exp_f32 v110, v110
    v_exp_f32 v111, v111
    v_mfma_f32_32x32x16_bf16 v[128:143], v[24:27], v[12:15], v[128:143]
    ds_read_b64_tr_b16 v[202:203], v205 offset:272
    v_exp_f32 v112, v112
    v_exp_f32 v113, v113
    v_exp_f32 v114, v114
    v_exp_f32 v115, v115
    v_smfmac_f32_32x32x32_bf16 v[64:79], v[36:39], v[104:111], v2
    s_waitcnt lgkmcnt(0)
    ds_read_b64_tr_b16 v[208:209], v206 offset:0
    v_exp_f32 v116, v116
    v_exp_f32 v117, v117
    v_exp_f32 v118, v118
    v_exp_f32 v119, v119
    v_mfma_f32_32x32x4_2b_bf16 v[80:111], v[28:29], v[16:17], 0
    v_exp_f32 v120, v120
    v_exp_f32 v121, v121
    v_exp_f32 v122, v122
    v_exp_f32 v123, v123
    v_exp_f32 v124, v124
    v_exp_f32 v125, v125
    v_exp_f32 v126, v126
    v_exp_f32 v127, v127
    v_smfmac_f32_32x32x32_bf16 v[48:63], v[40:43], v[112:119], v2
    ds_read_b128 v[24:27], v3 offset:14208
    ds_read_b64_tr_b16 v[210:211], v206 offset:144
    v_exp_f32 v128, v128
    v_exp_f32 v129, v129
    v_exp_f32 v130, v130
    v_exp_f32 v131, v131
    v_smfmac_f32_32x32x32_bf16 v[48:63], v[44:47], v[120:127], v2
    ds_read_b32 v30, v4 offset:14208
    s_setprio 0
    ds_read_b64_tr_b16 v[212:213], v206 offset:64
    v_exp_f32 v132, v132
    v_exp_f32 v133, v133
    v_exp_f32 v134, v134
    v_exp_f32 v135, v135
    v_mfma_f32_32x32x16_bf16 v[80:95], v[20:23], v[8:11], v[80:95]
    ds_read_b128 v[32:35], v5 offset:9472
    s_setprio 1
    ds_read_b64_tr_b16 v[214:215], v206 offset:208
    v_exp_f32 v136, v136
    v_exp_f32 v137, v137
    v_exp_f32 v138, v138
    v_exp_f32 v139, v139
    v_smfmac_f32_32x32x32_bf16 v[64:79], v[40:43], v[128:135], v2
    ds_read_b128 v[36:39], v5 offset:10080
    ds_read_b64_tr_b16 v[216:217], v207 offset:128
    v_exp_f32 v140, v140
    v_exp_f32 v141, v141
    v_exp_f32 v142, v142
    v_exp_f32 v143, v143
    v_mfma_f32_32x32x16_bf16 v[96:111], v[20:23], v[12:15], v[96:111]
    ds_read_b64_tr_b16 v[218:219], v207 offset:272
    v_exp_f32 v80, v80
    v_exp_f32 v81, v81
    v_exp_f32 v82, v82
    v_exp_f32 v83, v83
    v_smfmac_f32_32x32x32_bf16 v[64:79], v[44:47], v[136:143], v2
    s_waitcnt lgkmcnt(0)
    ds_read_b64_tr_b16 v[220:221], v206 offset:2304
    v_exp_f32 v84, v84
    v_exp_f32 v85, v85
    v_exp_f32 v86, v86
    v_exp_f32 v87, v87
    v_mfma_f32_32x32x4_2b_bf16 v[112:143], v[30:31], v[16:17], 0
    v_exp_f32 v88, v88
    v_exp_f32 v89, v89
    v_exp_f32 v90, v90
    v_exp_f32 v91, v91
    v_exp_f32 v92, v92
    v_exp_f32 v93, v93
    v_exp_f32 v94, v94
    v_exp_f32 v95, v95
    v_smfmac_f32_32x32x32_bf16 v[48:63], v[32:35], v[80:87], v2
    ds_read_b128 v[20:23], v3 offset:18944
    ds_read_b64_tr_b16 v[222:223], v206 offset:2448
    v_exp_f32 v96, v96
    v_exp_f32 v97, v97
    v_exp_f32 v98, v98
    v_exp_f32 v99, v99
    v_smfmac_f32_32x32x32_bf16 v[48:63], v[36:39], v[88:95], v2
    ds_read_b32 v28, v4 offset:18944
    s_setprio 0
    ds_read_b64_tr_b16 v[224:225], v206 offset:2368
    v_exp_f32 v100, v100
    v_exp_f32 v101, v101
    v_exp_f32 v102, v102
    v_exp_f32 v103, v103
    v_mfma_f32_32x32x16_bf16 v[112:127], v[24:27], v[8:11], v[112:127]
    ds_read_b128 v[40:43], v5 offset:14208
    s_setprio 1
    ds_read_b64_tr_b16 v[226:227], v206 offset:2512
    v_exp_f32 v104, v104
    v_exp_f32 v105, v105
    v_exp_f32 v106, v106
    v_exp_f32 v107, v107
    v_smfmac_f32_32x32x32_bf16 v[64:79], v[32:35], v[96:103], v2
    ds_read_b128 v[44:47], v5 offset:14816
    ds_read_b64_tr_b16 v[228:229], v207 offset:2432
    v_exp_f32 v108, v108
    v_exp_f32 v109, v109
    v_exp_f32 v110, v110
    v_exp_f32 v111, v111
    v_mfma_f32_32x32x16_bf16 v[128:143], v[24:27], v[12:15], v[128:143]
    ds_read_b64_tr_b16 v[230:231], v207 offset:2576
    v_exp_f32 v112, v112
    v_exp_f32 v113, v113
    v_exp_f32 v114, v114
    v_exp_f32 v115, v115
    v_smfmac_f32_32x32x32_bf16 v[64:79], v[36:39], v[104:111], v2
    s_waitcnt lgkmcnt(0)
    s_mov_b32 s58, s90
    buffer_load_dwordx4 v[144:147], v18, s[44:47], s58 offen offset:0 sc1
    v_exp_f32 v116, v116
    v_exp_f32 v117, v117
    v_exp_f32 v118, v118
    v_exp_f32 v119, v119
    v_mfma_f32_32x32x4_2b_bf16 v[80:111], v[28:29], v[16:17], 0
    v_exp_f32 v120, v120
    v_exp_f32 v121, v121
    v_exp_f32 v122, v122
    v_exp_f32 v123, v123
    v_exp_f32 v124, v124
    v_exp_f32 v125, v125
    v_exp_f32 v126, v126
    v_exp_f32 v127, v127
    v_smfmac_f32_32x32x32_bf16 v[48:63], v[40:43], v[112:119], v2
    ds_read_b128 v[24:27], v3 offset:23680
    buffer_load_dwordx4 v[148:151], v18, s[44:47], s58 offen offset:1024 sc1
    v_exp_f32 v128, v128
    v_exp_f32 v129, v129
    v_exp_f32 v130, v130
    v_exp_f32 v131, v131
    v_smfmac_f32_32x32x32_bf16 v[48:63], v[44:47], v[120:127], v2
    ds_read_b32 v30, v4 offset:23680
    s_setprio 0
    v_exp_f32 v132, v132
    v_exp_f32 v133, v133
    v_exp_f32 v134, v134
    v_exp_f32 v135, v135
    v_mfma_f32_32x32x16_bf16 v[80:95], v[20:23], v[8:11], v[80:95]
    ds_read_b128 v[32:35], v5 offset:18944
    s_setprio 1
    buffer_load_dwordx4 v[152:155], v18, s[44:47], s58 offen offset:2048 sc1
    s_add_u32 s58, s58, 6144
    v_exp_f32 v136, v136
    v_exp_f32 v137, v137
    v_exp_f32 v138, v138
    v_exp_f32 v139, v139
    v_smfmac_f32_32x32x32_bf16 v[64:79], v[40:43], v[128:135], v2
    ds_read_b128 v[36:39], v5 offset:19552
    v_exp_f32 v140, v140
    v_exp_f32 v141, v141
    v_exp_f32 v142, v142
    v_exp_f32 v143, v143
    v_mfma_f32_32x32x16_bf16 v[96:111], v[20:23], v[12:15], v[96:111]
    buffer_load_dwordx4 v[156:159], v18, s[44:47], s58 offen offset:0 sc1
    s_barrier
    v_exp_f32 v80, v80
    v_exp_f32 v81, v81
    v_exp_f32 v82, v82
    v_exp_f32 v83, v83
    v_smfmac_f32_32x32x32_bf16 v[64:79], v[44:47], v[136:143], v2
    s_waitcnt lgkmcnt(0)
    buffer_load_dwordx4 v[160:163], v18, s[44:47], s58 offen offset:1024 sc1
    v_exp_f32 v84, v84
    v_exp_f32 v85, v85
    v_exp_f32 v86, v86
    v_exp_f32 v87, v87
    v_mfma_f32_32x32x4_2b_bf16 v[112:143], v[30:31], v[16:17], 0
    v_exp_f32 v88, v88
    v_exp_f32 v89, v89
    v_exp_f32 v90, v90
    v_exp_f32 v91, v91
    v_exp_f32 v92, v92
    v_exp_f32 v93, v93
    v_exp_f32 v94, v94
    v_exp_f32 v95, v95
    v_smfmac_f32_32x32x32_bf16 v[48:63], v[32:35], v[80:87], v2
    ds_read_b128 v[20:23], v3 offset:28416
    buffer_load_dwordx4 v[164:167], v18, s[44:47], s58 offen offset:2048 sc1
    s_add_u32 s58, s58, 43008
    v_exp_f32 v96, v96
    v_exp_f32 v97, v97
    v_exp_f32 v98, v98
    v_exp_f32 v99, v99
    v_smfmac_f32_32x32x32_bf16 v[48:63], v[36:39], v[88:95], v2
    ds_read_b32 v28, v4 offset:28416
    s_setprio 0
    v_exp_f32 v100, v100
    v_exp_f32 v101, v101
    v_exp_f32 v102, v102
    v_exp_f32 v103, v103
    v_mfma_f32_32x32x16_bf16 v[112:127], v[24:27], v[8:11], v[112:127]
    ds_read_b128 v[40:43], v5 offset:23680
    s_setprio 1
    buffer_load_dwordx4 v[168:171], v18, s[44:47], s58 offen offset:0 sc1
    v_exp_f32 v104, v104
    v_exp_f32 v105, v105
    v_exp_f32 v106, v106
    v_exp_f32 v107, v107
    v_smfmac_f32_32x32x32_bf16 v[64:79], v[32:35], v[96:103], v2
    ds_read_b128 v[44:47], v5 offset:24288
    v_exp_f32 v108, v108
    v_exp_f32 v109, v109
    v_exp_f32 v110, v110
    v_exp_f32 v111, v111
    v_mfma_f32_32x32x16_bf16 v[128:143], v[24:27], v[12:15], v[128:143]
    buffer_load_dwordx4 v[172:175], v18, s[44:47], s58 offen offset:1024 sc1
    v_exp_f32 v112, v112
    v_exp_f32 v113, v113
    v_exp_f32 v114, v114
    v_exp_f32 v115, v115
    v_smfmac_f32_32x32x32_bf16 v[64:79], v[36:39], v[104:111], v2
    s_waitcnt lgkmcnt(0)
    buffer_load_dwordx4 v[176:179], v18, s[44:47], s58 offen offset:2048 sc1
    s_add_u32 s58, s58, 6144
    v_exp_f32 v116, v116
    v_exp_f32 v117, v117
    v_exp_f32 v118, v118
    v_exp_f32 v119, v119
    v_mfma_f32_32x32x4_2b_bf16 v[80:111], v[28:29], v[16:17], 0
    v_exp_f32 v120, v120
    v_exp_f32 v121, v121
    v_exp_f32 v122, v122
    v_exp_f32 v123, v123
    v_exp_f32 v124, v124
    v_exp_f32 v125, v125
    v_exp_f32 v126, v126
    v_exp_f32 v127, v127
    v_smfmac_f32_32x32x32_bf16 v[48:63], v[40:43], v[112:119], v2
    ds_read_b128 v[24:27], v3 offset:33152
    buffer_load_dwordx4 v[180:183], v18, s[44:47], s58 offen offset:0 sc1
    v_exp_f32 v128, v128
    v_exp_f32 v129, v129
    v_exp_f32 v130, v130
    v_exp_f32 v131, v131
    v_smfmac_f32_32x32x32_bf16 v[48:63], v[44:47], v[120:127], v2
    ds_read_b32 v30, v4 offset:33152
    s_setprio 0
    v_exp_f32 v132, v132
    v_exp_f32 v133, v133
    v_exp_f32 v134, v134
    v_exp_f32 v135, v135
    v_mfma_f32_32x32x16_bf16 v[80:95], v[20:23], v[8:11], v[80:95]
    ds_read_b128 v[32:35], v5 offset:28416
    s_setprio 1
    buffer_load_dwordx4 v[184:187], v18, s[44:47], s58 offen offset:1024 sc1
    v_exp_f32 v136, v136
    v_exp_f32 v137, v137
    v_exp_f32 v138, v138
    v_exp_f32 v139, v139
    v_smfmac_f32_32x32x32_bf16 v[64:79], v[40:43], v[128:135], v2
    ds_read_b128 v[36:39], v5 offset:29024
    v_exp_f32 v140, v140
    v_exp_f32 v141, v141
    v_exp_f32 v142, v142
    v_exp_f32 v143, v143
    v_mfma_f32_32x32x16_bf16 v[96:111], v[20:23], v[12:15], v[96:111]
    buffer_load_dwordx4 v[188:191], v18, s[44:47], s58 offen offset:2048 sc1
    s_barrier
    v_exp_f32 v80, v80
    v_exp_f32 v81, v81
    v_exp_f32 v82, v82
    v_exp_f32 v83, v83
    v_smfmac_f32_32x32x32_bf16 v[64:79], v[44:47], v[136:143], v2
    s_waitcnt lgkmcnt(0)
    v_exp_f32 v84, v84
    v_exp_f32 v85, v85
    v_exp_f32 v86, v86
    v_exp_f32 v87, v87
    v_mfma_f32_32x32x4_2b_bf16 v[112:143], v[30:31], v[16:17], 0
    v_exp_f32 v88, v88
    v_exp_f32 v89, v89
    v_exp_f32 v90, v90
    v_exp_f32 v91, v91
    v_exp_f32 v92, v92
    v_exp_f32 v93, v93
    v_exp_f32 v94, v94
    v_exp_f32 v95, v95
    v_smfmac_f32_32x32x32_bf16 v[48:63], v[32:35], v[80:87], v2
    v_exp_f32 v96, v96
    v_exp_f32 v97, v97
    v_exp_f32 v98, v98
    v_exp_f32 v99, v99
    v_smfmac_f32_32x32x32_bf16 v[48:63], v[36:39], v[88:95], v2
    s_setprio 0
    v_exp_f32 v100, v100
    v_exp_f32 v101, v101
    v_exp_f32 v102, v102
    v_exp_f32 v103, v103
    v_mfma_f32_32x32x16_bf16 v[112:127], v[24:27], v[8:11], v[112:127]
    ds_read_b128 v[40:43], v5 offset:33152
    s_setprio 1
    v_exp_f32 v104, v104
    v_exp_f32 v105, v105
    v_exp_f32 v106, v106
    v_exp_f32 v107, v107
    v_smfmac_f32_32x32x32_bf16 v[64:79], v[32:35], v[96:103], v2
    ds_read_b128 v[44:47], v5 offset:33760
    v_exp_f32 v108, v108
    v_exp_f32 v109, v109
    v_exp_f32 v110, v110
    v_exp_f32 v111, v111
    v_mfma_f32_32x32x16_bf16 v[128:143], v[24:27], v[12:15], v[128:143]
    v_exp_f32 v112, v112
    v_exp_f32 v113, v113
    v_exp_f32 v114, v114
    v_exp_f32 v115, v115
    v_smfmac_f32_32x32x32_bf16 v[64:79], v[36:39], v[104:111], v2
    s_waitcnt lgkmcnt(0)
    v_exp_f32 v116, v116
    v_exp_f32 v117, v117
    v_exp_f32 v118, v118
    v_exp_f32 v119, v119
    v_exp_f32 v120, v120
    v_exp_f32 v121, v121
    v_exp_f32 v122, v122
    v_exp_f32 v123, v123
    v_exp_f32 v124, v124
    v_exp_f32 v125, v125
    v_exp_f32 v126, v126
    v_exp_f32 v127, v127
    v_smfmac_f32_32x32x32_bf16 v[48:63], v[40:43], v[112:119], v2
    v_exp_f32 v128, v128
    v_exp_f32 v129, v129
    v_exp_f32 v130, v130
    v_exp_f32 v131, v131
    v_smfmac_f32_32x32x32_bf16 v[48:63], v[44:47], v[120:127], v2
    s_setprio 0
    v_exp_f32 v132, v132
    v_exp_f32 v133, v133
    v_exp_f32 v134, v134
    v_exp_f32 v135, v135
    s_setprio 1
    v_exp_f32 v136, v136
    v_exp_f32 v137, v137
    v_exp_f32 v138, v138
    v_exp_f32 v139, v139
    v_smfmac_f32_32x32x32_bf16 v[64:79], v[40:43], v[128:135], v2
    v_exp_f32 v140, v140
    v_exp_f32 v141, v141
    v_exp_f32 v142, v142
    v_exp_f32 v143, v143
    s_nop 1
    v_smfmac_f32_32x32x32_bf16 v[64:79], v[44:47], v[136:143], v2
    s_mul_i32 s57, s49, 9216
    v_add_u32 v20, s57, v18
    v_lshl_add_u32 v21, v7, 3, s57
    s_lshl_b32 s57, s49, 8
    s_add_u32 s57, s57, 156672
    v_lshl_add_u32 v22, v7, 2, s57
    s_setprio 3
    s_mov_b32 s58, 0x21800000
    s_mov_b32 s59, 0x71800000
    v_sub_f32 v107, 1.0, v254
    v_mov_b32 v59, v58
    s_nop 0
    v_mov_b32 v75, v74
    s_mov_b64 s[94:95], 0
    v_permlane32_swap_b32 v58, v59
    v_permlane32_swap_b32 v74, v75
    s_barrier
    ds_read_b32 v90, v22 offset:0
    ds_read_b32 v102, v22 offset:128
    ds_read_b128 v[80:83], v20 offset:0
    ds_read_b128 v[84:87], v20 offset:1024
    ds_read_b64 v[88:89], v21 offset:2048
    ds_read_b128 v[92:95], v20 offset:2304
    ds_read_b128 v[96:99], v20 offset:3328
    ds_read_b64 v[100:101], v21 offset:4352
    s_waitcnt lgkmcnt(6)
    v_add_f32 v58, v58, v90
    v_add_f32 v74, v74, v102
L_fin:
    v_rcp_f32 v104, v58
    v_rcp_f32 v108, v74
    v_min_f32 v105, v58, v74
    v_max_f32 v106, v58, v74
    v_cmp_lt_f32 vcc, s58, v105
    v_cmp_gt_f32 s[78:79], s59, v106
    v_cmp_o_f32 s[92:93], v58, v74
    v_mul_f32 v104, v104, v107
    v_mul_f32 v48, v48, v104
    v_mul_f32 v49, v49, v104
    v_mul_f32 v50, v50, v104
    v_mul_f32 v51, v51, v104
    v_mul_f32 v52, v52, v104
    v_mul_f32 v53, v53, v104
    v_mul_f32 v54, v54, v104
    v_mul_f32 v55, v55, v104
    v_mul_f32 v56, v56, v104
    v_mul_f32 v57, v57, v104
    v_mul_f32 v108, v108, v107
    v_mul_f32 v64, v64, v108
    v_mul_f32 v65, v65, v108
    v_mul_f32 v66, v66, v108
    v_mul_f32 v67, v67, v108
    v_mul_f32 v68, v68, v108
    v_mul_f32 v69, v69, v108
    v_mul_f32 v70, v70, v108
    v_mul_f32 v71, v71, v108
    v_mul_f32 v72, v72, v108
    v_mul_f32 v73, v73, v108
    s_and_b64 s[78:79], vcc, s[78:79]
    s_and_b64 s[78:79], s[78:79], s[92:93]
    s_waitcnt lgkmcnt(0)
    v_fmac_f32 v48, v80, v104
    v_fmac_f32 v49, v81, v104
    v_fmac_f32 v50, v82, v104
    v_fmac_f32 v51, v83, v104
    v_fmac_f32 v52, v84, v104
    v_fmac_f32 v53, v85, v104
    v_fmac_f32 v54, v86, v104
    v_fmac_f32 v55, v87, v104
    v_fmac_f32 v56, v88, v104
    v_fmac_f32 v57, v89, v104
    v_fmac_f32 v64, v92, v108
    v_fmac_f32 v65, v93, v108
    v_fmac_f32 v66, v94, v108
    v_fmac_f32 v67, v95, v108
    v_fmac_f32 v68, v96, v108
    v_fmac_f32 v69, v97, v108
    v_fmac_f32 v70, v98, v108
    v_fmac_f32 v71, v99, v108
    v_fmac_f32 v72, v100, v108
    v_fmac_f32 v73, v101, v108
    v_mul_f32 v105, v48, v64
    v_fmac_f32 v105, v49, v65
    v_fmac_f32 v105, v50, v66
    v_fmac_f32 v105, v51, v67
    v_fmac_f32 v105, v52, v68
    v_fmac_f32 v105, v53, v69
    v_fmac_f32 v105, v54, v70
    v_fmac_f32 v105, v55, v71
    v_fmac_f32 v105, v56, v72
    v_fmac_f32 v105, v57, v73
    v_cmp_gt_f32 vcc, s59, |v105|
    s_nop 0
    s_and_b64 vcc, vcc, s[78:79]
    s_or_b64 vcc, vcc, s[94:95]
    s_andn2_b64 vcc, exec, vcc
    s_cbranch_scc1 L_fallback
    s_waitcnt vmcnt(0)
    v_cvt_pk_bf16_f32 v80, v48, v49
    v_cvt_pk_bf16_f32 v81, v50, v51
    v_cvt_pk_bf16_f32 v82, v52, v53
    v_cvt_pk_bf16_f32 v90, v56, v57
    v_cvt_pk_bf16_f32 v91, v72, v73
    v_mov_b32 v83, v252
    s_lshl_b32 s57, s12, 4
    s_add_u32 s57, s57, s81
    s_mul_i32 s57, s57, 6144
    s_add_u32 s57, s57, 5606400
    v_cvt_pk_bf16_f32 v84, v64, v65
    v_cvt_pk_bf16_f32 v85, v66, v67
    v_cvt_pk_bf16_f32 v86, v68, v69
    v_mov_b32 v87, v252
    v_permlane32_swap_b32 v90, v91
    v_cvt_pk_bf16_f32 v88, v54, v55
    v_cvt_pk_bf16_f32 v89, v70, v71
    v_mov_b32 v91, v252
    s_bitcmp1_b32 s100, 0
    s_cbranch_scc1 L_far_121
    buffer_store_dwordx4 v[80:83], v18, s[44:47], s57 offen offset:0 nt
    buffer_store_dwordx4 v[84:87], v18, s[44:47], s57 offen offset:1024 nt
    buffer_store_dwordx4 v[88:91], v18, s[44:47], s57 offen offset:2048 nt
    s_branch L_nfd_122
L_far_121:
    buffer_store_dwordx4 v[80:83], v18, s[44:47], s57 offen offset:0 sc1
    buffer_store_dwordx4 v[84:87], v18, s[44:47], s57 offen offset:1024 sc1
    buffer_store_dwordx4 v[88:91], v18, s[44:47], s57 offen offset:2048 sc1
L_nfd_122:
    s_setprio 0
    s_branch L_ck_124
L_rt_123:
    s_add_u32 s58, s90, 0
    buffer_load_dwordx4 v[144:147], v18, s[44:47], s58 offen offset:0 sc1
    buffer_load_dwordx4 v[148:151], v18, s[44:47], s58 offen offset:1024 sc1
    buffer_load_dwordx4 v[152:155], v18, s[44:47], s58 offen offset:2048 sc1
    s_add_u32 s58, s58, 6144
    buffer_load_dwordx4 v[156:159], v18, s[44:47], s58 offen offset:0 sc1
    buffer_load_dwordx4 v[160:163], v18, s[44:47], s58 offen offset:1024 sc1
    buffer_load_dwordx4 v[164:167], v18, s[44:47], s58 offen offset:2048 sc1
    s_add_u32 s58, s58, 43008
    buffer_load_dwordx4 v[168:171], v18, s[44:47], s58 offen offset:0 sc1
    buffer_load_dwordx4 v[172:175], v18, s[44:47], s58 offen offset:1024 sc1
    buffer_load_dwordx4 v[176:179], v18, s[44:47], s58 offen offset:2048 sc1
    s_add_u32 s58, s58, 6144
    buffer_load_dwordx4 v[180:183], v18, s[44:47], s58 offen offset:0 sc1
    buffer_load_dwordx4 v[184:187], v18, s[44:47], s58 offen offset:1024 sc1
    buffer_load_dwordx4 v[188:191], v18, s[44:47], s58 offen offset:2048 sc1
    s_waitcnt vmcnt(0)
L_ck_124:
    v_xor_b32 v44, v147, v252
    v_bitop3_b32 v44, v44, v151, v252 bitop3:0xf6
    v_bitop3_b32 v44, v44, v155, v252 bitop3:0xf6
    v_bitop3_b32 v44, v44, v159, v252 bitop3:0xf6
    v_bitop3_b32 v44, v44, v163, v252 bitop3:0xf6
    v_bitop3_b32 v44, v44, v167, v252 bitop3:0xf6
    v_bitop3_b32 v44, v44, v171, v252 bitop3:0xf6
    v_bitop3_b32 v44, v44, v175, v252 bitop3:0xf6
    v_bitop3_b32 v44, v44, v179, v252 bitop3:0xf6
    v_bitop3_b32 v44, v44, v183, v252 bitop3:0xf6
    v_bitop3_b32 v44, v44, v187, v252 bitop3:0xf6
    v_bitop3_b32 v44, v44, v191, v252 bitop3:0xf6
    v_cmp_ne_u32 vcc, 0, v44
    s_cbranch_vccz L_ok_125
    s_sub_u32 s84, s84, 1
    s_cmp_gt_i32 s84, 0
    s_cbranch_scc1 L_rt_123
L_ok_125:
    v_mov_b32 v147, v152
    v_mov_b32 v151, v153
    v_mov_b32 v44, v154
    v_mov_b32 v159, v164
    v_mov_b32 v163, v165
    v_mov_b32 v45, v166
    v_mov_b32 v171, v176
    v_mov_b32 v175, v177
    v_mov_b32 v46, v178
    v_mov_b32 v183, v188
    v_mov_b32 v187, v189
    v_mov_b32 v47, v190
    v_add_u32 v12, 82944, v206
    v_add_u32 v13, 82944, v207
    v_cndmask_b32 v13, v207, v13, s[64:65]
    s_lshl_b32 s57, s30, 2
    s_add_u32 s57, s57, s31
    s_mul_i32 s57, s57, 4608
    v_lshl_add_u32 v14, v6, 6, v7
    v_mul_u32_u24 v14, 144, v14
    v_add_u32 v14, s57, v14
    v_and_b32 v16, 15, v1
    v_lshl_add_u32 v16, v6, 4, v16
    v_and_b32 v17, 16, v1
    v_lshl_add_u32 v16, v17, 2, v16
    v_mul_u32_u24 v16, 144, v16
    v_add_u32 v16, s57, v16
    s_mul_i32 s85, s82, 73728
    s_add_u32 s85, s85, s89
    v_add_u32 v238, s75, v18
    v_add_u32 v239, 36864, v238
    s_lshl_b32 s57, s48, 6
    v_add_u32 v15, s57, v1
    v_mul_u32_u24 v3, 7282, v15
    v_lshrrev_b32 v3, 16, v3
    v_mul_u32_u24 v4, 1008, v3
    v_lshl_add_u32 v236, v15, 4, v4
    v_add_u32 v15, 512, v1
    v_mul_u32_u24 v3, 7282, v15
    v_lshrrev_b32 v3, 16, v3
    v_mul_u32_u24 v4, 1008, v3
    v_lshl_add_u32 v237, v15, 4, v4
    v_mfma_f32_32x32x16_bf16 v[48:63], v[192:195], v[44:47], 0
    ds_read_b64_tr_b16 v[192:193], v206 offset:4608
    ds_read_b64_tr_b16 v[194:195], v206 offset:4752
    v_mfma_f32_32x32x16_bf16 v[64:79], v[196:199], v[44:47], 0
    ds_read_b64_tr_b16 v[196:197], v206 offset:4672
    ds_read_b64_tr_b16 v[198:199], v206 offset:4816
    v_mfma_f32_16x16x32_bf16 v[80:83], v[200:203], v[44:47], 0
    ds_read_b64_tr_b16 v[200:201], v207 offset:4736
    ds_read_b64_tr_b16 v[202:203], v207 offset:4880
    v_mfma_f32_32x32x16_bf16 v[48:63], v[208:211], v[144:147], v[48:63]
    ds_read_b64_tr_b16 v[208:209], v206 offset:6912
    ds_read_b64_tr_b16 v[210:211], v206 offset:7056
    v_mfma_f32_32x32x16_bf16 v[64:79], v[212:215], v[144:147], v[64:79]
    ds_read_b64_tr_b16 v[212:213], v206 offset:6976
    ds_read_b64_tr_b16 v[214:215], v206 offset:7120
    v_mfma_f32_16x16x32_bf16 v[80:83], v[216:219], v[144:147], v[80:83]
    ds_read_b64_tr_b16 v[216:217], v207 offset:7040
    ds_read_b64_tr_b16 v[218:219], v207 offset:7184
    v_mfma_f32_32x32x16_bf16 v[48:63], v[220:223], v[148:151], v[48:63]
    ds_read_b64_tr_b16 v[220:221], v206 offset:36864
    ds_read_b64_tr_b16 v[222:223], v206 offset:37008
    v_mfma_f32_32x32x16_bf16 v[64:79], v[224:227], v[148:151], v[64:79]
    ds_read_b64_tr_b16 v[224:225], v206 offset:36928
    ds_read_b64_tr_b16 v[226:227], v206 offset:37072
    v_mfma_f32_16x16x32_bf16 v[80:83], v[228:231], v[148:151], v[80:83]
    ds_read_b64_tr_b16 v[228:229], v207 offset:36992
    ds_read_b64_tr_b16 v[230:231], v207 offset:37136
    s_waitcnt lgkmcnt(12)
    v_mfma_f32_32x32x16_bf16 v[48:63], v[192:195], v[156:159], v[48:63]
    ds_read_b64_tr_b16 v[192:193], v206 offset:39168
    ds_read_b64_tr_b16 v[194:195], v206 offset:39312
    v_mfma_f32_32x32x16_bf16 v[64:79], v[196:199], v[156:159], v[64:79]
    ds_read_b64_tr_b16 v[196:197], v206 offset:39232
    ds_read_b64_tr_b16 v[198:199], v206 offset:39376
    v_mfma_f32_16x16x32_bf16 v[80:83], v[200:203], v[156:159], v[80:83]
    ds_read_b64_tr_b16 v[200:201], v207 offset:39296
    ds_read_b64_tr_b16 v[202:203], v207 offset:39440
    s_waitcnt lgkmcnt(12)
    v_mfma_f32_32x32x16_bf16 v[48:63], v[208:211], v[160:163], v[48:63]
    ds_read_b64_tr_b16 v[208:209], v206 offset:41472
    ds_read_b64_tr_b16 v[210:211], v206 offset:41616
    v_mfma_f32_32x32x16_bf16 v[64:79], v[212:215], v[160:163], v[64:79]
    ds_read_b64_tr_b16 v[212:213], v206 offset:41536
    ds_read_b64_tr_b16 v[214:215], v206 offset:41680
    v_mfma_f32_16x16x32_bf16 v[80:83], v[216:219], v[160:163], v[80:83]
    ds_read_b64_tr_b16 v[216:217], v207 offset:41600
    ds_read_b64_tr_b16 v[218:219], v207 offset:41744
    s_waitcnt lgkmcnt(12)
    v_mfma_f32_32x32x16_bf16 v[48:63], v[220:223], v[168:171], v[48:63]
    ds_read_b64_tr_b16 v[220:221], v206 offset:43776
    ds_read_b64_tr_b16 v[222:223], v206 offset:43920
    v_mfma_f32_32x32x16_bf16 v[64:79], v[224:227], v[168:171], v[64:79]
    ds_read_b64_tr_b16 v[224:225], v206 offset:43840
    ds_read_b64_tr_b16 v[226:227], v206 offset:43984
    v_mfma_f32_16x16x32_bf16 v[80:83], v[228:231], v[168:171], v[80:83]
    ds_read_b64_tr_b16 v[228:229], v207 offset:43904
    ds_read_b64_tr_b16 v[230:231], v207 offset:44048
    s_waitcnt lgkmcnt(12)
    s_add_u32 s58, s90, 3072
    v_mfma_f32_32x32x16_bf16 v[48:63], v[192:195], v[172:175], v[48:63]
    s_waitcnt lgkmcnt(0)
    s_barrier
    buffer_load_dwordx4 v[96:99], v18, s[44:47], s58 offen offset:0 sc1
    v_mfma_f32_32x32x16_bf16 v[64:79], v[196:199], v[172:175], v[64:79]
    buffer_load_dwordx4 v[100:103], v18, s[44:47], s58 offen offset:1024 sc1
    v_mfma_f32_16x16x32_bf16 v[80:83], v[200:203], v[172:175], v[80:83]
    buffer_load_dwordx4 v[104:107], v18, s[44:47], s58 offen offset:2048 sc1
    s_add_u32 s58, s58, 6144
    s_waitcnt lgkmcnt(6)
    v_mfma_f32_32x32x16_bf16 v[48:63], v[208:211], v[180:183], v[48:63]
    buffer_load_dwordx4 v[108:111], v18, s[44:47], s58 offen offset:0 sc1
    v_mfma_f32_32x32x16_bf16 v[64:79], v[212:215], v[180:183], v[64:79]
    buffer_load_dwordx4 v[112:115], v18, s[44:47], s58 offen offset:1024 sc1
    v_mfma_f32_16x16x32_bf16 v[80:83], v[216:219], v[180:183], v[80:83]
    buffer_load_dwordx4 v[116:119], v18, s[44:47], s58 offen offset:2048 sc1
    s_add_u32 s58, s58, 43008
    s_waitcnt lgkmcnt(0)
    v_mfma_f32_32x32x16_bf16 v[48:63], v[220:223], v[184:187], v[48:63]
    buffer_load_dwordx4 v[120:123], v18, s[44:47], s58 offen offset:0 sc1
    v_mfma_f32_32x32x16_bf16 v[64:79], v[224:227], v[184:187], v[64:79]
    buffer_load_dwordx4 v[124:127], v18, s[44:47], s58 offen offset:1024 sc1
    v_mfma_f32_16x16x32_bf16 v[80:83], v[228:231], v[184:187], v[80:83]
    buffer_load_dwordx4 v[128:131], v18, s[44:47], s58 offen offset:2048 sc1
    s_add_u32 s58, s58, 6144
    buffer_load_dwordx4 v[132:135], v18, s[44:47], s58 offen offset:0 sc1
    buffer_load_dwordx4 v[136:139], v18, s[44:47], s58 offen offset:1024 sc1
    buffer_load_dwordx4 v[140:143], v18, s[44:47], s58 offen offset:2048 sc1
L_phase3:
    ds_read_b64_tr_b16 v[192:193], v12 offset:0
    ds_read_b64_tr_b16 v[194:195], v12 offset:144
    ds_read_b64_tr_b16 v[196:197], v12 offset:64
    ds_read_b64_tr_b16 v[198:199], v12 offset:208
    ds_read_b64_tr_b16 v[200:201], v13 offset:128
    ds_read_b64_tr_b16 v[202:203], v13 offset:272
    ds_read_b64_tr_b16 v[208:209], v12 offset:2304
    ds_read_b64_tr_b16 v[210:211], v12 offset:2448
    ds_read_b64_tr_b16 v[212:213], v12 offset:2368
    ds_read_b64_tr_b16 v[214:215], v12 offset:2512
    ds_read_b64_tr_b16 v[216:217], v13 offset:2432
    ds_read_b64_tr_b16 v[218:219], v13 offset:2576
    ds_read_b64_tr_b16 v[220:221], v12 offset:4608
    ds_read_b64_tr_b16 v[222:223], v12 offset:4752
    ds_read_b64_tr_b16 v[224:225], v12 offset:4672
    ds_read_b64_tr_b16 v[226:227], v12 offset:4816
    ds_read_b64_tr_b16 v[228:229], v13 offset:4736
    ds_read_b64_tr_b16 v[230:231], v13 offset:4880
    s_waitcnt vmcnt(9)
    s_branch L_ck_127
L_rt_126:
    s_add_u32 s58, s90, 3072
    buffer_load_dwordx4 v[96:99], v18, s[44:47], s58 offen offset:0 sc1
    buffer_load_dwordx4 v[100:103], v18, s[44:47], s58 offen offset:1024 sc1
    buffer_load_dwordx4 v[104:107], v18, s[44:47], s58 offen offset:2048 sc1
    s_waitcnt vmcnt(0)
L_ck_127:
    v_xor_b32 v232, v99, v252
    v_bitop3_b32 v232, v232, v103, v252 bitop3:0xf6
    v_bitop3_b32 v232, v232, v107, v252 bitop3:0xf6
    v_cmp_ne_u32 vcc, 0, v232
    s_cbranch_vccz L_ok_128
    s_sub_u32 s84, s84, 1
    s_cmp_gt_i32 s84, 0
    s_cbranch_scc1 L_rt_126
L_ok_128:
    v_mov_b32 v99, v104
    v_mov_b32 v103, v105
    v_mov_b32 v232, v106
    s_waitcnt lgkmcnt(12)
    v_mfma_f32_32x32x16_bf16 v[48:63], v[192:195], v[96:99], v[48:63]
    ds_read_b64_tr_b16 v[192:193], v12 offset:6912
    ds_read_b64_tr_b16 v[194:195], v12 offset:7056
    v_mfma_f32_32x32x16_bf16 v[64:79], v[196:199], v[96:99], v[64:79]
    ds_read_b64_tr_b16 v[196:197], v12 offset:6976
    ds_read_b64_tr_b16 v[198:199], v12 offset:7120
    v_mfma_f32_16x16x32_bf16 v[80:83], v[200:203], v[96:99], v[80:83]
    ds_read_b64_tr_b16 v[200:201], v13 offset:7040
    ds_read_b64_tr_b16 v[202:203], v13 offset:7184
    s_waitcnt lgkmcnt(12)
    v_mfma_f32_32x32x16_bf16 v[48:63], v[208:211], v[100:103], v[48:63]
    ds_read_b64_tr_b16 v[208:209], v12 offset:36864
    ds_read_b64_tr_b16 v[210:211], v12 offset:37008
    v_mfma_f32_32x32x16_bf16 v[64:79], v[212:215], v[100:103], v[64:79]
    ds_read_b64_tr_b16 v[212:213], v12 offset:36928
    ds_read_b64_tr_b16 v[214:215], v12 offset:37072
    s_waitcnt vmcnt(6)
    s_branch L_ck_130
L_rt_129:
    s_add_u32 s58, s90, 9216
    buffer_load_dwordx4 v[108:111], v18, s[44:47], s58 offen offset:0 sc1
    buffer_load_dwordx4 v[112:115], v18, s[44:47], s58 offen offset:1024 sc1
    buffer_load_dwordx4 v[116:119], v18, s[44:47], s58 offen offset:2048 sc1
    s_waitcnt vmcnt(0)
L_ck_130:
    v_xor_b32 v233, v111, v252
    v_bitop3_b32 v233, v233, v115, v252 bitop3:0xf6
    v_bitop3_b32 v233, v233, v119, v252 bitop3:0xf6
    v_cmp_ne_u32 vcc, 0, v233
    s_cbranch_vccz L_ok_131
    s_sub_u32 s84, s84, 1
    s_cmp_gt_i32 s84, 0
    s_cbranch_scc1 L_rt_129
L_ok_131:
    v_mov_b32 v111, v116
    v_mov_b32 v115, v117
    v_mov_b32 v233, v118
    v_mfma_f32_16x16x32_bf16 v[80:83], v[216:219], v[100:103], v[80:83]
    ds_read_b64_tr_b16 v[216:217], v13 offset:36992
    ds_read_b64_tr_b16 v[218:219], v13 offset:37136
    s_waitcnt lgkmcnt(12)
    v_mfma_f32_32x32x16_bf16 v[48:63], v[220:223], v[108:111], v[48:63]
    ds_read_b64_tr_b16 v[220:221], v12 offset:39168
    ds_read_b64_tr_b16 v[222:223], v12 offset:39312
    v_mfma_f32_32x32x16_bf16 v[64:79], v[224:227], v[108:111], v[64:79]
    ds_read_b64_tr_b16 v[224:225], v12 offset:39232
    ds_read_b64_tr_b16 v[226:227], v12 offset:39376
    v_mfma_f32_16x16x32_bf16 v[80:83], v[228:231], v[108:111], v[80:83]
    ds_read_b64_tr_b16 v[228:229], v13 offset:39296
    ds_read_b64_tr_b16 v[230:231], v13 offset:39440
    s_waitcnt lgkmcnt(12)
    v_mfma_f32_32x32x16_bf16 v[48:63], v[192:195], v[112:115], v[48:63]
    ds_read_b64_tr_b16 v[192:193], v12 offset:41472
    ds_read_b64_tr_b16 v[194:195], v12 offset:41616
    v_mfma_f32_32x32x16_bf16 v[64:79], v[196:199], v[112:115], v[64:79]
    ds_read_b64_tr_b16 v[196:197], v12 offset:41536
    ds_read_b64_tr_b16 v[198:199], v12 offset:41680
    s_waitcnt vmcnt(3)
    s_branch L_ck_133
L_rt_132:
    s_add_u32 s58, s90, 52224
    buffer_load_dwordx4 v[120:123], v18, s[44:47], s58 offen offset:0 sc1
    buffer_load_dwordx4 v[124:127], v18, s[44:47], s58 offen offset:1024 sc1
    buffer_load_dwordx4 v[128:131], v18, s[44:47], s58 offen offset:2048 sc1
    s_waitcnt vmcnt(0)
L_ck_133:
    v_xor_b32 v234, v123, v252
    v_bitop3_b32 v234, v234, v127, v252 bitop3:0xf6
    v_bitop3_b32 v234, v234, v131, v252 bitop3:0xf6
    v_cmp_ne_u32 vcc, 0, v234
    s_cbranch_vccz L_ok_134
    s_sub_u32 s84, s84, 1
    s_cmp_gt_i32 s84, 0
    s_cbranch_scc1 L_rt_132
L_ok_134:
    v_mov_b32 v123, v128
    v_mov_b32 v127, v129
    v_mov_b32 v234, v130
    v_mfma_f32_16x16x32_bf16 v[80:83], v[200:203], v[112:115], v[80:83]
    ds_read_b64_tr_b16 v[200:201], v13 offset:41600
    ds_read_b64_tr_b16 v[202:203], v13 offset:41744
    s_waitcnt lgkmcnt(12)
    v_mfma_f32_32x32x16_bf16 v[48:63], v[208:211], v[120:123], v[48:63]
    ds_read_b64_tr_b16 v[208:209], v12 offset:43776
    ds_read_b64_tr_b16 v[210:211], v12 offset:43920
    v_mfma_f32_32x32x16_bf16 v[64:79], v[212:215], v[120:123], v[64:79]
    ds_read_b64_tr_b16 v[212:213], v12 offset:43840
    ds_read_b64_tr_b16 v[214:215], v12 offset:43984
    v_mfma_f32_16x16x32_bf16 v[80:83], v[216:219], v[120:123], v[80:83]
    ds_read_b64_tr_b16 v[216:217], v13 offset:43904
    ds_read_b64_tr_b16 v[218:219], v13 offset:44048
    s_waitcnt lgkmcnt(12)
    v_mfma_f32_32x32x16_bf16 v[48:63], v[220:223], v[124:127], v[48:63]
    ds_read_b64_tr_b16 v[220:221], v204 offset:0
    ds_read_b64_tr_b16 v[222:223], v204 offset:144
    v_mfma_f32_32x32x16_bf16 v[64:79], v[224:227], v[124:127], v[64:79]
    ds_read_b64_tr_b16 v[224:225], v204 offset:64
    ds_read_b64_tr_b16 v[226:227], v204 offset:208
    s_waitcnt vmcnt(0)
    s_branch L_ck_136
L_rt_135:
    s_add_u32 s58, s90, 58368
    buffer_load_dwordx4 v[132:135], v18, s[44:47], s58 offen offset:0 sc1
    buffer_load_dwordx4 v[136:139], v18, s[44:47], s58 offen offset:1024 sc1
    buffer_load_dwordx4 v[140:143], v18, s[44:47], s58 offen offset:2048 sc1
    s_waitcnt vmcnt(0)
L_ck_136:
    v_xor_b32 v235, v135, v252
    v_bitop3_b32 v235, v235, v139, v252 bitop3:0xf6
    v_bitop3_b32 v235, v235, v143, v252 bitop3:0xf6
    v_cmp_ne_u32 vcc, 0, v235
    s_cbranch_vccz L_ok_137
    s_sub_u32 s84, s84, 1
    s_cmp_gt_i32 s84, 0
    s_cbranch_scc1 L_rt_135
L_ok_137:
    v_mov_b32 v135, v140
    v_mov_b32 v139, v141
    v_mov_b32 v235, v142
    v_mfma_f32_16x16x32_bf16 v[80:83], v[228:231], v[124:127], v[80:83]
    ds_read_b64_tr_b16 v[228:229], v205 offset:128
    ds_read_b64_tr_b16 v[230:231], v205 offset:272
    s_lshr_b32 s57, s2, 3
    s_xor_b32 s58, s48, 3
    s_or_b32 s57, s57, s58
    s_cbranch_scc1 L_g_138
    buffer_wbl2 sc1
L_g_138:
    s_waitcnt lgkmcnt(12)
    v_mfma_f32_32x32x16_bf16 v[48:63], v[192:195], v[132:135], v[48:63]
    s_waitcnt lgkmcnt(6)
    v_mfma_f32_32x32x16_bf16 v[48:63], v[208:211], v[136:139], v[48:63]
    s_waitcnt lgkmcnt(4)
    v_mfma_f32_32x32x16_bf16 v[48:63], v[220:223], v[232:235], v[48:63]
    s_waitcnt lgkmcnt(0)
    v_mfma_f32_16x16x32_bf16 v[80:83], v[200:203], v[132:135], v[80:83]
    v_mfma_f32_16x16x32_bf16 v[80:83], v[216:219], v[136:139], v[80:83]
    v_mfma_f32_16x16x32_bf16 v[80:83], v[228:231], v[232:235], v[80:83]
    v_mfma_f32_32x32x16_bf16 v[64:79], v[196:199], v[132:135], v[64:79]
    v_mfma_f32_32x32x16_bf16 v[64:79], v[212:215], v[136:139], v[64:79]
    s_nop 5
    ds_write_b128 v14, v[48:51] offset:0
    v_mfma_f32_32x32x16_bf16 v[64:79], v[224:227], v[232:235], v[64:79]
    ds_write_b128 v14, v[52:55] offset:16
    ds_write_b128 v14, v[56:59] offset:32
    ds_write_b128 v14, v[60:63] offset:48
    ds_write_b128 v16, v[80:83] offset:128
    s_nop 7
    ds_write_b128 v14, v[64:67] offset:64
    ds_write_b128 v14, v[68:71] offset:80
    ds_write_b128 v14, v[72:75] offset:96
    ds_write_b128 v14, v[76:79] offset:112
    s_waitcnt lgkmcnt(0)
    s_barrier
    ds_read_b128 v[96:99], v238 offset:0
    ds_read_b128 v[100:103], v238 offset:9216
    ds_read_b128 v[104:107], v238 offset:18432
    ds_read_b128 v[108:111], v238 offset:27648
    ds_read_b128 v[112:115], v239 offset:0
    ds_read_b128 v[116:119], v239 offset:9216
    ds_read_b128 v[120:123], v239 offset:18432
    ds_read_b128 v[124:127], v239 offset:27648
    s_cmp_lg_u32 s48, 0
    s_cbranch_scc1 L_g_139
    ds_read_b128 v[128:131], v238 offset:8192
    ds_read_b128 v[132:135], v238 offset:17408
    ds_read_b128 v[136:139], v238 offset:26624
    ds_read_b128 v[140:143], v238 offset:35840
    ds_read_b128 v[144:147], v239 offset:8192
    ds_read_b128 v[148:151], v239 offset:17408
    ds_read_b128 v[152:155], v239 offset:26624
    ds_read_b128 v[156:159], v239 offset:35840
L_g_139:
    s_waitcnt lgkmcnt(0)
    v_pk_add_f32 v[96:97], v[96:97], v[104:105]
    v_pk_add_f32 v[112:113], v[112:113], v[120:121]
    v_pk_add_f32 v[98:99], v[98:99], v[106:107]
    v_pk_add_f32 v[114:115], v[114:115], v[122:123]
    v_pk_add_f32 v[100:101], v[100:101], v[108:109]
    v_pk_add_f32 v[116:117], v[116:117], v[124:125]
    v_pk_add_f32 v[102:103], v[102:103], v[110:111]
    v_pk_add_f32 v[118:119], v[118:119], v[126:127]
    v_pk_add_f32 v[96:97], v[96:97], v[112:113]
    v_pk_add_f32 v[98:99], v[98:99], v[114:115]
    v_pk_add_f32 v[100:101], v[100:101], v[116:117]
    v_pk_add_f32 v[102:103], v[102:103], v[118:119]
    v_cvt_pk_bf16_f32 v160, v96, v97
    v_cvt_pk_bf16_f32 v161, v98, v99
    v_cvt_pk_bf16_f32 v162, v100, v101
    v_cvt_pk_bf16_f32 v163, v102, v103
    buffer_store_dwordx4 v[160:163], v236, s[40:43], s85 offen nt
    s_cmp_lg_u32 s48, 0
    s_cbranch_scc1 L_end
    v_pk_add_f32 v[128:129], v[128:129], v[136:137]
    v_pk_add_f32 v[144:145], v[144:145], v[152:153]
    v_pk_add_f32 v[130:131], v[130:131], v[138:139]
    v_pk_add_f32 v[146:147], v[146:147], v[154:155]
    v_pk_add_f32 v[132:133], v[132:133], v[140:141]
    v_pk_add_f32 v[148:149], v[148:149], v[156:157]
    v_pk_add_f32 v[134:135], v[134:135], v[142:143]
    v_pk_add_f32 v[150:151], v[150:151], v[158:159]
    v_pk_add_f32 v[128:129], v[128:129], v[144:145]
    v_pk_add_f32 v[130:131], v[130:131], v[146:147]
    v_pk_add_f32 v[132:133], v[132:133], v[148:149]
    v_pk_add_f32 v[134:135], v[134:135], v[150:151]
    v_cvt_pk_bf16_f32 v164, v128, v129
    v_cvt_pk_bf16_f32 v165, v130, v131
    v_cvt_pk_bf16_f32 v166, v132, v133
    v_cvt_pk_bf16_f32 v167, v134, v135
    buffer_store_dwordx4 v[164:167], v237, s[40:43], s85 offen nt
    s_or_b32 s57, s2, s48
    s_cbranch_scc1 L_end
    s_mov_b32 s57, 163840
    v_mov_b32 v3, s83
    s_mov_b64 exec, 1
    buffer_store_dword v3, off, s[44:47], s57 sc1
L_end:
L_exit:
    s_endpgm
L_fallback:
    v_mov_b32 v17, 0
    v_lshlrev_b32 v4, 2, v7
    v_min_u32 v5, 18, v7
    v_lshlrev_b32 v5, 4, v5
    v_mul_u32_u24 v40, 304, v6
    v_add_u32 v5, v5, v40
    v_mov_b32 v40, 0xff800000
    v_mov_b32 v41, 0xff800000
    s_mov_b32 s57, 0
L_fb1:
    buffer_load_dwordx4 v[20:23], v18, s[44:47], s57 offen sc1
    buffer_load_dword v28, v4, s[44:47], s57 offen offset:1024 sc1
    buffer_load_dwordx4 v[32:35], v5, s[44:47], s57 offen offset:1152 sc1
    buffer_load_dwordx4 v[36:39], v5, s[44:47], s57 offen offset:1760 sc1
    s_waitcnt vmcnt(0)
    v_mfma_f32_32x32x16_bf16 v[112:127], v[20:23], v[8:11], 0
    v_mfma_f32_32x32x16_bf16 v[128:143], v[20:23], v[12:15], 0
    s_nop 9
    v_mfma_f32_32x32x4_2b_bf16 v[112:143], v[28:29], v[16:17], v[112:143]
    s_nop 15
    s_nop 3
    v_max3_f32 v40, v40, v112, v113
    v_max3_f32 v40, v40, v114, v115
    v_max3_f32 v40, v40, v116, v117
    v_max3_f32 v40, v40, v118, v119
    v_max3_f32 v40, v40, v120, v121
    v_max3_f32 v40, v40, v122, v123
    v_max3_f32 v40, v40, v124, v125
    v_max3_f32 v40, v40, v126, v127
    v_max3_f32 v41, v41, v128, v129
    v_max3_f32 v41, v41, v130, v131
    v_max3_f32 v41, v41, v132, v133
    v_max3_f32 v41, v41, v134, v135
    v_max3_f32 v41, v41, v136, v137
    v_max3_f32 v41, v41, v138, v139
    v_max3_f32 v41, v41, v140, v141
    v_max3_f32 v41, v41, v142, v143
    s_add_u32 s57, s57, 2368
    s_cmp_lt_u32 s57, 151552
    s_cbranch_scc1 L_fb1
    v_mov_b32 v42, v40
    s_nop 1
    v_permlane32_swap_b32 v42, v40
    v_max_f32 v40, v42, v40
    v_mov_b32 v42, v41
    s_nop 1
    v_permlane32_swap_b32 v42, v41
    v_max_f32 v41, v42, v41
    v_mov_b32 v48, 0
    v_mov_b32 v49, 0
    v_mov_b32 v50, 0
    v_mov_b32 v51, 0
    v_mov_b32 v52, 0
    v_mov_b32 v53, 0
    v_mov_b32 v54, 0
    v_mov_b32 v55, 0
    v_mov_b32 v56, 0
    v_mov_b32 v57, 0
    v_mov_b32 v58, 0
    v_mov_b32 v59, 0
    v_mov_b32 v60, 0
    v_mov_b32 v61, 0
    v_mov_b32 v62, 0
    v_mov_b32 v63, 0
    v_mov_b32 v64, 0
    v_mov_b32 v65, 0
    v_mov_b32 v66, 0
    v_mov_b32 v67, 0
    v_mov_b32 v68, 0
    v_mov_b32 v69, 0
    v_mov_b32 v70, 0
    v_mov_b32 v71, 0
    v_mov_b32 v72, 0
    v_mov_b32 v73, 0
    v_mov_b32 v74, 0
    v_mov_b32 v75, 0
    v_mov_b32 v76, 0
    v_mov_b32 v77, 0
    v_mov_b32 v78, 0
    v_mov_b32 v79, 0
    s_mov_b32 s57, 0
L_fb2:
    buffer_load_dwordx4 v[20:23], v18, s[44:47], s57 offen sc1
    buffer_load_dword v28, v4, s[44:47], s57 offen offset:1024 sc1
    buffer_load_dwordx4 v[32:35], v5, s[44:47], s57 offen offset:1152 sc1
    buffer_load_dwordx4 v[36:39], v5, s[44:47], s57 offen offset:1760 sc1
    s_waitcnt vmcnt(0)
    v_mfma_f32_32x32x16_bf16 v[112:127], v[20:23], v[8:11], 0
    v_mfma_f32_32x32x16_bf16 v[128:143], v[20:23], v[12:15], 0
    s_nop 9
    v_mfma_f32_32x32x4_2b_bf16 v[112:143], v[28:29], v[16:17], v[112:143]
    s_nop 15
    s_nop 3
    v_sub_f32 v112, v112, v40
    v_sub_f32 v113, v113, v40
    v_sub_f32 v114, v114, v40
    v_sub_f32 v115, v115, v40
    v_sub_f32 v116, v116, v40
    v_sub_f32 v117, v117, v40
    v_sub_f32 v118, v118, v40
    v_sub_f32 v119, v119, v40
    v_sub_f32 v120, v120, v40
    v_sub_f32 v121, v121, v40
    v_sub_f32 v122, v122, v40
    v_sub_f32 v123, v123, v40
    v_sub_f32 v124, v124, v40
    v_sub_f32 v125, v125, v40
    v_sub_f32 v126, v126, v40
    v_sub_f32 v127, v127, v40
    v_sub_f32 v128, v128, v41
    v_sub_f32 v129, v129, v41
    v_sub_f32 v130, v130, v41
    v_sub_f32 v131, v131, v41
    v_sub_f32 v132, v132, v41
    v_sub_f32 v133, v133, v41
    v_sub_f32 v134, v134, v41
    v_sub_f32 v135, v135, v41
    v_sub_f32 v136, v136, v41
    v_sub_f32 v137, v137, v41
    v_sub_f32 v138, v138, v41
    v_sub_f32 v139, v139, v41
    v_sub_f32 v140, v140, v41
    v_sub_f32 v141, v141, v41
    v_sub_f32 v142, v142, v41
    v_sub_f32 v143, v143, v41
    v_exp_f32 v112, v112
    v_exp_f32 v113, v113
    v_exp_f32 v114, v114
    v_exp_f32 v115, v115
    v_exp_f32 v116, v116
    v_exp_f32 v117, v117
    v_exp_f32 v118, v118
    v_exp_f32 v119, v119
    v_exp_f32 v120, v120
    v_exp_f32 v121, v121
    v_exp_f32 v122, v122
    v_exp_f32 v123, v123
    v_exp_f32 v124, v124
    v_exp_f32 v125, v125
    v_exp_f32 v126, v126
    v_exp_f32 v127, v127
    v_exp_f32 v128, v128
    v_exp_f32 v129, v129
    v_exp_f32 v130, v130
    v_exp_f32 v131, v131
    v_exp_f32 v132, v132
    v_exp_f32 v133, v133
    v_exp_f32 v134, v134
    v_exp_f32 v135, v135
    v_exp_f32 v136, v136
    v_exp_f32 v137, v137
    v_exp_f32 v138, v138
    v_exp_f32 v139, v139
    v_exp_f32 v140, v140
    v_exp_f32 v141, v141
    v_exp_f32 v142, v142
    v_exp_f32 v143, v143
    v_smfmac_f32_32x32x32_bf16 v[48:63], v[32:35], v[112:119], v2
    v_smfmac_f32_32x32x32_bf16 v[48:63], v[36:39], v[120:127], v2
    v_smfmac_f32_32x32x32_bf16 v[64:79], v[32:35], v[128:135], v2
    v_smfmac_f32_32x32x32_bf16 v[64:79], v[36:39], v[136:143], v2
    s_add_u32 s57, s57, 2368
    s_cmp_lt_u32 s57, 151552
    s_cbranch_scc1 L_fb2
    s_nop 15
    v_mov_b32 v59, v58
    v_mov_b32 v75, v74
    s_nop 0
    v_permlane32_swap_b32 v58, v59
    v_permlane32_swap_b32 v74, v75
    s_mov_b64 s[94:95], -1
    v_mov_b32 v80, 0
    v_mov_b32 v81, 0
    v_mov_b32 v82, 0
    v_mov_b32 v83, 0
    v_mov_b32 v84, 0
    v_mov_b32 v85, 0
    v_mov_b32 v86, 0
    v_mov_b32 v87, 0
    v_mov_b32 v88, 0
    v_mov_b32 v89, 0
    v_mov_b32 v92, 0
    v_mov_b32 v93, 0
    v_mov_b32 v94, 0
    v_mov_b32 v95, 0
    v_mov_b32 v96, 0
    v_mov_b32 v97, 0
    v_mov_b32 v98, 0
    v_mov_b32 v99, 0
    v_mov_b32 v100, 0
    v_mov_b32 v101, 0
    s_nop 1
    s_branch L_fin
L_codeend:
.section .rodata,"a"
.p2align 6
.amdhsa_kernel gated_mix__linear_kernel_hedgehog__grouped_kv_mqa__prompt_kernel
  .amdhsa_next_free_vgpr 255
  .amdhsa_next_free_sgpr 102
  .amdhsa_accum_offset 256
  .amdhsa_group_segment_fixed_size 0
  .amdhsa_kernarg_size 104
  .amdhsa_user_sgpr_count 2
  .amdhsa_user_sgpr_kernarg_segment_ptr 1
  .amdhsa_system_sgpr_workgroup_id_x 1
  .amdhsa_float_denorm_mode_32 3
.end_amdhsa_kernel
```
